```python
import torch

def _softmax(x, axis=-1):
    return torch.softmax(x, dim=axis)
def _gelu(x):
    return torch.nn.functional.gelu(x, approximate="tanh")
def _silu(x):
    return torch.nn.functional.silu(x)
def _sigmoid(x):
    return torch.sigmoid(x)
def _layernorm(x, axis=-1, eps=1e-5):
    m = x.mean(dim=axis, keepdim=True)
    v = x.var(dim=axis, keepdim=True, unbiased=False)
    return (x - m) / torch.sqrt(v + eps)
def _scatter_add(tgt, idx, src, axis=0):
    return tgt.clone().index_add_(axis, idx, src)
def _segment_sum(src, seg, n):
    out = torch.zeros((n,) + src.shape[1:], dtype=src.dtype)
    return out.index_add_(0, seg, src)
def _pad(x, pw):
    flat = tuple(v for pair in reversed(pw) for v in pair)
    return torch.nn.functional.pad(x, flat)

kernel_name = 'gated_mix__sliding_block__dense_activation_mish__prompt'

def setup_inputs():

    _w = (lambda a: (lambda t: t.to(torch.bfloat16) if t.is_floating_point() else t)(torch.as_tensor(a)))
    def _A_setup():
        B, S, D = 1, 2048, 512
        return {
            "x": _w((lambda *s: torch.randn(*s, dtype=torch.bfloat16) * 0.05)(B, S, D)),
            "wqkv": _w((lambda *s: torch.randn(*s, dtype=torch.bfloat16) * 0.8)(D, 3 * D)),
            "wo": _w((lambda *s: torch.randn(*s, dtype=torch.bfloat16) * 0.05)(D, D)),
        }
    _A_in = _A_setup()

    def _B_setup():
        B, S, D, F = 1, 2048, 512, 1376
        return {
            "x": _w((lambda *s: torch.randn(*s, dtype=torch.bfloat16) * 0.05)(B, S, D)),
            "w1": _w((lambda *s: torch.randn(*s, dtype=torch.bfloat16) * 12.8)(D, F) * (D ** -0.5)),
            "b1": _w((lambda *s: torch.randn(*s, dtype=torch.bfloat16) * 0.8)(F)),
            "w2": _w((lambda *s: torch.randn(*s, dtype=torch.bfloat16) * 0.8)(F, D) * (F ** -0.5)),
        }
    _B_in = _B_setup()

    return {
        "A_x": _A_in["x"],
        "A_wqkv": _A_in["wqkv"],
        "A_wo": _A_in["wo"],
        "B_x": _B_in["x"],
        "B_w1": _B_in["w1"],
        "B_b1": _B_in["b1"],
        "B_w2": _B_in["w2"],
        "gate_w": _w((lambda *s: torch.randn(*s, dtype=torch.bfloat16) * 0.05)(512) * 16.0),
    }

def reference(A_x, A_wqkv, A_wo, B_x, B_w1, B_b1, B_w2, gate_w):
    def _A_ref(x, wqkv, wo):
        B, S, D = x.shape
        H = 32; Dh = D // H; W = 256
        qkv = (lambda x, *d: x.permute(*d))((x @ wqkv).reshape(B, S, 3, H, Dh), 2, 0, 3, 1, 4)
        q, k, v = qkv[0], qkv[1], qkv[2]
        scores = torch.einsum("bhqd,bhkd->bhqk", q, k) * (Dh ** -0.5)
        idx = torch.arange(S)
        mask = (idx[:, None] - idx[None, :] >= 0) & (idx[:, None] - idx[None, :] < W)
        scores = torch.where(mask[None, None], scores, -1e9)
        p = _softmax(scores, axis=-1)
        o = torch.einsum("bhqk,bhkd->bhqd", p, v)
        return (lambda x, *d: x.permute(*d))(o, 0, 2, 1, 3).reshape(B, S, D) @ wo

    def _B_ref(x, w1, b1, w2):
        h = torch.einsum("bsd,df->bsf", x, w1) + b1
        sp = torch.log1p(torch.exp(-torch.abs(h))) + torch.where(h > 0, h, torch.zeros_like(h))
        act = h * torch.tanh(sp)
        return torch.einsum("bsf,fd->bsd", act, w2)

    x = A_x
    g = _sigmoid((x * gate_w).sum(-1, keepdims=True))
    a = _A_ref(x, A_wqkv, A_wo)
    b = _B_ref(x, B_w1, B_b1, B_w2)
    return g * a + (1 - g) * b
```

```asm
; @launch grid=(256,1,1) block=(512,1,1) lds=163840
.amdgcn_target "amdgcn-amd-amdhsa--gfx950"
.text
.globl gated_mix__sliding_block__dense_activation_mish__prompt_kernel
.p2align 8
.type gated_mix__sliding_block__dense_activation_mish__prompt_kernel,@function
gated_mix__sliding_block__dense_activation_mish__prompt_kernel:
    s_cmp_ge_u32 s2, 256
    s_cbranch_scc1 L_END
    s_load_dwordx16 s[4:19], s[0:1], 0
    s_load_dwordx4 s[20:23], s[0:1], 64
    s_load_dwordx2 s[24:25], s[0:1], 80
    v_lshrrev_b32 v2, 6, v0
    v_and_b32 v1, 63, v0
    s_and_b32 s27, s2, 7
    s_lshr_b32 s35, s2, 3
    v_readfirstlane_b32 s26, v2
    s_and_b32 s38, s27, 1
    s_lshl_b32 s38, s38, 3
    s_and_b32 s39, s35, 7
    s_add_u32 s40, s38, s39
    s_lshr_b32 s38, s27, 1
    s_lshl_b32 s38, s38, 2
    s_lshr_b32 s39, s35, 3
    s_add_u32 s41, s38, s39
    s_and_b32 s42, s41, 1
    s_lshr_b32 s43, s41, 1
    s_add_u32 s44, s43, 8
    s_and_b32 s39, s35, 7
    s_add_u32 s45, s39, 16
    s_sub_u32 s39, s39, s43
    s_and_b32 s39, s39, 7
    s_and_b32 s38, s40, 8
    s_add_u32 s39, s39, s38
    s_cmp_eq_u32 s42, 0
    s_cselect_b32 s45, s43, s45
    s_cselect_b32 s40, s40, s39
    s_or_b32 s38, s35, 1
    s_xor_b32 s39, s35, 18
    s_cmp_eq_u32 s38, 13
    s_cselect_b32 s33, s39, s35
    s_cmp_eq_u32 s38, 31
    s_cselect_b32 s33, s39, s33
    s_lshl_b32 s32, s27, 2
    s_and_b32 s38, s33, 3
    s_add_u32 s32, s32, s38
    s_lshr_b32 s33, s33, 2
    s_cmp_ge_u32 s26, 4
    s_cbranch_scc0 L_CONSUMER
    s_sub_u32 s47, s26, 4
    v_lshrrev_b32 v4, 3, v1
    v_lshrrev_b32 v5, 4, v1
    v_and_b32 v6, 7, v1
    v_xor_b32 v7, v6, v5
    v_xor_b32 v8, 4, v7
    s_lshl_b32 s38, s40, 7
    s_lshl_b32 s39, s47, 5
    s_add_u32 s38, s38, s39
    v_add_u32 v4, s38, v4
    v_lshlrev_b32 v4, 10, v4
    v_lshl_add_u32 v2, v7, 4, v4
    v_lshl_add_u32 v3, v8, 4, v4
    v_add_u32 v3, 7168, v3
    s_mov_b32 s34, 0
    s_lshl_b32 s59, s34, 7
    v_and_b32 v13, 15, v1
    v_lshrrev_b32 v13, 2, v13
    v_lshrrev_b32 v14, 5, v1
    v_lshl_add_u32 v13, v14, 2, v13
    v_mul_u32_u24 v10, 3072, v13
    v_bfe_u32 v14, v1, 4, 1
    v_lshl_add_u32 v10, v14, 6, v10
    v_and_b32 v14, 3, v1
    v_lshl_add_u32 v10, v14, 4, v10
    v_and_b32 v13, 15, v1
    v_lshrrev_b32 v13, 2, v13
    v_lshrrev_b32 v14, 5, v1
    v_lshl_add_u32 v13, v14, 2, v13
    v_mul_u32_u24 v12, 2752, v13
    v_bfe_u32 v14, v1, 4, 1
    v_lshl_add_u32 v12, v14, 6, v12
    v_and_b32 v14, 3, v1
    v_lshl_add_u32 v12, v14, 4, v12
    s_mul_i32 s38, s47, 49152
    s_lshl_b32 s39, s43, 7
    s_add_u32 s38, s38, s39
    v_add_u32 v13, s38, v10
    s_mul_i32 s38, s47, 44032
    v_add_u32 v12, s38, v12
    s_lshl_b32 s38, s44, 7
    v_add_u32 v11, s38, v12
    s_lshl_b32 s38, s45, 7
    v_add_u32 v12, s38, v12
    s_lshl_b32 s38, s42, 10
    s_add_u32 s38, s38, 1024
    v_add_u32 v10, s38, v13
    s_cmp_eq_u32 s42, 0
    s_cselect_b64 s[66:67], -1, 0
    v_cndmask_b32 v11, v11, v13, s[66:67]
    s_cmp_ge_u32 s45, 22
    s_cselect_b32 s38, 0x40000000, 0
    v_add_u32 v12, s38, v12
    s_cmp_eq_u32 s45, 21
    s_cselect_b32 s66, 0xffff, -1
    s_cselect_b32 s67, 0xffff, -1
    s_cselect_b32 s46, 1, 0
    s_cmp_eq_u32 s47, 0
    s_cselect_b32 s46, s46, 0
    s_mov_b32 s63, 196608
    s_mov_b32 s65, 176128
    s_cmp_eq_u32 s42, 0
    s_cselect_b32 s64, s63, s65
    s_mov_b32 s68, 23552
    s_mov_b32 s70, 20992
    s_cselect_b32 s69, s68, s70
    s_mul_i32 s60, s34, s63
    s_mul_i32 s61, s34, s64
    s_mul_i32 s62, s34, s65
    s_lshl_b32 s72, s47, 12
    s_lshl_b32 s73, s47, 11
    s_waitcnt lgkmcnt(0)
    s_mov_b32 s48, s4
    s_and_b32 s49, s5, 0xffff
    s_mov_b32 s50, 2097152
    s_mov_b32 s51, 0x00020000
    s_mov_b32 s52, s6
    s_and_b32 s53, s7, 0xffff
    s_mov_b32 s54, 1572864
    s_mov_b32 s55, 0x00020000
    s_mov_b32 s80, s12
    s_and_b32 s81, s13, 0xffff
    s_mov_b32 s82, 1409024
    s_mov_b32 s83, 0x00020000
    s_cmp_eq_u32 s42, 0
    s_cselect_b32 s76, s52, s80
    s_cselect_b32 s77, s53, s81
    s_cselect_b32 s78, s54, s82
    s_mov_b32 s79, 0x00020000
    s_cmp_eq_u32 s46, 0
    s_cbranch_scc1 L_NOGATE
    s_mov_b32 s84, s18
    s_and_b32 s85, s19, 0xffff
    s_mov_b32 s86, 1024
    s_mov_b32 s87, 0x00020000
    v_lshlrev_b32 v29, 1, v1
    v_add_u32 v29, s59, v29
    buffer_load_ushort v20, v29, s[84:87], 0 offen
    v_add_u32 v29, 128, v29
    v_and_b32 v29, 1023, v29
    buffer_load_ushort v21, v29, s[84:87], 0 offen
    v_add_u32 v29, 128, v29
    v_and_b32 v29, 1023, v29
    buffer_load_ushort v22, v29, s[84:87], 0 offen
    v_add_u32 v29, 128, v29
    v_and_b32 v29, 1023, v29
    buffer_load_ushort v23, v29, s[84:87], 0 offen
    v_add_u32 v29, 128, v29
    v_and_b32 v29, 1023, v29
    buffer_load_ushort v24, v29, s[84:87], 0 offen
    v_add_u32 v29, 128, v29
    v_and_b32 v29, 1023, v29
    buffer_load_ushort v25, v29, s[84:87], 0 offen
    v_add_u32 v29, 128, v29
    v_and_b32 v29, 1023, v29
    buffer_load_ushort v26, v29, s[84:87], 0 offen
    v_add_u32 v29, 128, v29
    v_and_b32 v29, 1023, v29
    buffer_load_ushort v27, v29, s[84:87], 0 offen
    v_add_u32 v29, 128, v29
    v_and_b32 v29, 1023, v29
    v_lshrrev_b32 v28, 2, v1
    v_lshlrev_b32 v28, 9, v28
    v_and_b32 v29, 3, v1
    v_lshl_add_u32 v28, v29, 6, v28
    v_add_u32 v28, 98560, v28
L_NOGATE:
    s_add_u32 m0, s72, 0
    s_add_u32 s74, s59, 14336
    buffer_load_dwordx4 v2, s[48:51], s59 offen lds
    buffer_load_dwordx4 v3, s[48:51], s59 offen offset:1024 lds
    buffer_load_dwordx4 v2, s[48:51], s74 offen offset:2048 lds
    buffer_load_dwordx4 v3, s[48:51], s74 offen offset:3072 lds
    s_add_u32 m0, s73, 16384
    s_add_u32 s74, s60, s68
    buffer_load_dwordx4 v10, s[52:55], s60 offen lds
    buffer_load_dwordx4 v10, s[52:55], s74 offen offset:1024 lds
    s_add_u32 m0, s73, 24576
    s_add_u32 s74, s61, s69
    buffer_load_dwordx4 v11, s[76:79], s61 offen lds
    buffer_load_dwordx4 v11, s[76:79], s74 offen offset:1024 lds
    s_add_u32 s59, s59, 128
    s_add_u32 s60, s60, s63
    s_add_u32 s61, s61, s64
    s_add_u32 m0, s72, 32768
    s_add_u32 s74, s59, 14336
    buffer_load_dwordx4 v2, s[48:51], s59 offen lds
    buffer_load_dwordx4 v3, s[48:51], s59 offen offset:1024 lds
    buffer_load_dwordx4 v2, s[48:51], s74 offen offset:2048 lds
    buffer_load_dwordx4 v3, s[48:51], s74 offen offset:3072 lds
    s_add_u32 m0, s73, 49152
    s_add_u32 s74, s60, s68
    buffer_load_dwordx4 v10, s[52:55], s60 offen lds
    buffer_load_dwordx4 v10, s[52:55], s74 offen offset:1024 lds
    s_add_u32 m0, s73, 57344
    s_add_u32 s74, s61, s69
    buffer_load_dwordx4 v11, s[76:79], s61 offen lds
    buffer_load_dwordx4 v11, s[76:79], s74 offen offset:1024 lds
    s_add_u32 s59, s59, 128
    s_add_u32 s60, s60, s63
    s_add_u32 s61, s61, s64
    s_mov_b32 s28, s24
    s_and_b32 s29, s25, 0xffff
    s_mov_b32 s30, 16777216
    s_mov_b32 s31, 0x00020000
    s_waitcnt vmcnt(8)
    s_barrier
    s_add_u32 m0, s72, 65536
    s_add_u32 s74, s59, 14336
    buffer_load_dwordx4 v2, s[48:51], s59 offen lds
    buffer_load_dwordx4 v3, s[48:51], s59 offen offset:1024 lds
    buffer_load_dwordx4 v2, s[48:51], s74 offen offset:2048 lds
    buffer_load_dwordx4 v3, s[48:51], s74 offen offset:3072 lds
    s_add_u32 m0, s73, 81920
    s_add_u32 s74, s60, s68
    buffer_load_dwordx4 v10, s[52:55], s60 offen lds
    buffer_load_dwordx4 v10, s[52:55], s74 offen offset:1024 lds
    s_add_u32 m0, s73, 90112
    s_add_u32 s74, s61, s69
    buffer_load_dwordx4 v11, s[76:79], s61 offen lds
    buffer_load_dwordx4 v11, s[76:79], s74 offen offset:1024 lds
    s_add_u32 s59, s59, 128
    s_add_u32 s60, s60, s63
    s_add_u32 s61, s61, s64
    s_waitcnt vmcnt(8)
    s_barrier
    s_add_u32 m0, s72, 98304
    s_add_u32 s74, s59, 14336
    buffer_load_dwordx4 v2, s[48:51], s59 offen lds
    buffer_load_dwordx4 v3, s[48:51], s59 offen offset:1024 lds
    buffer_load_dwordx4 v2, s[48:51], s74 offen offset:2048 lds
    buffer_load_dwordx4 v3, s[48:51], s74 offen offset:3072 lds
    s_add_u32 m0, s73, 114688
    s_add_u32 s74, s60, s68
    buffer_load_dwordx4 v10, s[52:55], s60 offen lds
    buffer_load_dwordx4 v10, s[52:55], s74 offen offset:1024 lds
    s_add_u32 m0, s73, 122880
    s_add_u32 s74, s61, s69
    buffer_load_dwordx4 v11, s[76:79], s61 offen lds
    buffer_load_dwordx4 v11, s[76:79], s74 offen offset:1024 lds
    s_add_u32 s59, s59, 128
    s_add_u32 s60, s60, s63
    s_add_u32 s61, s61, s64
    s_waitcnt vmcnt(8)
    s_barrier
    s_add_u32 m0, s72, 131072
    s_add_u32 s74, s59, 14336
    buffer_load_dwordx4 v2, s[48:51], s59 offen lds
    buffer_load_dwordx4 v3, s[48:51], s59 offen offset:1024 lds
    buffer_load_dwordx4 v2, s[48:51], s74 offen offset:2048 lds
    buffer_load_dwordx4 v3, s[48:51], s74 offen offset:3072 lds
    s_add_u32 m0, s73, 147456
    s_add_u32 s74, s60, s68
    buffer_load_dwordx4 v10, s[52:55], s60 offen lds
    buffer_load_dwordx4 v10, s[52:55], s74 offen offset:1024 lds
    s_add_u32 m0, s73, 155648
    s_add_u32 s74, s61, s69
    buffer_load_dwordx4 v11, s[76:79], s61 offen lds
    buffer_load_dwordx4 v11, s[76:79], s74 offen offset:1024 lds
    s_add_u32 s59, s59, 128
    s_add_u32 s60, s60, s63
    s_add_u32 s61, s61, s64
    s_waitcnt vmcnt(8)
    s_barrier
    s_add_u32 m0, s72, 0
    s_add_u32 s74, s59, 14336
    buffer_load_dwordx4 v2, s[48:51], s59 offen lds
    buffer_load_dwordx4 v3, s[48:51], s59 offen offset:1024 lds
    buffer_load_dwordx4 v2, s[48:51], s74 offen offset:2048 lds
    buffer_load_dwordx4 v3, s[48:51], s74 offen offset:3072 lds
    s_add_u32 m0, s73, 16384
    s_add_u32 s74, s60, s68
    buffer_load_dwordx4 v10, s[52:55], s60 offen lds
    buffer_load_dwordx4 v10, s[52:55], s74 offen offset:1024 lds
    s_add_u32 m0, s73, 24576
    s_add_u32 s74, s61, s69
    buffer_load_dwordx4 v11, s[76:79], s61 offen lds
    buffer_load_dwordx4 v11, s[76:79], s74 offen offset:1024 lds
    s_add_u32 s59, s59, 128
    s_add_u32 s60, s60, s63
    s_add_u32 s61, s61, s64
    s_waitcnt vmcnt(8)
    s_barrier
    s_add_u32 m0, s72, 32768
    s_add_u32 s74, s59, 14336
    buffer_load_dwordx4 v2, s[48:51], s59 offen lds
    buffer_load_dwordx4 v3, s[48:51], s59 offen offset:1024 lds
    buffer_load_dwordx4 v2, s[48:51], s74 offen offset:2048 lds
    buffer_load_dwordx4 v3, s[48:51], s74 offen offset:3072 lds
    s_add_u32 m0, s73, 49152
    s_add_u32 s74, s60, s68
    buffer_load_dwordx4 v10, s[52:55], s60 offen lds
    buffer_load_dwordx4 v10, s[52:55], s74 offen offset:1024 lds
    s_add_u32 m0, s73, 57344
    s_add_u32 s74, s61, s69
    buffer_load_dwordx4 v11, s[76:79], s61 offen lds
    buffer_load_dwordx4 v11, s[76:79], s74 offen offset:1024 lds
    s_add_u32 s59, s59, 128
    s_add_u32 s60, s60, s63
    s_add_u32 s61, s61, s64
    s_waitcnt vmcnt(8)
    s_barrier
    s_add_u32 m0, s72, 65536
    s_add_u32 s74, s59, 14336
    buffer_load_dwordx4 v2, s[48:51], s59 offen lds
    buffer_load_dwordx4 v3, s[48:51], s59 offen offset:1024 lds
    buffer_load_dwordx4 v2, s[48:51], s74 offen offset:2048 lds
    buffer_load_dwordx4 v3, s[48:51], s74 offen offset:3072 lds
    s_add_u32 m0, s73, 81920
    s_add_u32 s74, s60, s68
    buffer_load_dwordx4 v10, s[52:55], s60 offen lds
    buffer_load_dwordx4 v10, s[52:55], s74 offen offset:1024 lds
    s_add_u32 m0, s73, 90112
    s_add_u32 s74, s61, s69
    buffer_load_dwordx4 v11, s[76:79], s61 offen lds
    buffer_load_dwordx4 v11, s[76:79], s74 offen offset:1024 lds
    s_add_u32 s59, s59, 128
    s_add_u32 s60, s60, s63
    s_add_u32 s61, s61, s64
    s_mov_b64 exec, s[66:67]
    s_add_u32 m0, s73, 98304
    s_add_u32 s74, s62, s70
    buffer_load_dwordx4 v12, s[80:83], s62 offen lds
    buffer_load_dwordx4 v12, s[80:83], s74 offen offset:1024 lds
    s_add_u32 s62, s62, s65
    s_add_u32 m0, s73, 106496
    s_add_u32 s74, s62, s70
    buffer_load_dwordx4 v12, s[80:83], s62 offen lds
    buffer_load_dwordx4 v12, s[80:83], s74 offen offset:1024 lds
    s_add_u32 s62, s62, s65
    s_add_u32 m0, s73, 114688
    s_add_u32 s74, s62, s70
    buffer_load_dwordx4 v12, s[80:83], s62 offen lds
    buffer_load_dwordx4 v12, s[80:83], s74 offen offset:1024 lds
    s_add_u32 s62, s62, s65
    s_add_u32 m0, s73, 122880
    s_add_u32 s74, s62, s70
    buffer_load_dwordx4 v12, s[80:83], s62 offen lds
    buffer_load_dwordx4 v12, s[80:83], s74 offen offset:1024 lds
    s_add_u32 s62, s62, s65
    s_mov_b64 exec, -1
    s_waitcnt vmcnt(16)
    s_barrier
    s_mov_b64 exec, s[66:67]
    s_add_u32 m0, s73, 131072
    s_add_u32 s74, s62, s70
    buffer_load_dwordx4 v12, s[80:83], s62 offen lds
    buffer_load_dwordx4 v12, s[80:83], s74 offen offset:1024 lds
    s_add_u32 s62, s62, s65
    s_add_u32 m0, s73, 139264
    s_add_u32 s74, s62, s70
    buffer_load_dwordx4 v12, s[80:83], s62 offen lds
    buffer_load_dwordx4 v12, s[80:83], s74 offen offset:1024 lds
    s_add_u32 s62, s62, s65
    s_add_u32 m0, s73, 147456
    s_add_u32 s74, s62, s70
    buffer_load_dwordx4 v12, s[80:83], s62 offen lds
    buffer_load_dwordx4 v12, s[80:83], s74 offen offset:1024 lds
    s_add_u32 s62, s62, s65
    s_add_u32 m0, s73, 155648
    s_add_u32 s74, s62, s70
    buffer_load_dwordx4 v12, s[80:83], s62 offen lds
    buffer_load_dwordx4 v12, s[80:83], s74 offen offset:1024 lds
    s_add_u32 s62, s62, s65
    s_mov_b64 exec, -1
    s_waitcnt vmcnt(16)
    s_barrier
    s_mov_b32 s40, s16
    s_and_b32 s41, s17, 0xffff
    s_mov_b32 s42, 1409024
    s_mov_b32 s43, 0x00020000
    v_and_b32 v10, 15, v1
    v_lshrrev_b32 v10, 2, v10
    v_lshrrev_b32 v11, 5, v1
    v_lshl_add_u32 v10, v11, 2, v10
    v_mul_u32_u24 v250, 1024, v10
    v_bfe_u32 v11, v1, 4, 1
    v_lshl_add_u32 v250, v11, 6, v250
    v_and_b32 v11, 3, v1
    v_lshl_add_u32 v250, v11, 4, v250
    s_lshl_b32 s62, s33, 7
    v_add_u32 v250, s62, v250
    v_add_u32 v251, 7168, v250
    s_lshl_b32 s48, s47, 11
    s_add_u32 s48, s48, 40960
    s_lshl_b32 s60, s47, 14
    s_add_u32 s61, s60, 1441792
    s_and_b32 s62, s32, 3
    s_mul_i32 s62, s62, 5
    s_cmp_eq_u32 s33, 3
    s_cselect_b32 s62, s62, 0
    s_mul_i32 s49, s27, 0
    s_add_u32 s49, s49, s62
    s_sub_u32 s62, s49, 22
    s_cmp_ge_u32 s49, 22
    s_cselect_b32 s49, s62, s49
    s_lshl_b32 s49, s49, 16
    s_add_u32 s49, s49, s60
    s_waitcnt vmcnt(0)
    s_cmp_eq_u32 s46, 0
    s_cbranch_scc1 L_NG_1
    ds_write_b16 v28, v20 offset:0
    ds_write_b16 v28, v21 offset:8192
    ds_write_b16 v28, v22 offset:16384
    ds_write_b16 v28, v23 offset:24576
    ds_write_b16 v28, v24 offset:32768
    ds_write_b16 v28, v25 offset:40960
    ds_write_b16 v28, v26 offset:49152
    ds_write_b16 v28, v27 offset:57344
    s_waitcnt lgkmcnt(0)
L_NG_1:
    s_barrier
    s_mov_b32 m0, s48
    s_mov_b32 s62, 0
L_TRING:
    buffer_load_dwordx4 v250, s[40:43], s49 offen lds
    buffer_load_dwordx4 v251, s[40:43], s49 offen offset:1024 lds
    s_add_u32 m0, m0, 8192
    s_add_u32 s49, s49, 65536
    s_cmp_ge_u32 s49, s61
    s_cselect_b32 s49, s60, s49
    s_add_u32 s62, s62, 1
    s_cmp_lt_u32 s62, 7
    s_cbranch_scc1 L_TRING
    s_add_u32 s48, s48, 57344
    s_waitcnt lgkmcnt(0)
    v_mov_b32 v60, 0x3f803f80
    v_mov_b32 v61, 0x3f803f80
    v_mov_b32 v62, 0x3f803f80
    v_mov_b32 v63, 0x3f803f80
    v_mov_b32 v68, 0x3f803f80
    v_mov_b32 v69, 0x3f803f80
    v_mov_b32 v70, 0x3f803f80
    v_mov_b32 v71, 0x3f803f80
    v_mov_b32 v76, 0x3f803f80
    v_mov_b32 v77, 0x3f803f80
    v_mov_b32 v78, 0x3f803f80
    v_mov_b32 v79, 0x3f803f80
    v_mov_b32 v84, 0x3f803f80
    v_mov_b32 v85, 0x3f803f80
    v_mov_b32 v86, 0x3f803f80
    v_mov_b32 v87, 0x3f803f80
    v_mov_b32 v92, 0x3f803f80
    v_mov_b32 v93, 0x3f803f80
    v_mov_b32 v94, 0x3f803f80
    v_mov_b32 v95, 0x3f803f80
    v_mov_b32 v100, 0x3f803f80
    v_mov_b32 v101, 0x3f803f80
    v_mov_b32 v102, 0x3f803f80
    v_mov_b32 v103, 0x3f803f80
    v_mov_b32 v108, 0x3f803f80
    v_mov_b32 v109, 0x3f803f80
    v_mov_b32 v110, 0x3f803f80
    v_mov_b32 v111, 0x3f803f80
    v_mov_b32 v116, 0x3f803f80
    v_mov_b32 v117, 0x3f803f80
    v_mov_b32 v118, 0x3f803f80
    v_mov_b32 v119, 0x3f803f80
    v_mov_b32 v124, 0x3f803f80
    v_mov_b32 v125, 0x3f803f80
    v_mov_b32 v126, 0x3f803f80
    v_mov_b32 v127, 0x3f803f80
    v_mov_b32 v132, 0x3f803f80
    v_mov_b32 v133, 0x3f803f80
    v_mov_b32 v134, 0x3f803f80
    v_mov_b32 v135, 0x3f803f80
    v_lshrrev_b32 v9, 5, v1
    v_and_b32 v8, 31, v1
    v_lshlrev_b32 v4, 2, v9
    v_sub_u32 v4, v8, v4
    v_cmp_le_i32 s[64:65], 0, v4
    v_cmp_le_i32 s[66:67], 1, v4
    v_cmp_le_i32 s[68:69], 2, v4
    v_cmp_le_i32 s[70:71], 3, v4
    v_cmp_le_i32 s[72:73], 8, v4
    v_cmp_le_i32 s[74:75], 9, v4
    v_cmp_le_i32 s[76:77], 10, v4
    v_cmp_le_i32 s[78:79], 11, v4
    v_cmp_le_i32 s[80:81], 16, v4
    v_cmp_le_i32 s[82:83], 17, v4
    v_cmp_le_i32 s[84:85], 18, v4
    v_cmp_le_i32 s[86:87], 19, v4
    v_cmp_le_i32 s[88:89], 24, v4
    v_cmp_le_i32 s[90:91], 25, v4
    v_cmp_le_i32 s[92:93], 26, v4
    v_cmp_le_i32 s[94:95], 27, v4
    s_nop 1
    s_and_b32 s32, s35, 28
    s_add_u32 s32, s32, s47
    s_mov_b32 s33, s27
    v_mov_b32 v5, 0xffff
    v_mov_b32 v6, 0xffff0000
    v_cndmask_b32 v10, 0, v5, s[64:65]
    v_cndmask_b32 v11, 0, v6, s[66:67]
    v_or_b32 v240, v10, v11
    v_cndmask_b32 v10, 0, v5, s[68:69]
    v_cndmask_b32 v11, 0, v6, s[70:71]
    v_or_b32 v241, v10, v11
    v_cndmask_b32 v10, 0, v5, s[72:73]
    v_cndmask_b32 v11, 0, v6, s[74:75]
    v_or_b32 v242, v10, v11
    v_cndmask_b32 v10, 0, v5, s[76:77]
    v_cndmask_b32 v11, 0, v6, s[78:79]
    v_or_b32 v243, v10, v11
    v_cndmask_b32 v10, 0, v5, s[80:81]
    v_cndmask_b32 v11, 0, v6, s[82:83]
    v_or_b32 v244, v10, v11
    v_cndmask_b32 v10, 0, v5, s[84:85]
    v_cndmask_b32 v11, 0, v6, s[86:87]
    v_or_b32 v245, v10, v11
    v_cndmask_b32 v10, 0, v5, s[88:89]
    v_cndmask_b32 v11, 0, v6, s[90:91]
    v_or_b32 v246, v10, v11
    v_cndmask_b32 v10, 0, v5, s[92:93]
    v_cndmask_b32 v11, 0, v6, s[94:95]
    v_or_b32 v247, v10, v11
    s_lshl_b32 s36, s33, 2
    s_and_b32 s34, s35, 3
    s_add_u32 s36, s36, s34
    s_lshl_b32 s37, s32, 1
    s_sub_i32 s38, 8, s37
    s_lshl_b32 s39, s36, 16
    s_and_b32 s63, s35, 28
    s_lshl_b32 s63, s63, 1
    s_lshl_b32 s62, s47, 2
    s_add_u32 s56, s63, s62
    s_add_i32 s62, s56, -8
    s_max_i32 s62, s62, 0
    s_lshl_b32 s62, s62, 10
    s_add_u32 s50, s62, s39
    s_add_i32 s62, s56, -7
    s_max_i32 s62, s62, 0
    s_lshl_b32 s62, s62, 10
    s_add_u32 s51, s62, s39
    s_add_i32 s62, s56, -6
    s_max_i32 s62, s62, 0
    s_lshl_b32 s62, s62, 10
    s_add_u32 s52, s62, s39
    s_add_i32 s62, s56, -5
    s_max_i32 s62, s62, 0
    s_lshl_b32 s62, s62, 10
    s_add_u32 s53, s62, s39
    s_lshl_b32 s58, s37, 10
    s_add_u32 s58, s58, s39
    v_lshlrev_b32 v2, 4, v1
    v_mov_b32 v7, 0
    s_lshl_b32 s62, s47, 13
    s_add_u32 s62, s62, 8192
    v_add_u32 v248, s62, v2
    s_lshl_b32 s62, s47, 12
    s_add_u32 s62, s62, 8192
    v_add_u32 v249, s62, v2
    v_and_b32 v10, 15, v1
    s_sub_i32 s62, s63, 8
    v_add_u32 v10, s62, v10
    v_max_i32 v10, 0, v10
    v_bfe_u32 v11, v1, 4, 1
    v_lshl_add_u32 v10, v11, 9, v10
    v_lshlrev_b32 v3, 6, v10
    s_setprio 2
    s_mov_b32 s40, s22
    s_and_b32 s41, s23, 0xffff
    s_mov_b32 s42, 256
    s_mov_b32 s43, 0x00020000
    s_lshl_b32 s62, s47, 4
    s_add_u32 s62, s62, 128
    v_mov_b32 v10, s62
    ds_read_b64 v[252:253], v10
    ds_read_b32 v11, v10 offset:8
    s_waitcnt lgkmcnt(0)
    v_readfirstlane_b32 s97, v11
    v_cmp_eq_u64 vcc, 0, v[252:253]
    s_cbranch_vccz L_TN
    s_mov_b32 s96, 0
L_PN2:
    buffer_load_dwordx2 v[252:253], v7, s[40:43], 0 offen sc1
    s_add_u32 s96, s96, 1
    s_waitcnt vmcnt(0)
    v_cmp_eq_u64 vcc, 0, v[252:253]
    s_cmp_ge_u32 s96, 200000
    s_cbranch_scc1 L_PN2_X
    s_cbranch_vccz L_PN2_X
    s_sleep 1
    s_branch L_PN2
L_PN2_X:
L_TN:
    s_lshl_b32 s62, s47, 3
    s_add_u32 s62, s62, 0
    v_mov_b32 v10, s62
    s_waitcnt vmcnt(0)
    ds_write_b64 v10, v[252:253]
    s_lshl_b32 s62, s33, 12
    s_add_u32 s62, s62, 14811136
    v_mov_b32 v10, 192
    s_cmp_lg_u32 s47, 0
    s_cbranch_scc1 L_PQW
    s_mov_b32 s96, 0
    s_mov_b32 exec_lo, -1
    s_mov_b32 exec_hi, 0
L_PQ:
    buffer_load_dwordx2 v[12:13], v3, s[28:31], s62 offen sc1
    s_add_u32 s96, s96, 1
    s_waitcnt vmcnt(0)
    v_cmp_ne_u64 vcc, v[12:13], v[252:253]
    s_cmp_ge_u32 s96, 200000
    s_cbranch_scc1 L_PQ_X
    s_cbranch_vccz L_PQ_X
    s_sleep 2
    s_branch L_PQ
L_PQ_X:
    s_mov_b64 exec, -1
    ds_write_b64 v10, v[252:253]
    s_branch L_PQD
L_PQW:
    s_mov_b32 s96, 0
L_PQL:
    ds_read_b64 v[12:13], v10
    s_add_u32 s96, s96, 1
    s_waitcnt lgkmcnt(0)
    v_cmp_ne_u64 vcc, v[12:13], v[252:253]
    s_cmp_ge_u32 s96, 800000
    s_cbranch_scc1 L_PQL_X
    s_cbranch_vccz L_PQL_X
    s_sleep 1
    s_branch L_PQL
L_PQL_X:
    s_mov_b64 exec, -1
L_PQD:
    s_add_u32 s62, s50, 2097152
    s_add_u32 s63, s50, 4194304
    buffer_load_dwordx4 v[144:147], v2, s[28:31], s62 offen sc1
    buffer_load_dwordx4 v[148:151], v2, s[28:31], s63 offen sc1
    s_add_u32 s62, s51, 2097152
    s_add_u32 s63, s51, 4194304
    buffer_load_dwordx4 v[152:155], v2, s[28:31], s62 offen sc1
    buffer_load_dwordx4 v[156:159], v2, s[28:31], s63 offen sc1
    s_add_u32 s62, s52, 2097152
    s_add_u32 s63, s52, 4194304
    buffer_load_dwordx4 v[160:163], v2, s[28:31], s62 offen sc1
    buffer_load_dwordx4 v[164:167], v2, s[28:31], s63 offen sc1
    s_add_u32 s62, s53, 2097152
    s_add_u32 s63, s53, 4194304
    buffer_load_dwordx4 v[168:171], v2, s[28:31], s62 offen sc1
    buffer_load_dwordx4 v[172:175], v2, s[28:31], s63 offen sc1
    buffer_load_dwordx4 v[136:139], v2, s[28:31], s58 offen sc1
    buffer_load_dwordx4 v[140:143], v2, s[28:31], s58 offen offset:1024 sc1
    s_lshl_b32 s62, s47, 3
    s_add_u32 s62, s62, 32
    v_mov_b32 v11, s62
    v_lshlrev_b32 v10, 3, v1
    s_waitcnt vmcnt(9)
    ds_write_b128 v248, v[144:147] offset:0
    s_waitcnt vmcnt(8)
    ds_write_b128 v248, v[148:151] offset:1024
    s_waitcnt vmcnt(7)
    ds_write_b128 v248, v[152:155] offset:2048
    s_waitcnt vmcnt(6)
    ds_write_b128 v248, v[156:159] offset:3072
    s_waitcnt vmcnt(5)
    ds_write_b128 v248, v[160:163] offset:4096
    s_waitcnt vmcnt(4)
    ds_write_b128 v248, v[164:167] offset:5120
    s_waitcnt vmcnt(3)
    ds_write_b128 v248, v[168:171] offset:6144
    s_waitcnt vmcnt(2)
    ds_write_b128 v248, v[172:175] offset:7168
    s_waitcnt lgkmcnt(0)
    ds_write_b64 v11, v[252:253]
    s_mov_b32 s96, 0
    s_mov_b64 exec, 0xf0
L_WKV:
    ds_read_b64 v[12:13], v10
    s_add_u32 s96, s96, 1
    s_waitcnt lgkmcnt(0)
    v_cmp_ne_u64 vcc, v[12:13], v[252:253]
    s_cmp_ge_u32 s96, 800000
    s_cbranch_scc1 L_WKV_X
    s_cbranch_vccz L_WKV_X
    s_sleep 1
    s_branch L_WKV
L_WKV_X:
    s_mov_b64 exec, -1
    ds_read_b128 v[20:23], v249 offset:2048
    ds_read_b128 v[64:67], v249 offset:3072
    ds_read_b128 v[24:27], v249 offset:4096
    ds_read_b128 v[72:75], v249 offset:5120
    ds_read_b128 v[28:31], v249 offset:6144
    ds_read_b128 v[80:83], v249 offset:7168
    ds_read_b128 v[32:35], v249 offset:8192
    ds_read_b128 v[88:91], v249 offset:9216
    ds_read_b128 v[36:39], v249 offset:10240
    ds_read_b128 v[96:99], v249 offset:11264
    ds_read_b128 v[40:43], v249 offset:12288
    ds_read_b128 v[104:107], v249 offset:13312
    s_waitcnt lgkmcnt(4)
    ds_read_b128 v[44:47], v249 offset:14336
    ds_read_b128 v[112:115], v249 offset:15360
    ds_read_b128 v[48:51], v249 offset:16384
    ds_read_b128 v[120:123], v249 offset:17408
    ds_read_b128 v[16:19], v249 offset:0
    ds_read_b128 v[56:59], v249 offset:1024
    ds_read_b128 v[52:55], v249 offset:18432
    ds_read_b128 v[128:131], v249 offset:19456
    s_waitcnt vmcnt(0) lgkmcnt(0)
    s_setprio 2
    v_mov_b32 v6, 0x4e800000
    v_mov_b32 v3, 0x7b800000
    s_cmp_lt_u32 s32, 4
    s_cbranch_scc1 L_ATT_SLOW
    v_mfma_f32_32x32x16_bf16 v[144:159], v[20:23], v[136:139], 0
    v_mfma_f32_32x32x16_bf16 v[160:175], v[24:27], v[136:139], 0
    s_nop 10
    v_exp_f32 v144, v144
    v_exp_f32 v145, v145
    v_exp_f32 v146, v146
    v_exp_f32 v147, v147
    v_exp_f32 v148, v148
    v_exp_f32 v149, v149
    v_exp_f32 v150, v150
    v_exp_f32 v151, v151
    v_exp_f32 v152, v152
    v_exp_f32 v153, v153
    v_exp_f32 v154, v154
    v_exp_f32 v155, v155
    v_exp_f32 v156, v156
    v_exp_f32 v157, v157
    v_exp_f32 v158, v158
    v_exp_f32 v159, v159
    v_permlane16_swap_b32 v64, v68
    v_permlane16_swap_b32 v65, v69
    v_permlane16_swap_b32 v66, v70
    v_permlane16_swap_b32 v67, v71
    v_cvt_pk_bf16_f32 v224, v144, v145
    v_cvt_pk_bf16_f32 v225, v146, v147
    v_cvt_pk_bf16_f32 v226, v148, v149
    v_cvt_pk_bf16_f32 v227, v150, v151
    v_cvt_pk_bf16_f32 v228, v152, v153
    v_cvt_pk_bf16_f32 v229, v154, v155
    v_cvt_pk_bf16_f32 v230, v156, v157
    v_cvt_pk_bf16_f32 v231, v158, v159
    v_exp_f32 v160, v160
    v_exp_f32 v161, v161
    v_mfma_f32_32x32x16_bf16 v[144:159], v[28:31], v[136:139], 0
    v_exp_f32 v162, v162
    v_exp_f32 v163, v163
    v_exp_f32 v164, v164
    v_exp_f32 v165, v165
    v_mfma_f32_32x32x16_bf16 v[208:223], v[64:67], v[224:227], 0
    v_exp_f32 v166, v166
    v_exp_f32 v167, v167
    v_exp_f32 v168, v168
    v_exp_f32 v169, v169
    v_mfma_f32_32x32x16_bf16 v[208:223], v[68:71], v[228:231], v[208:223]
    v_exp_f32 v170, v170
    v_exp_f32 v171, v171
    v_exp_f32 v172, v172
    v_exp_f32 v173, v173
    v_exp_f32 v174, v174
    v_exp_f32 v175, v175
    v_permlane16_swap_b32 v72, v76
    v_permlane16_swap_b32 v73, v77
    v_permlane16_swap_b32 v74, v78
    v_permlane16_swap_b32 v75, v79
    v_cvt_pk_bf16_f32 v232, v160, v161
    v_cvt_pk_bf16_f32 v233, v162, v163
    v_cvt_pk_bf16_f32 v234, v164, v165
    v_cvt_pk_bf16_f32 v235, v166, v167
    v_cvt_pk_bf16_f32 v236, v168, v169
    v_cvt_pk_bf16_f32 v237, v170, v171
    v_cvt_pk_bf16_f32 v238, v172, v173
    v_cvt_pk_bf16_f32 v239, v174, v175
    v_exp_f32 v144, v144
    v_exp_f32 v145, v145
    v_mfma_f32_32x32x16_bf16 v[160:175], v[32:35], v[136:139], 0
    v_exp_f32 v146, v146
    v_exp_f32 v147, v147
    v_exp_f32 v148, v148
    v_exp_f32 v149, v149
    v_mfma_f32_32x32x16_bf16 v[208:223], v[72:75], v[232:235], v[208:223]
    v_exp_f32 v150, v150
    v_exp_f32 v151, v151
    v_exp_f32 v152, v152
    v_exp_f32 v153, v153
    v_mfma_f32_32x32x16_bf16 v[208:223], v[76:79], v[236:239], v[208:223]
    v_exp_f32 v154, v154
    v_exp_f32 v155, v155
    v_exp_f32 v156, v156
    v_exp_f32 v157, v157
    v_exp_f32 v158, v158
    v_exp_f32 v159, v159
    v_permlane16_swap_b32 v80, v84
    v_permlane16_swap_b32 v81, v85
    v_permlane16_swap_b32 v82, v86
    v_permlane16_swap_b32 v83, v87
    v_cvt_pk_bf16_f32 v224, v144, v145
    v_cvt_pk_bf16_f32 v225, v146, v147
    v_cvt_pk_bf16_f32 v226, v148, v149
    v_cvt_pk_bf16_f32 v227, v150, v151
    v_cvt_pk_bf16_f32 v228, v152, v153
    v_cvt_pk_bf16_f32 v229, v154, v155
    v_cvt_pk_bf16_f32 v230, v156, v157
    v_cvt_pk_bf16_f32 v231, v158, v159
    v_exp_f32 v160, v160
    v_exp_f32 v161, v161
    v_mfma_f32_32x32x16_bf16 v[144:159], v[36:39], v[136:139], 0
    v_exp_f32 v162, v162
    v_exp_f32 v163, v163
    v_exp_f32 v164, v164
    v_exp_f32 v165, v165
    v_mfma_f32_32x32x16_bf16 v[208:223], v[80:83], v[224:227], v[208:223]
    v_exp_f32 v166, v166
    v_exp_f32 v167, v167
    v_exp_f32 v168, v168
    v_exp_f32 v169, v169
    v_mfma_f32_32x32x16_bf16 v[208:223], v[84:87], v[228:231], v[208:223]
    v_exp_f32 v170, v170
    v_exp_f32 v171, v171
    v_exp_f32 v172, v172
    v_exp_f32 v173, v173
    v_exp_f32 v174, v174
    v_exp_f32 v175, v175
    v_permlane16_swap_b32 v88, v92
    v_permlane16_swap_b32 v89, v93
    v_permlane16_swap_b32 v90, v94
    v_permlane16_swap_b32 v91, v95
    v_cvt_pk_bf16_f32 v232, v160, v161
    v_cvt_pk_bf16_f32 v233, v162, v163
    v_cvt_pk_bf16_f32 v234, v164, v165
    v_cvt_pk_bf16_f32 v235, v166, v167
    v_cvt_pk_bf16_f32 v236, v168, v169
    v_cvt_pk_bf16_f32 v237, v170, v171
    v_cvt_pk_bf16_f32 v238, v172, v173
    v_cvt_pk_bf16_f32 v239, v174, v175
    v_exp_f32 v144, v144
    v_exp_f32 v145, v145
    v_mfma_f32_32x32x16_bf16 v[160:175], v[40:43], v[136:139], 0
    v_exp_f32 v146, v146
    v_exp_f32 v147, v147
    v_exp_f32 v148, v148
    v_exp_f32 v149, v149
    v_mfma_f32_32x32x16_bf16 v[208:223], v[88:91], v[232:235], v[208:223]
    v_exp_f32 v150, v150
    v_exp_f32 v151, v151
    v_exp_f32 v152, v152
    v_exp_f32 v153, v153
    v_mfma_f32_32x32x16_bf16 v[208:223], v[92:95], v[236:239], v[208:223]
    v_exp_f32 v154, v154
    v_exp_f32 v155, v155
    v_exp_f32 v156, v156
    v_exp_f32 v157, v157
    v_mfma_f32_32x32x16_bf16 v[176:191], v[48:51], v[136:139], 0
    v_exp_f32 v158, v158
    v_exp_f32 v159, v159
    v_permlane16_swap_b32 v96, v100
    v_permlane16_swap_b32 v97, v101
    v_permlane16_swap_b32 v98, v102
    v_permlane16_swap_b32 v99, v103
    v_cvt_pk_bf16_f32 v224, v144, v145
    v_cvt_pk_bf16_f32 v225, v146, v147
    v_cvt_pk_bf16_f32 v226, v148, v149
    v_cvt_pk_bf16_f32 v227, v150, v151
    v_cvt_pk_bf16_f32 v228, v152, v153
    v_cvt_pk_bf16_f32 v229, v154, v155
    v_cvt_pk_bf16_f32 v230, v156, v157
    v_cvt_pk_bf16_f32 v231, v158, v159
    v_exp_f32 v160, v160
    v_exp_f32 v161, v161
    v_mfma_f32_32x32x16_bf16 v[144:159], v[44:47], v[136:139], 0
    v_exp_f32 v162, v162
    v_exp_f32 v163, v163
    v_exp_f32 v164, v164
    v_exp_f32 v165, v165
    v_mfma_f32_32x32x16_bf16 v[208:223], v[96:99], v[224:227], v[208:223]
    v_exp_f32 v166, v166
    v_exp_f32 v167, v167
    v_exp_f32 v168, v168
    v_exp_f32 v169, v169
    v_mfma_f32_32x32x16_bf16 v[208:223], v[100:103], v[228:231], v[208:223]
    v_exp_f32 v170, v170
    v_exp_f32 v171, v171
    v_exp_f32 v172, v172
    v_exp_f32 v173, v173
    v_mfma_f32_32x32x16_bf16 v[192:207], v[16:19], v[136:139], 0
    v_exp_f32 v174, v174
    v_exp_f32 v175, v175
    v_permlane16_swap_b32 v104, v108
    v_permlane16_swap_b32 v105, v109
    v_permlane16_swap_b32 v106, v110
    v_permlane16_swap_b32 v107, v111
    v_cvt_pk_bf16_f32 v232, v160, v161
    v_cvt_pk_bf16_f32 v233, v162, v163
    v_cvt_pk_bf16_f32 v234, v164, v165
    v_cvt_pk_bf16_f32 v235, v166, v167
    v_cvt_pk_bf16_f32 v236, v168, v169
    v_cvt_pk_bf16_f32 v237, v170, v171
    v_cvt_pk_bf16_f32 v238, v172, v173
    v_cvt_pk_bf16_f32 v239, v174, v175
    v_exp_f32 v144, v144
    v_exp_f32 v145, v145
    v_exp_f32 v146, v146
    v_exp_f32 v147, v147
    v_exp_f32 v148, v148
    v_exp_f32 v149, v149
    v_mfma_f32_32x32x16_bf16 v[208:223], v[104:107], v[232:235], v[208:223]
    v_exp_f32 v150, v150
    v_exp_f32 v151, v151
    v_exp_f32 v152, v152
    v_exp_f32 v153, v153
    v_mfma_f32_32x32x16_bf16 v[208:223], v[108:111], v[236:239], v[208:223]
    v_exp_f32 v154, v154
    v_exp_f32 v155, v155
    v_exp_f32 v156, v156
    v_exp_f32 v157, v157
    v_exp_f32 v158, v158
    v_exp_f32 v159, v159
    v_permlane16_swap_b32 v112, v116
    v_permlane16_swap_b32 v113, v117
    v_permlane16_swap_b32 v114, v118
    v_permlane16_swap_b32 v115, v119
    v_cvt_pk_bf16_f32 v224, v144, v145
    v_cvt_pk_bf16_f32 v225, v146, v147
    v_cvt_pk_bf16_f32 v226, v148, v149
    v_cvt_pk_bf16_f32 v227, v150, v151
    v_cvt_pk_bf16_f32 v228, v152, v153
    v_cvt_pk_bf16_f32 v229, v154, v155
    v_cvt_pk_bf16_f32 v230, v156, v157
    v_cvt_pk_bf16_f32 v231, v158, v159
    v_cndmask_b32 v176, v192, v176, s[64:65]
    v_cndmask_b32 v177, v193, v177, s[66:67]
    v_cndmask_b32 v178, v194, v178, s[68:69]
    v_cndmask_b32 v179, v195, v179, s[70:71]
    v_mfma_f32_32x32x16_bf16 v[208:223], v[112:115], v[224:227], v[208:223]
    v_cndmask_b32 v180, v196, v180, s[72:73]
    v_cndmask_b32 v181, v197, v181, s[74:75]
    v_cndmask_b32 v182, v198, v182, s[76:77]
    v_cndmask_b32 v183, v199, v183, s[78:79]
    v_cndmask_b32 v184, v200, v184, s[80:81]
    v_cndmask_b32 v185, v201, v185, s[82:83]
    v_cndmask_b32 v186, v202, v186, s[84:85]
    v_cndmask_b32 v187, v203, v187, s[86:87]
    v_mfma_f32_32x32x16_bf16 v[208:223], v[116:119], v[228:231], v[208:223]
    v_cndmask_b32 v188, v204, v188, s[88:89]
    v_cndmask_b32 v189, v205, v189, s[90:91]
    v_cndmask_b32 v190, v206, v190, s[92:93]
    v_cndmask_b32 v191, v207, v191, s[94:95]
    v_exp_f32 v176, v176
    v_exp_f32 v177, v177
    v_exp_f32 v178, v178
    v_exp_f32 v179, v179
    v_exp_f32 v180, v180
    v_exp_f32 v181, v181
    v_exp_f32 v182, v182
    v_exp_f32 v183, v183
    v_exp_f32 v184, v184
    v_exp_f32 v185, v185
    v_exp_f32 v186, v186
    v_exp_f32 v187, v187
    v_exp_f32 v188, v188
    v_exp_f32 v189, v189
    v_exp_f32 v190, v190
    v_exp_f32 v191, v191
    v_permlane16_swap_b32 v120, v124
    v_permlane16_swap_b32 v121, v125
    v_permlane16_swap_b32 v122, v126
    v_permlane16_swap_b32 v123, v127
    v_permlane16_swap_b32 v56, v60
    v_permlane16_swap_b32 v57, v61
    v_permlane16_swap_b32 v58, v62
    v_permlane16_swap_b32 v59, v63
    v_cvt_pk_bf16_f32 v232, v176, v177
    v_cvt_pk_bf16_f32 v233, v178, v179
    v_cvt_pk_bf16_f32 v234, v180, v181
    v_cvt_pk_bf16_f32 v235, v182, v183
    v_cvt_pk_bf16_f32 v236, v184, v185
    v_cvt_pk_bf16_f32 v237, v186, v187
    v_cvt_pk_bf16_f32 v238, v188, v189
    v_cvt_pk_bf16_f32 v239, v190, v191
    v_and_b32 v176, v232, v240
    v_and_b32 v177, v233, v241
    v_and_b32 v178, v234, v242
    v_and_b32 v179, v235, v243
    v_and_b32 v180, v236, v244
    v_and_b32 v181, v237, v245
    v_and_b32 v182, v238, v246
    v_and_b32 v183, v239, v247
    v_xor_b32 v184, v232, v176
    v_xor_b32 v185, v233, v177
    v_mfma_f32_32x32x16_bf16 v[208:223], v[120:123], v[176:179], v[208:223]
    v_xor_b32 v186, v234, v178
    v_xor_b32 v187, v235, v179
    v_xor_b32 v188, v236, v180
    v_xor_b32 v189, v237, v181
    v_mfma_f32_32x32x16_bf16 v[208:223], v[124:127], v[180:183], v[208:223]
    v_xor_b32 v190, v238, v182
    v_xor_b32 v191, v239, v183
    s_nop 1
    v_mfma_f32_32x32x16_bf16 v[208:223], v[56:59], v[184:187], v[208:223]
    v_mfma_f32_32x32x16_bf16 v[208:223], v[60:63], v[188:191], v[208:223]
    s_nop 15
    v_cmp_lt_f32 vcc, 0x30800000, v216
    v_cmp_gt_f32 s[98:99], v6, v216
    v_max3_f32 v4, |v208|, |v209|, |v210|
    v_max3_f32 v5, |v211|, |v212|, |v213|
    v_max3_f32 v4, v4, |v214|, |v215|
    s_and_b64 vcc, vcc, s[98:99]
    v_max_f32 v4, v4, v5
    v_cmp_gt_f32 s[98:99], v3, v4
    s_nop 1
    s_and_b64 vcc, vcc, s[98:99]
    s_cmp_eq_u64 vcc, -1
    s_cbranch_scc0 L_FB0
    v_rcp_f32 v5, v216
    s_add_u32 s62, s37, 0
    s_mul_i32 s62, s62, 118
    v_mul_f32 v208, v208, v5
    v_mul_f32 v209, v209, v5
    v_mul_f32 v210, v210, v5
    v_mul_f32 v211, v211, v5
    v_mul_f32 v212, v212, v5
    v_mul_f32 v213, v213, v5
    v_mul_f32 v214, v214, v5
    v_mul_f32 v215, v215, v5
    s_add_u32 s62, s62, s36
    s_lshl_b32 s62, s62, 10
    s_add_u32 s62, s62, 6379520
    v_cvt_pk_bf16_f32 v12, v208, v209
    v_cvt_pk_bf16_f32 v13, v210, v211
    v_cvt_pk_bf16_f32 v14, v212, v213
    v_cvt_pk_bf16_f32 v15, v214, v215
    buffer_store_dwordx4 v[12:15], v2, s[28:31], s62 offen sc1
L_ATT_MID:
    s_waitcnt vmcnt(1)
    v_permlane16_swap_b32 v128, v132
    v_permlane16_swap_b32 v129, v133
    v_permlane16_swap_b32 v130, v134
    v_permlane16_swap_b32 v131, v135
    s_cmp_lt_u32 s32, 4
    s_cbranch_scc1 L_ATT_SLOW2
    v_mfma_f32_32x32x16_bf16 v[144:159], v[24:27], v[140:143], 0
    v_mfma_f32_32x32x16_bf16 v[160:175], v[28:31], v[140:143], 0
    s_nop 10
    v_exp_f32 v144, v144
    v_exp_f32 v145, v145
    v_exp_f32 v146, v146
    v_exp_f32 v147, v147
    v_exp_f32 v148, v148
    v_exp_f32 v149, v149
    v_exp_f32 v150, v150
    v_exp_f32 v151, v151
    v_exp_f32 v152, v152
    v_exp_f32 v153, v153
    v_exp_f32 v154, v154
    v_exp_f32 v155, v155
    v_exp_f32 v156, v156
    v_exp_f32 v157, v157
    v_exp_f32 v158, v158
    v_exp_f32 v159, v159
    v_cvt_pk_bf16_f32 v224, v144, v145
    v_cvt_pk_bf16_f32 v225, v146, v147
    v_cvt_pk_bf16_f32 v226, v148, v149
    v_cvt_pk_bf16_f32 v227, v150, v151
    v_cvt_pk_bf16_f32 v228, v152, v153
    v_cvt_pk_bf16_f32 v229, v154, v155
    v_cvt_pk_bf16_f32 v230, v156, v157
    v_cvt_pk_bf16_f32 v231, v158, v159
    v_exp_f32 v160, v160
    v_exp_f32 v161, v161
    v_mfma_f32_32x32x16_bf16 v[144:159], v[32:35], v[140:143], 0
    v_exp_f32 v162, v162
    v_exp_f32 v163, v163
    v_exp_f32 v164, v164
    v_exp_f32 v165, v165
    v_mfma_f32_32x32x16_bf16 v[208:223], v[72:75], v[224:227], 0
    v_exp_f32 v166, v166
    v_exp_f32 v167, v167
    v_exp_f32 v168, v168
    v_exp_f32 v169, v169
    v_mfma_f32_32x32x16_bf16 v[208:223], v[76:79], v[228:231], v[208:223]
    v_exp_f32 v170, v170
    v_exp_f32 v171, v171
    v_exp_f32 v172, v172
    v_exp_f32 v173, v173
    v_exp_f32 v174, v174
    v_exp_f32 v175, v175
    v_cvt_pk_bf16_f32 v232, v160, v161
    v_cvt_pk_bf16_f32 v233, v162, v163
    v_cvt_pk_bf16_f32 v234, v164, v165
    v_cvt_pk_bf16_f32 v235, v166, v167
    v_cvt_pk_bf16_f32 v236, v168, v169
    v_cvt_pk_bf16_f32 v237, v170, v171
    v_cvt_pk_bf16_f32 v238, v172, v173
    v_cvt_pk_bf16_f32 v239, v174, v175
    v_exp_f32 v144, v144
    v_exp_f32 v145, v145
    v_mfma_f32_32x32x16_bf16 v[160:175], v[36:39], v[140:143], 0
    v_exp_f32 v146, v146
    v_exp_f32 v147, v147
    v_exp_f32 v148, v148
    v_exp_f32 v149, v149
    v_mfma_f32_32x32x16_bf16 v[208:223], v[80:83], v[232:235], v[208:223]
    v_exp_f32 v150, v150
    v_exp_f32 v151, v151
    v_exp_f32 v152, v152
    v_exp_f32 v153, v153
    v_mfma_f32_32x32x16_bf16 v[208:223], v[84:87], v[236:239], v[208:223]
    v_exp_f32 v154, v154
    v_exp_f32 v155, v155
    v_exp_f32 v156, v156
    v_exp_f32 v157, v157
    v_exp_f32 v158, v158
    v_exp_f32 v159, v159
    v_cvt_pk_bf16_f32 v224, v144, v145
    v_cvt_pk_bf16_f32 v225, v146, v147
    v_cvt_pk_bf16_f32 v226, v148, v149
    v_cvt_pk_bf16_f32 v227, v150, v151
    v_cvt_pk_bf16_f32 v228, v152, v153
    v_cvt_pk_bf16_f32 v229, v154, v155
    v_cvt_pk_bf16_f32 v230, v156, v157
    v_cvt_pk_bf16_f32 v231, v158, v159
    v_exp_f32 v160, v160
    v_exp_f32 v161, v161
    v_mfma_f32_32x32x16_bf16 v[144:159], v[40:43], v[140:143], 0
    v_exp_f32 v162, v162
    v_exp_f32 v163, v163
    v_exp_f32 v164, v164
    v_exp_f32 v165, v165
    v_mfma_f32_32x32x16_bf16 v[208:223], v[88:91], v[224:227], v[208:223]
    v_exp_f32 v166, v166
    v_exp_f32 v167, v167
    v_exp_f32 v168, v168
    v_exp_f32 v169, v169
    v_mfma_f32_32x32x16_bf16 v[208:223], v[92:95], v[228:231], v[208:223]
    v_exp_f32 v170, v170
    v_exp_f32 v171, v171
    v_exp_f32 v172, v172
    v_exp_f32 v173, v173
    v_exp_f32 v174, v174
    v_exp_f32 v175, v175
    v_cvt_pk_bf16_f32 v232, v160, v161
    v_cvt_pk_bf16_f32 v233, v162, v163
    v_cvt_pk_bf16_f32 v234, v164, v165
    v_cvt_pk_bf16_f32 v235, v166, v167
    v_cvt_pk_bf16_f32 v236, v168, v169
    v_cvt_pk_bf16_f32 v237, v170, v171
    v_cvt_pk_bf16_f32 v238, v172, v173
    v_cvt_pk_bf16_f32 v239, v174, v175
    v_exp_f32 v144, v144
    v_exp_f32 v145, v145
    v_mfma_f32_32x32x16_bf16 v[160:175], v[44:47], v[140:143], 0
    v_exp_f32 v146, v146
    v_exp_f32 v147, v147
    v_exp_f32 v148, v148
    v_exp_f32 v149, v149
    v_mfma_f32_32x32x16_bf16 v[208:223], v[96:99], v[232:235], v[208:223]
    v_exp_f32 v150, v150
    v_exp_f32 v151, v151
    v_exp_f32 v152, v152
    v_exp_f32 v153, v153
    v_mfma_f32_32x32x16_bf16 v[208:223], v[100:103], v[236:239], v[208:223]
    v_exp_f32 v154, v154
    v_exp_f32 v155, v155
    v_exp_f32 v156, v156
    v_exp_f32 v157, v157
    v_mfma_f32_32x32x16_bf16 v[176:191], v[52:55], v[140:143], 0
    v_exp_f32 v158, v158
    v_exp_f32 v159, v159
    v_cvt_pk_bf16_f32 v224, v144, v145
    v_cvt_pk_bf16_f32 v225, v146, v147
    v_cvt_pk_bf16_f32 v226, v148, v149
    v_cvt_pk_bf16_f32 v227, v150, v151
    v_cvt_pk_bf16_f32 v228, v152, v153
    v_cvt_pk_bf16_f32 v229, v154, v155
    v_cvt_pk_bf16_f32 v230, v156, v157
    v_cvt_pk_bf16_f32 v231, v158, v159
    v_exp_f32 v160, v160
    v_exp_f32 v161, v161
    v_mfma_f32_32x32x16_bf16 v[144:159], v[48:51], v[140:143], 0
    v_exp_f32 v162, v162
    v_exp_f32 v163, v163
    v_exp_f32 v164, v164
    v_exp_f32 v165, v165
    v_mfma_f32_32x32x16_bf16 v[208:223], v[104:107], v[224:227], v[208:223]
    v_exp_f32 v166, v166
    v_exp_f32 v167, v167
    v_exp_f32 v168, v168
    v_exp_f32 v169, v169
    v_mfma_f32_32x32x16_bf16 v[208:223], v[108:111], v[228:231], v[208:223]
    v_exp_f32 v170, v170
    v_exp_f32 v171, v171
    v_exp_f32 v172, v172
    v_exp_f32 v173, v173
    v_mfma_f32_32x32x16_bf16 v[192:207], v[20:23], v[140:143], 0
    v_exp_f32 v174, v174
    v_exp_f32 v175, v175
    v_cvt_pk_bf16_f32 v232, v160, v161
    v_cvt_pk_bf16_f32 v233, v162, v163
    v_cvt_pk_bf16_f32 v234, v164, v165
    v_cvt_pk_bf16_f32 v235, v166, v167
    v_cvt_pk_bf16_f32 v236, v168, v169
    v_cvt_pk_bf16_f32 v237, v170, v171
    v_cvt_pk_bf16_f32 v238, v172, v173
    v_cvt_pk_bf16_f32 v239, v174, v175
    v_exp_f32 v144, v144
    v_exp_f32 v145, v145
    v_exp_f32 v146, v146
    v_exp_f32 v147, v147
    v_exp_f32 v148, v148
    v_exp_f32 v149, v149
    v_mfma_f32_32x32x16_bf16 v[208:223], v[112:115], v[232:235], v[208:223]
    v_exp_f32 v150, v150
    v_exp_f32 v151, v151
    v_exp_f32 v152, v152
    v_exp_f32 v153, v153
    v_mfma_f32_32x32x16_bf16 v[208:223], v[116:119], v[236:239], v[208:223]
    v_exp_f32 v154, v154
    v_exp_f32 v155, v155
    v_exp_f32 v156, v156
    v_exp_f32 v157, v157
    v_exp_f32 v158, v158
    v_exp_f32 v159, v159
    v_cvt_pk_bf16_f32 v224, v144, v145
    v_cvt_pk_bf16_f32 v225, v146, v147
    v_cvt_pk_bf16_f32 v226, v148, v149
    v_cvt_pk_bf16_f32 v227, v150, v151
    v_cvt_pk_bf16_f32 v228, v152, v153
    v_cvt_pk_bf16_f32 v229, v154, v155
    v_cvt_pk_bf16_f32 v230, v156, v157
    v_cvt_pk_bf16_f32 v231, v158, v159
    v_cndmask_b32 v176, v192, v176, s[64:65]
    v_cndmask_b32 v177, v193, v177, s[66:67]
    v_cndmask_b32 v178, v194, v178, s[68:69]
    v_cndmask_b32 v179, v195, v179, s[70:71]
    v_mfma_f32_32x32x16_bf16 v[208:223], v[120:123], v[224:227], v[208:223]
    v_cndmask_b32 v180, v196, v180, s[72:73]
    v_cndmask_b32 v181, v197, v181, s[74:75]
    v_cndmask_b32 v182, v198, v182, s[76:77]
    v_cndmask_b32 v183, v199, v183, s[78:79]
    v_cndmask_b32 v184, v200, v184, s[80:81]
    v_cndmask_b32 v185, v201, v185, s[82:83]
    v_cndmask_b32 v186, v202, v186, s[84:85]
    v_cndmask_b32 v187, v203, v187, s[86:87]
    v_mfma_f32_32x32x16_bf16 v[208:223], v[124:127], v[228:231], v[208:223]
    v_cndmask_b32 v188, v204, v188, s[88:89]
    v_cndmask_b32 v189, v205, v189, s[90:91]
    v_cndmask_b32 v190, v206, v190, s[92:93]
    v_cndmask_b32 v191, v207, v191, s[94:95]
    v_exp_f32 v176, v176
    v_exp_f32 v177, v177
    v_exp_f32 v178, v178
    v_exp_f32 v179, v179
    v_exp_f32 v180, v180
    v_exp_f32 v181, v181
    v_exp_f32 v182, v182
    v_exp_f32 v183, v183
    v_exp_f32 v184, v184
    v_exp_f32 v185, v185
    v_exp_f32 v186, v186
    v_exp_f32 v187, v187
    v_exp_f32 v188, v188
    v_exp_f32 v189, v189
    v_exp_f32 v190, v190
    v_exp_f32 v191, v191
    s_nop 0
    v_cvt_pk_bf16_f32 v232, v176, v177
    v_cvt_pk_bf16_f32 v233, v178, v179
    v_cvt_pk_bf16_f32 v234, v180, v181
    v_cvt_pk_bf16_f32 v235, v182, v183
    v_cvt_pk_bf16_f32 v236, v184, v185
    v_cvt_pk_bf16_f32 v237, v186, v187
    v_cvt_pk_bf16_f32 v238, v188, v189
    v_cvt_pk_bf16_f32 v239, v190, v191
    v_and_b32 v176, v232, v240
    v_and_b32 v177, v233, v241
    v_and_b32 v178, v234, v242
    v_and_b32 v179, v235, v243
    v_and_b32 v180, v236, v244
    v_and_b32 v181, v237, v245
    v_and_b32 v182, v238, v246
    v_and_b32 v183, v239, v247
    v_xor_b32 v184, v232, v176
    v_xor_b32 v185, v233, v177
    v_mfma_f32_32x32x16_bf16 v[208:223], v[128:131], v[176:179], v[208:223]
    v_xor_b32 v186, v234, v178
    v_xor_b32 v187, v235, v179
    v_xor_b32 v188, v236, v180
    v_xor_b32 v189, v237, v181
    v_mfma_f32_32x32x16_bf16 v[208:223], v[132:135], v[180:183], v[208:223]
    v_xor_b32 v190, v238, v182
    v_xor_b32 v191, v239, v183
    s_nop 1
    v_mfma_f32_32x32x16_bf16 v[208:223], v[64:67], v[184:187], v[208:223]
    v_mfma_f32_32x32x16_bf16 v[208:223], v[68:71], v[188:191], v[208:223]
    s_nop 15
    v_cmp_lt_f32 vcc, 0x30800000, v216
    v_cmp_gt_f32 s[98:99], v6, v216
    v_max3_f32 v4, |v208|, |v209|, |v210|
    v_max3_f32 v5, |v211|, |v212|, |v213|
    v_max3_f32 v4, v4, |v214|, |v215|
    s_and_b64 vcc, vcc, s[98:99]
    v_max_f32 v4, v4, v5
    v_cmp_gt_f32 s[98:99], v3, v4
    s_nop 1
    s_and_b64 vcc, vcc, s[98:99]
    s_cmp_eq_u64 vcc, -1
    s_cbranch_scc0 L_FB1
    v_rcp_f32 v5, v216
    s_add_u32 s62, s37, 1
    s_mul_i32 s62, s62, 118
    v_mul_f32 v208, v208, v5
    v_mul_f32 v209, v209, v5
    v_mul_f32 v210, v210, v5
    v_mul_f32 v211, v211, v5
    v_mul_f32 v212, v212, v5
    v_mul_f32 v213, v213, v5
    v_mul_f32 v214, v214, v5
    v_mul_f32 v215, v215, v5
    s_add_u32 s62, s62, s36
    s_lshl_b32 s62, s62, 10
    s_add_u32 s62, s62, 6379520
    v_cvt_pk_bf16_f32 v12, v208, v209
    v_cvt_pk_bf16_f32 v13, v210, v211
    v_cvt_pk_bf16_f32 v14, v212, v213
    v_cvt_pk_bf16_f32 v15, v214, v215
    buffer_store_dwordx4 v[12:15], v2, s[28:31], s62 offen sc1
    s_branch L_ATT_DONE
L_ATT_SLOW:
    s_waitcnt vmcnt(0)
    v_permlane16_swap_b32 v56, v60
    v_permlane16_swap_b32 v57, v61
    v_permlane16_swap_b32 v58, v62
    v_permlane16_swap_b32 v59, v63
    v_permlane16_swap_b32 v64, v68
    v_permlane16_swap_b32 v65, v69
    v_permlane16_swap_b32 v66, v70
    v_permlane16_swap_b32 v67, v71
    v_permlane16_swap_b32 v72, v76
    v_permlane16_swap_b32 v73, v77
    v_permlane16_swap_b32 v74, v78
    v_permlane16_swap_b32 v75, v79
    v_permlane16_swap_b32 v80, v84
    v_permlane16_swap_b32 v81, v85
    v_permlane16_swap_b32 v82, v86
    v_permlane16_swap_b32 v83, v87
    v_permlane16_swap_b32 v88, v92
    v_permlane16_swap_b32 v89, v93
    v_permlane16_swap_b32 v90, v94
    v_permlane16_swap_b32 v91, v95
    v_permlane16_swap_b32 v96, v100
    v_permlane16_swap_b32 v97, v101
    v_permlane16_swap_b32 v98, v102
    v_permlane16_swap_b32 v99, v103
    v_permlane16_swap_b32 v104, v108
    v_permlane16_swap_b32 v105, v109
    v_permlane16_swap_b32 v106, v110
    v_permlane16_swap_b32 v107, v111
    v_permlane16_swap_b32 v112, v116
    v_permlane16_swap_b32 v113, v117
    v_permlane16_swap_b32 v114, v118
    v_permlane16_swap_b32 v115, v119
    v_permlane16_swap_b32 v120, v124
    v_permlane16_swap_b32 v121, v125
    v_permlane16_swap_b32 v122, v126
    v_permlane16_swap_b32 v123, v127
    v_mfma_f32_32x32x16_bf16 v[176:191], v[48:51], v[136:139], 0
    v_mfma_f32_32x32x16_bf16 v[144:159], v[44:47], v[136:139], 0
    s_nop 10
    v_exp_f32 v176, v176
    v_exp_f32 v177, v177
    v_exp_f32 v178, v178
    v_exp_f32 v179, v179
    v_exp_f32 v180, v180
    v_exp_f32 v181, v181
    v_exp_f32 v182, v182
    v_exp_f32 v183, v183
    v_exp_f32 v184, v184
    v_exp_f32 v185, v185
    v_exp_f32 v186, v186
    v_exp_f32 v187, v187
    v_exp_f32 v188, v188
    v_exp_f32 v189, v189
    v_exp_f32 v190, v190
    v_exp_f32 v191, v191
    s_nop 0
    v_cvt_pk_bf16_f32 v232, v176, v177
    v_cvt_pk_bf16_f32 v233, v178, v179
    v_cvt_pk_bf16_f32 v234, v180, v181
    v_cvt_pk_bf16_f32 v235, v182, v183
    v_cvt_pk_bf16_f32 v236, v184, v185
    v_cvt_pk_bf16_f32 v237, v186, v187
    v_cvt_pk_bf16_f32 v238, v188, v189
    v_cvt_pk_bf16_f32 v239, v190, v191
    v_and_b32 v232, v232, v240
    v_and_b32 v233, v233, v241
    v_and_b32 v234, v234, v242
    v_and_b32 v235, v235, v243
    v_and_b32 v236, v236, v244
    v_and_b32 v237, v237, v245
    v_and_b32 v238, v238, v246
    v_and_b32 v239, v239, v247
    s_nop 1
    v_mfma_f32_32x32x16_bf16 v[208:223], v[120:123], v[232:235], 0
    v_mfma_f32_32x32x16_bf16 v[208:223], v[124:127], v[236:239], v[208:223]
    s_cmp_lt_i32 7, s38
    s_cbranch_scc1 L_S1D_2
    v_exp_f32 v144, v144
    v_exp_f32 v145, v145
    v_mfma_f32_32x32x16_bf16 v[160:175], v[40:43], v[136:139], 0
    v_exp_f32 v146, v146
    v_exp_f32 v147, v147
    v_exp_f32 v148, v148
    v_exp_f32 v149, v149
    v_exp_f32 v150, v150
    v_exp_f32 v151, v151
    v_exp_f32 v152, v152
    v_exp_f32 v153, v153
    v_exp_f32 v154, v154
    v_exp_f32 v155, v155
    v_exp_f32 v156, v156
    v_exp_f32 v157, v157
    v_exp_f32 v158, v158
    v_exp_f32 v159, v159
    v_cvt_pk_bf16_f32 v224, v144, v145
    v_cvt_pk_bf16_f32 v225, v146, v147
    v_cvt_pk_bf16_f32 v226, v148, v149
    v_cvt_pk_bf16_f32 v227, v150, v151
    v_cvt_pk_bf16_f32 v228, v152, v153
    v_cvt_pk_bf16_f32 v229, v154, v155
    v_cvt_pk_bf16_f32 v230, v156, v157
    v_cvt_pk_bf16_f32 v231, v158, v159
    s_nop 1
    v_mfma_f32_32x32x16_bf16 v[208:223], v[112:115], v[224:227], v[208:223]
    v_mfma_f32_32x32x16_bf16 v[208:223], v[116:119], v[228:231], v[208:223]
    s_cmp_lt_i32 6, s38
    s_cbranch_scc1 L_S1D_2
    v_exp_f32 v160, v160
    v_exp_f32 v161, v161
    v_mfma_f32_32x32x16_bf16 v[144:159], v[36:39], v[136:139], 0
    v_exp_f32 v162, v162
    v_exp_f32 v163, v163
    v_exp_f32 v164, v164
    v_exp_f32 v165, v165
    v_exp_f32 v166, v166
    v_exp_f32 v167, v167
    v_exp_f32 v168, v168
    v_exp_f32 v169, v169
    v_exp_f32 v170, v170
    v_exp_f32 v171, v171
    v_exp_f32 v172, v172
    v_exp_f32 v173, v173
    v_exp_f32 v174, v174
    v_exp_f32 v175, v175
    v_cvt_pk_bf16_f32 v232, v160, v161
    v_cvt_pk_bf16_f32 v233, v162, v163
    v_cvt_pk_bf16_f32 v234, v164, v165
    v_cvt_pk_bf16_f32 v235, v166, v167
    v_cvt_pk_bf16_f32 v236, v168, v169
    v_cvt_pk_bf16_f32 v237, v170, v171
    v_cvt_pk_bf16_f32 v238, v172, v173
    v_cvt_pk_bf16_f32 v239, v174, v175
    s_nop 1
    v_mfma_f32_32x32x16_bf16 v[208:223], v[104:107], v[232:235], v[208:223]
    v_mfma_f32_32x32x16_bf16 v[208:223], v[108:111], v[236:239], v[208:223]
    s_cmp_lt_i32 5, s38
    s_cbranch_scc1 L_S1D_2
    v_exp_f32 v144, v144
    v_exp_f32 v145, v145
    v_mfma_f32_32x32x16_bf16 v[160:175], v[32:35], v[136:139], 0
    v_exp_f32 v146, v146
    v_exp_f32 v147, v147
    v_exp_f32 v148, v148
    v_exp_f32 v149, v149
    v_exp_f32 v150, v150
    v_exp_f32 v151, v151
    v_exp_f32 v152, v152
    v_exp_f32 v153, v153
    v_exp_f32 v154, v154
    v_exp_f32 v155, v155
    v_exp_f32 v156, v156
    v_exp_f32 v157, v157
    v_exp_f32 v158, v158
    v_exp_f32 v159, v159
    v_cvt_pk_bf16_f32 v224, v144, v145
    v_cvt_pk_bf16_f32 v225, v146, v147
    v_cvt_pk_bf16_f32 v226, v148, v149
    v_cvt_pk_bf16_f32 v227, v150, v151
    v_cvt_pk_bf16_f32 v228, v152, v153
    v_cvt_pk_bf16_f32 v229, v154, v155
    v_cvt_pk_bf16_f32 v230, v156, v157
    v_cvt_pk_bf16_f32 v231, v158, v159
    s_nop 1
    v_mfma_f32_32x32x16_bf16 v[208:223], v[96:99], v[224:227], v[208:223]
    v_mfma_f32_32x32x16_bf16 v[208:223], v[100:103], v[228:231], v[208:223]
    s_cmp_lt_i32 4, s38
    s_cbranch_scc1 L_S1D_2
    v_exp_f32 v160, v160
    v_exp_f32 v161, v161
    v_mfma_f32_32x32x16_bf16 v[144:159], v[28:31], v[136:139], 0
    v_exp_f32 v162, v162
    v_exp_f32 v163, v163
    v_exp_f32 v164, v164
    v_exp_f32 v165, v165
    v_exp_f32 v166, v166
    v_exp_f32 v167, v167
    v_exp_f32 v168, v168
    v_exp_f32 v169, v169
    v_exp_f32 v170, v170
    v_exp_f32 v171, v171
    v_exp_f32 v172, v172
    v_exp_f32 v173, v173
    v_exp_f32 v174, v174
    v_exp_f32 v175, v175
    v_cvt_pk_bf16_f32 v232, v160, v161
    v_cvt_pk_bf16_f32 v233, v162, v163
    v_cvt_pk_bf16_f32 v234, v164, v165
    v_cvt_pk_bf16_f32 v235, v166, v167
    v_cvt_pk_bf16_f32 v236, v168, v169
    v_cvt_pk_bf16_f32 v237, v170, v171
    v_cvt_pk_bf16_f32 v238, v172, v173
    v_cvt_pk_bf16_f32 v239, v174, v175
    s_nop 1
    v_mfma_f32_32x32x16_bf16 v[208:223], v[88:91], v[232:235], v[208:223]
    v_mfma_f32_32x32x16_bf16 v[208:223], v[92:95], v[236:239], v[208:223]
    s_cmp_lt_i32 3, s38
    s_cbranch_scc1 L_S1D_2
    v_exp_f32 v144, v144
    v_exp_f32 v145, v145
    v_mfma_f32_32x32x16_bf16 v[160:175], v[24:27], v[136:139], 0
    v_exp_f32 v146, v146
    v_exp_f32 v147, v147
    v_exp_f32 v148, v148
    v_exp_f32 v149, v149
    v_exp_f32 v150, v150
    v_exp_f32 v151, v151
    v_exp_f32 v152, v152
    v_exp_f32 v153, v153
    v_exp_f32 v154, v154
    v_exp_f32 v155, v155
    v_exp_f32 v156, v156
    v_exp_f32 v157, v157
    v_exp_f32 v158, v158
    v_exp_f32 v159, v159
    v_cvt_pk_bf16_f32 v224, v144, v145
    v_cvt_pk_bf16_f32 v225, v146, v147
    v_cvt_pk_bf16_f32 v226, v148, v149
    v_cvt_pk_bf16_f32 v227, v150, v151
    v_cvt_pk_bf16_f32 v228, v152, v153
    v_cvt_pk_bf16_f32 v229, v154, v155
    v_cvt_pk_bf16_f32 v230, v156, v157
    v_cvt_pk_bf16_f32 v231, v158, v159
    s_nop 1
    v_mfma_f32_32x32x16_bf16 v[208:223], v[80:83], v[224:227], v[208:223]
    v_mfma_f32_32x32x16_bf16 v[208:223], v[84:87], v[228:231], v[208:223]
    s_cmp_lt_i32 2, s38
    s_cbranch_scc1 L_S1D_2
    v_exp_f32 v160, v160
    v_exp_f32 v161, v161
    v_mfma_f32_32x32x16_bf16 v[144:159], v[20:23], v[136:139], 0
    v_exp_f32 v162, v162
    v_exp_f32 v163, v163
    v_exp_f32 v164, v164
    v_exp_f32 v165, v165
    v_exp_f32 v166, v166
    v_exp_f32 v167, v167
    v_exp_f32 v168, v168
    v_exp_f32 v169, v169
    v_exp_f32 v170, v170
    v_exp_f32 v171, v171
    v_exp_f32 v172, v172
    v_exp_f32 v173, v173
    v_exp_f32 v174, v174
    v_exp_f32 v175, v175
    v_cvt_pk_bf16_f32 v232, v160, v161
    v_cvt_pk_bf16_f32 v233, v162, v163
    v_cvt_pk_bf16_f32 v234, v164, v165
    v_cvt_pk_bf16_f32 v235, v166, v167
    v_cvt_pk_bf16_f32 v236, v168, v169
    v_cvt_pk_bf16_f32 v237, v170, v171
    v_cvt_pk_bf16_f32 v238, v172, v173
    v_cvt_pk_bf16_f32 v239, v174, v175
    s_nop 1
    v_mfma_f32_32x32x16_bf16 v[208:223], v[72:75], v[232:235], v[208:223]
    v_mfma_f32_32x32x16_bf16 v[208:223], v[76:79], v[236:239], v[208:223]
    s_cmp_lt_i32 1, s38
    s_cbranch_scc1 L_S1D_2
    v_exp_f32 v144, v144
    v_exp_f32 v145, v145
    v_exp_f32 v146, v146
    v_exp_f32 v147, v147
    v_exp_f32 v148, v148
    v_exp_f32 v149, v149
    v_exp_f32 v150, v150
    v_exp_f32 v151, v151
    v_exp_f32 v152, v152
    v_exp_f32 v153, v153
    v_exp_f32 v154, v154
    v_exp_f32 v155, v155
    v_exp_f32 v156, v156
    v_exp_f32 v157, v157
    v_exp_f32 v158, v158
    v_exp_f32 v159, v159
    v_cvt_pk_bf16_f32 v224, v144, v145
    v_cvt_pk_bf16_f32 v225, v146, v147
    v_cvt_pk_bf16_f32 v226, v148, v149
    v_cvt_pk_bf16_f32 v227, v150, v151
    v_cvt_pk_bf16_f32 v228, v152, v153
    v_cvt_pk_bf16_f32 v229, v154, v155
    v_cvt_pk_bf16_f32 v230, v156, v157
    v_cvt_pk_bf16_f32 v231, v158, v159
    s_nop 1
    v_mfma_f32_32x32x16_bf16 v[208:223], v[64:67], v[224:227], v[208:223]
    v_mfma_f32_32x32x16_bf16 v[208:223], v[68:71], v[228:231], v[208:223]
L_S1D_2:
    s_nop 15
    v_cmp_lt_f32 vcc, 0x30800000, v216
    v_cmp_gt_f32 s[98:99], v6, v216
    v_max3_f32 v4, |v208|, |v209|, |v210|
    v_max3_f32 v5, |v211|, |v212|, |v213|
    v_max3_f32 v4, v4, |v214|, |v215|
    s_and_b64 vcc, vcc, s[98:99]
    v_max_f32 v4, v4, v5
    v_cmp_gt_f32 s[98:99], v3, v4
    s_nop 1
    s_and_b64 vcc, vcc, s[98:99]
    s_cmp_eq_u64 vcc, -1
    s_cbranch_scc0 L_FB0
    v_rcp_f32 v5, v216
    s_add_u32 s62, s37, 0
    s_mul_i32 s62, s62, 118
    v_mul_f32 v208, v208, v5
    v_mul_f32 v209, v209, v5
    v_mul_f32 v210, v210, v5
    v_mul_f32 v211, v211, v5
    v_mul_f32 v212, v212, v5
    v_mul_f32 v213, v213, v5
    v_mul_f32 v214, v214, v5
    v_mul_f32 v215, v215, v5
    s_add_u32 s62, s62, s36
    s_lshl_b32 s62, s62, 10
    s_add_u32 s62, s62, 6379520
    v_cvt_pk_bf16_f32 v12, v208, v209
    v_cvt_pk_bf16_f32 v13, v210, v211
    v_cvt_pk_bf16_f32 v14, v212, v213
    v_cvt_pk_bf16_f32 v15, v214, v215
    buffer_store_dwordx4 v[12:15], v2, s[28:31], s62 offen sc1
    s_branch L_ATT_MID
L_ATT_SLOW2:
    v_mfma_f32_32x32x16_bf16 v[176:191], v[52:55], v[140:143], 0
    v_mfma_f32_32x32x16_bf16 v[144:159], v[48:51], v[140:143], 0
    s_nop 10
    v_exp_f32 v176, v176
    v_exp_f32 v177, v177
    v_exp_f32 v178, v178
    v_exp_f32 v179, v179
    v_exp_f32 v180, v180
    v_exp_f32 v181, v181
    v_exp_f32 v182, v182
    v_exp_f32 v183, v183
    v_exp_f32 v184, v184
    v_exp_f32 v185, v185
    v_exp_f32 v186, v186
    v_exp_f32 v187, v187
    v_exp_f32 v188, v188
    v_exp_f32 v189, v189
    v_exp_f32 v190, v190
    v_exp_f32 v191, v191
    s_nop 0
    v_cvt_pk_bf16_f32 v232, v176, v177
    v_cvt_pk_bf16_f32 v233, v178, v179
    v_cvt_pk_bf16_f32 v234, v180, v181
    v_cvt_pk_bf16_f32 v235, v182, v183
    v_cvt_pk_bf16_f32 v236, v184, v185
    v_cvt_pk_bf16_f32 v237, v186, v187
    v_cvt_pk_bf16_f32 v238, v188, v189
    v_cvt_pk_bf16_f32 v239, v190, v191
    v_and_b32 v232, v232, v240
    v_and_b32 v233, v233, v241
    v_and_b32 v234, v234, v242
    v_and_b32 v235, v235, v243
    v_and_b32 v236, v236, v244
    v_and_b32 v237, v237, v245
    v_and_b32 v238, v238, v246
    v_and_b32 v239, v239, v247
    s_nop 1
    v_mfma_f32_32x32x16_bf16 v[208:223], v[128:131], v[232:235], 0
    v_mfma_f32_32x32x16_bf16 v[208:223], v[132:135], v[236:239], v[208:223]
    s_cmp_lt_i32 8, s38
    s_cbranch_scc1 L_S1D_3
    v_exp_f32 v144, v144
    v_exp_f32 v145, v145
    v_mfma_f32_32x32x16_bf16 v[160:175], v[44:47], v[140:143], 0
    v_exp_f32 v146, v146
    v_exp_f32 v147, v147
    v_exp_f32 v148, v148
    v_exp_f32 v149, v149
    v_exp_f32 v150, v150
    v_exp_f32 v151, v151
    v_exp_f32 v152, v152
    v_exp_f32 v153, v153
    v_exp_f32 v154, v154
    v_exp_f32 v155, v155
    v_exp_f32 v156, v156
    v_exp_f32 v157, v157
    v_exp_f32 v158, v158
    v_exp_f32 v159, v159
    v_cvt_pk_bf16_f32 v224, v144, v145
    v_cvt_pk_bf16_f32 v225, v146, v147
    v_cvt_pk_bf16_f32 v226, v148, v149
    v_cvt_pk_bf16_f32 v227, v150, v151
    v_cvt_pk_bf16_f32 v228, v152, v153
    v_cvt_pk_bf16_f32 v229, v154, v155
    v_cvt_pk_bf16_f32 v230, v156, v157
    v_cvt_pk_bf16_f32 v231, v158, v159
    s_nop 1
    v_mfma_f32_32x32x16_bf16 v[208:223], v[120:123], v[224:227], v[208:223]
    v_mfma_f32_32x32x16_bf16 v[208:223], v[124:127], v[228:231], v[208:223]
    s_cmp_lt_i32 7, s38
    s_cbranch_scc1 L_S1D_3
    v_exp_f32 v160, v160
    v_exp_f32 v161, v161
    v_mfma_f32_32x32x16_bf16 v[144:159], v[40:43], v[140:143], 0
    v_exp_f32 v162, v162
    v_exp_f32 v163, v163
    v_exp_f32 v164, v164
    v_exp_f32 v165, v165
    v_exp_f32 v166, v166
    v_exp_f32 v167, v167
    v_exp_f32 v168, v168
    v_exp_f32 v169, v169
    v_exp_f32 v170, v170
    v_exp_f32 v171, v171
    v_exp_f32 v172, v172
    v_exp_f32 v173, v173
    v_exp_f32 v174, v174
    v_exp_f32 v175, v175
    v_cvt_pk_bf16_f32 v232, v160, v161
    v_cvt_pk_bf16_f32 v233, v162, v163
    v_cvt_pk_bf16_f32 v234, v164, v165
    v_cvt_pk_bf16_f32 v235, v166, v167
    v_cvt_pk_bf16_f32 v236, v168, v169
    v_cvt_pk_bf16_f32 v237, v170, v171
    v_cvt_pk_bf16_f32 v238, v172, v173
    v_cvt_pk_bf16_f32 v239, v174, v175
    s_nop 1
    v_mfma_f32_32x32x16_bf16 v[208:223], v[112:115], v[232:235], v[208:223]
    v_mfma_f32_32x32x16_bf16 v[208:223], v[116:119], v[236:239], v[208:223]
    s_cmp_lt_i32 6, s38
    s_cbranch_scc1 L_S1D_3
    v_exp_f32 v144, v144
    v_exp_f32 v145, v145
    v_mfma_f32_32x32x16_bf16 v[160:175], v[36:39], v[140:143], 0
    v_exp_f32 v146, v146
    v_exp_f32 v147, v147
    v_exp_f32 v148, v148
    v_exp_f32 v149, v149
    v_exp_f32 v150, v150
    v_exp_f32 v151, v151
    v_exp_f32 v152, v152
    v_exp_f32 v153, v153
    v_exp_f32 v154, v154
    v_exp_f32 v155, v155
    v_exp_f32 v156, v156
    v_exp_f32 v157, v157
    v_exp_f32 v158, v158
    v_exp_f32 v159, v159
    v_cvt_pk_bf16_f32 v224, v144, v145
    v_cvt_pk_bf16_f32 v225, v146, v147
    v_cvt_pk_bf16_f32 v226, v148, v149
    v_cvt_pk_bf16_f32 v227, v150, v151
    v_cvt_pk_bf16_f32 v228, v152, v153
    v_cvt_pk_bf16_f32 v229, v154, v155
    v_cvt_pk_bf16_f32 v230, v156, v157
    v_cvt_pk_bf16_f32 v231, v158, v159
    s_nop 1
    v_mfma_f32_32x32x16_bf16 v[208:223], v[104:107], v[224:227], v[208:223]
    v_mfma_f32_32x32x16_bf16 v[208:223], v[108:111], v[228:231], v[208:223]
    s_cmp_lt_i32 5, s38
    s_cbranch_scc1 L_S1D_3
    v_exp_f32 v160, v160
    v_exp_f32 v161, v161
    v_mfma_f32_32x32x16_bf16 v[144:159], v[32:35], v[140:143], 0
    v_exp_f32 v162, v162
    v_exp_f32 v163, v163
    v_exp_f32 v164, v164
    v_exp_f32 v165, v165
    v_exp_f32 v166, v166
    v_exp_f32 v167, v167
    v_exp_f32 v168, v168
    v_exp_f32 v169, v169
    v_exp_f32 v170, v170
    v_exp_f32 v171, v171
    v_exp_f32 v172, v172
    v_exp_f32 v173, v173
    v_exp_f32 v174, v174
    v_exp_f32 v175, v175
    v_cvt_pk_bf16_f32 v232, v160, v161
    v_cvt_pk_bf16_f32 v233, v162, v163
    v_cvt_pk_bf16_f32 v234, v164, v165
    v_cvt_pk_bf16_f32 v235, v166, v167
    v_cvt_pk_bf16_f32 v236, v168, v169
    v_cvt_pk_bf16_f32 v237, v170, v171
    v_cvt_pk_bf16_f32 v238, v172, v173
    v_cvt_pk_bf16_f32 v239, v174, v175
    s_nop 1
    v_mfma_f32_32x32x16_bf16 v[208:223], v[96:99], v[232:235], v[208:223]
    v_mfma_f32_32x32x16_bf16 v[208:223], v[100:103], v[236:239], v[208:223]
    s_cmp_lt_i32 4, s38
    s_cbranch_scc1 L_S1D_3
    v_exp_f32 v144, v144
    v_exp_f32 v145, v145
    v_mfma_f32_32x32x16_bf16 v[160:175], v[28:31], v[140:143], 0
    v_exp_f32 v146, v146
    v_exp_f32 v147, v147
    v_exp_f32 v148, v148
    v_exp_f32 v149, v149
    v_exp_f32 v150, v150
    v_exp_f32 v151, v151
    v_exp_f32 v152, v152
    v_exp_f32 v153, v153
    v_exp_f32 v154, v154
    v_exp_f32 v155, v155
    v_exp_f32 v156, v156
    v_exp_f32 v157, v157
    v_exp_f32 v158, v158
    v_exp_f32 v159, v159
    v_cvt_pk_bf16_f32 v224, v144, v145
    v_cvt_pk_bf16_f32 v225, v146, v147
    v_cvt_pk_bf16_f32 v226, v148, v149
    v_cvt_pk_bf16_f32 v227, v150, v151
    v_cvt_pk_bf16_f32 v228, v152, v153
    v_cvt_pk_bf16_f32 v229, v154, v155
    v_cvt_pk_bf16_f32 v230, v156, v157
    v_cvt_pk_bf16_f32 v231, v158, v159
    s_nop 1
    v_mfma_f32_32x32x16_bf16 v[208:223], v[88:91], v[224:227], v[208:223]
    v_mfma_f32_32x32x16_bf16 v[208:223], v[92:95], v[228:231], v[208:223]
    s_cmp_lt_i32 3, s38
    s_cbranch_scc1 L_S1D_3
    v_exp_f32 v160, v160
    v_exp_f32 v161, v161
    v_mfma_f32_32x32x16_bf16 v[144:159], v[24:27], v[140:143], 0
    v_exp_f32 v162, v162
    v_exp_f32 v163, v163
    v_exp_f32 v164, v164
    v_exp_f32 v165, v165
    v_exp_f32 v166, v166
    v_exp_f32 v167, v167
    v_exp_f32 v168, v168
    v_exp_f32 v169, v169
    v_exp_f32 v170, v170
    v_exp_f32 v171, v171
    v_exp_f32 v172, v172
    v_exp_f32 v173, v173
    v_exp_f32 v174, v174
    v_exp_f32 v175, v175
    v_cvt_pk_bf16_f32 v232, v160, v161
    v_cvt_pk_bf16_f32 v233, v162, v163
    v_cvt_pk_bf16_f32 v234, v164, v165
    v_cvt_pk_bf16_f32 v235, v166, v167
    v_cvt_pk_bf16_f32 v236, v168, v169
    v_cvt_pk_bf16_f32 v237, v170, v171
    v_cvt_pk_bf16_f32 v238, v172, v173
    v_cvt_pk_bf16_f32 v239, v174, v175
    s_nop 1
    v_mfma_f32_32x32x16_bf16 v[208:223], v[80:83], v[232:235], v[208:223]
    v_mfma_f32_32x32x16_bf16 v[208:223], v[84:87], v[236:239], v[208:223]
    s_cmp_lt_i32 2, s38
    s_cbranch_scc1 L_S1D_3
    v_exp_f32 v144, v144
    v_exp_f32 v145, v145
    v_exp_f32 v146, v146
    v_exp_f32 v147, v147
    v_exp_f32 v148, v148
    v_exp_f32 v149, v149
    v_exp_f32 v150, v150
    v_exp_f32 v151, v151
    v_exp_f32 v152, v152
    v_exp_f32 v153, v153
    v_exp_f32 v154, v154
    v_exp_f32 v155, v155
    v_exp_f32 v156, v156
    v_exp_f32 v157, v157
    v_exp_f32 v158, v158
    v_exp_f32 v159, v159
    v_cvt_pk_bf16_f32 v224, v144, v145
    v_cvt_pk_bf16_f32 v225, v146, v147
    v_cvt_pk_bf16_f32 v226, v148, v149
    v_cvt_pk_bf16_f32 v227, v150, v151
    v_cvt_pk_bf16_f32 v228, v152, v153
    v_cvt_pk_bf16_f32 v229, v154, v155
    v_cvt_pk_bf16_f32 v230, v156, v157
    v_cvt_pk_bf16_f32 v231, v158, v159
    s_nop 1
    v_mfma_f32_32x32x16_bf16 v[208:223], v[72:75], v[224:227], v[208:223]
    v_mfma_f32_32x32x16_bf16 v[208:223], v[76:79], v[228:231], v[208:223]
L_S1D_3:
    s_nop 15
    v_cmp_lt_f32 vcc, 0x30800000, v216
    v_cmp_gt_f32 s[98:99], v6, v216
    v_max3_f32 v4, |v208|, |v209|, |v210|
    v_max3_f32 v5, |v211|, |v212|, |v213|
    v_max3_f32 v4, v4, |v214|, |v215|
    s_and_b64 vcc, vcc, s[98:99]
    v_max_f32 v4, v4, v5
    v_cmp_gt_f32 s[98:99], v3, v4
    s_nop 1
    s_and_b64 vcc, vcc, s[98:99]
    s_cmp_eq_u64 vcc, -1
    s_cbranch_scc0 L_FB1
    v_rcp_f32 v5, v216
    s_add_u32 s62, s37, 1
    s_mul_i32 s62, s62, 118
    v_mul_f32 v208, v208, v5
    v_mul_f32 v209, v209, v5
    v_mul_f32 v210, v210, v5
    v_mul_f32 v211, v211, v5
    v_mul_f32 v212, v212, v5
    v_mul_f32 v213, v213, v5
    v_mul_f32 v214, v214, v5
    v_mul_f32 v215, v215, v5
    s_add_u32 s62, s62, s36
    s_lshl_b32 s62, s62, 10
    s_add_u32 s62, s62, 6379520
    v_cvt_pk_bf16_f32 v12, v208, v209
    v_cvt_pk_bf16_f32 v13, v210, v211
    v_cvt_pk_bf16_f32 v14, v212, v213
    v_cvt_pk_bf16_f32 v15, v214, v215
    buffer_store_dwordx4 v[12:15], v2, s[28:31], s62 offen sc1
L_ATT_DONE:
    s_lshl_b32 s62, s32, 5
    s_lshl_b32 s63, s34, 3
    s_add_u32 s62, s62, s63
    s_add_u32 s62, s62, s33
    s_lshl_b32 s62, s62, 6
    s_add_u32 s62, s62, 15073280
    s_waitcnt vmcnt(0)
    v_lshlrev_b32 v13, 3, v1
    s_mov_b64 exec, 255
    buffer_store_dwordx2 v[252:253], v13, s[28:31], s62 offen sc1
    s_mov_b64 exec, -1
    s_endpgm
L_CONSUMER:
    s_getpc_b64 s[76:77]
L_PCREF:
    s_sub_u32 s76, s76, L_PCREF-gated_mix__sliding_block__dense_activation_mish__prompt_kernel
    s_subb_u32 s77, s77, 0
    s_and_b32 s77, s77, 0xffff
    s_mov_b32 s78, L_CODE_END-gated_mix__sliding_block__dense_activation_mish__prompt_kernel
    s_mov_b32 s79, 0x00020000
    s_lshl_b32 s38, s35, 2
    s_add_u32 s38, s38, s26
    s_lshl_b32 s38, s38, 9
    v_and_b32 v12, 3, v1
    v_lshlrev_b32 v12, 7, v12
    v_add_u32 v13, s38, v12
    buffer_load_dword v13, v13, s[76:79], 0 offen
L_NOCODEPF:
    v_and_b32 v8, 31, v1
    v_lshrrev_b32 v9, 5, v1
    v_lshrrev_b32 v10, 1, v8
    v_and_b32 v10, 7, v10
    v_xor_b32 v10, v10, v9
    s_lshl_b32 s38, s26, 5
    v_add_u32 v11, s38, v8
    v_lshlrev_b32 v11, 7, v11
    v_lshl_add_u32 v2, v10, 4, v11
    v_xor_b32 v3, 32, v2
    v_xor_b32 v4, 64, v2
    v_xor_b32 v5, 96, v2
    v_lshlrev_b32 v6, 10, v9
    v_and_b32 v10, 15, v1
    v_lshrrev_b32 v10, 2, v10
    v_lshl_add_u32 v6, v10, 6, v6
    v_bfe_u32 v10, v1, 4, 1
    v_lshl_add_u32 v6, v10, 5, v6
    v_and_b32 v10, 3, v1
    v_lshl_add_u32 v6, v10, 3, v6
    v_mov_b32 v7, 0
    v_lshlrev_b32 v12, 4, v1
    s_lshl_b32 s50, s40, 2
    s_add_u32 s50, s50, s26
    s_lshl_b32 s39, s42, 3
    s_add_u32 s39, s39, s43
    s_lshl_b32 s39, s39, 6
    s_add_u32 s39, s39, s50
    s_lshl_b32 s39, s39, 6
    s_add_u32 s51, s39, 14811136
    s_lshl_b32 s39, s50, 4
    s_add_u32 s39, s39, s41
    s_lshl_b32 s39, s39, 6
    s_add_u32 s52, s39, 14942208
    s_lshl_b32 s57, s43, 8
    s_add_u32 s57, s57, s50
    s_lshl_b32 s57, s57, 10
    s_mul_i32 s38, s50, 118
    s_lshl_b32 s60, s44, 2
    s_add_u32 s60, s60, s38
    s_lshl_b32 s60, s60, 10
    s_add_u32 s60, s60, 6291456
    s_lshl_b32 s61, s45, 2
    s_add_u32 s61, s61, s38
    s_lshl_b32 s61, s61, 10
    s_add_u32 s61, s61, 6291456
    v_lshlrev_b32 v28, 3, v9
    s_lshl_b32 s38, s44, 7
    s_lshl_b32 s39, s45, 7
    s_waitcnt lgkmcnt(0)
    s_mov_b32 s72, s22
    s_and_b32 s73, s23, 0xffff
    s_mov_b32 s74, 256
    s_mov_b32 s75, 0x00020000
    s_or_b32 s88, s2, s26
    s_cmp_lg_u32 s88, 0
    s_cbranch_scc1 L_NONONCE
    s_memrealtime s[98:99]
    s_waitcnt lgkmcnt(0)
    v_mov_b32 v30, s98
    v_mov_b32 v31, s99
    s_mov_b64 exec, 1
    buffer_store_dwordx2 v[30:31], v7, s[72:75], 0 offen sc1
    s_mov_b64 exec, -1
L_NONONCE:
    s_mov_b32 s92, s14
    s_and_b32 s93, s15, 0xffff
    s_mov_b32 s94, 2752
    s_mov_b32 s95, 0x00020000
    s_cmp_eq_u32 s42, 0
    s_cbranch_scc1 L_NOB1
    buffer_load_dwordx2 v[224:225], v28, s[92:95], s38 offen offset:0
    buffer_load_dwordx2 v[226:227], v28, s[92:95], s38 offen offset:16
    buffer_load_dwordx2 v[228:229], v28, s[92:95], s38 offen offset:32
    buffer_load_dwordx2 v[230:231], v28, s[92:95], s38 offen offset:48
    buffer_load_dwordx2 v[232:233], v28, s[92:95], s38 offen offset:64
    buffer_load_dwordx2 v[234:235], v28, s[92:95], s38 offen offset:80
    buffer_load_dwordx2 v[236:237], v28, s[92:95], s38 offen offset:96
    buffer_load_dwordx2 v[238:239], v28, s[92:95], s38 offen offset:112
L_NOB1:
    s_mov_b32 s89, s39
    s_mov_b32 s28, s24
    s_and_b32 s29, s25, 0xffff
    s_mov_b32 s30, 16777216
    s_mov_b32 s31, 0x00020000
    s_lshl_b32 s58, s27, 8
    s_add_u32 s58, s58, 15204352
    s_lshl_b32 s47, s35, 3
    s_add_u32 s47, s47, s58
    s_mov_b32 s97, 0
    s_cmp_eq_u32 s26, 0
    s_cselect_b32 s80, s4, s6
    s_cselect_b32 s81, s5, s7
    s_mov_b32 s84, 2097152
    s_mov_b32 s85, 1572864
    s_cselect_b32 s82, s84, s85
    s_cselect_b32 s84, 64, 48
    s_cmp_eq_u32 s26, 2
    s_cselect_b32 s80, s12, s80
    s_cselect_b32 s81, s13, s81
    s_cmp_eq_u32 s26, 3
    s_cselect_b32 s80, s16, s80
    s_cselect_b32 s81, s17, s81
    s_cmp_ge_u32 s26, 2
    s_cselect_b32 s82, 1409024, s82
    s_cselect_b32 s84, 43, s84
    s_and_b32 s81, s81, 0xffff
    s_mov_b32 s83, 0x00020000
    s_mul_i32 s85, s84, s2
    s_sub_u32 s84, s84, 1
    v_min_u32 v29, s84, v1
    v_add_u32 v29, s85, v29
    v_lshlrev_b32 v29, 7, v29
    s_cmp_eq_u32 s26, 3
    s_cbranch_scc1 L_MTS_4
    s_cmp_eq_u32 s26, 1
    s_cselect_b32 s84, 36, 33
    s_mov_b32 s85, 393216
    s_cselect_b32 s86, s85, 352256
    s_mul_i32 s85, s84, s2
    s_sub_u32 s84, s84, 1
    v_min_u32 v29, s84, v1
    v_add_u32 v29, s85, v29
    v_lshlrev_b32 v29, 7, v29
    v_add_u32 v29, s86, v29
    s_cmp_lg_u32 s26, 0
    s_cbranch_scc1 L_MTS_4
    v_and_b32 v29, 7, v1
    v_max_u32 v29, 2, v29
    v_and_b32 v31, 56, v1
    v_or_b32 v29, v29, v31
    s_lshl_b32 s85, s2, 6
    v_add_u32 v29, s85, v29
    v_lshlrev_b32 v29, 7, v29
L_MTS_4:
    s_mov_b32 s84, s8
    s_and_b32 s85, s9, 0xffff
    s_mov_b32 s86, 524288
    s_mov_b32 s87, 0x00020000
    s_lshl_b32 s88, s2, 11
    s_mov_b32 s55, 32768
    s_mov_b32 s56, 4294836224
    s_waitcnt vmcnt(0)
    s_cmp_eq_u32 s26, 3
    s_cbranch_scc1 L_NOMT
    buffer_load_dword v29, v29, s[80:83], 0 offen
L_NOMT:
    s_cmp_eq_u32 s42, 0
    s_cbranch_scc0 L_C_Y
    s_barrier
    ds_read_b128 v[32:35], v2
    ds_read_b64_tr_b16 v[224:225], v6 offset:16384
    ds_read_b64_tr_b16 v[226:227], v6 offset:16896
    ds_read_b64_tr_b16 v[228:229], v6 offset:16640
    ds_read_b64_tr_b16 v[230:231], v6 offset:17152
    ds_read_b64_tr_b16 v[232:233], v6 offset:24576
    ds_read_b64_tr_b16 v[234:235], v6 offset:25088
    ds_read_b64_tr_b16 v[236:237], v6 offset:24832
    ds_read_b64_tr_b16 v[238:239], v6 offset:25344
    s_waitcnt lgkmcnt(6)
    v_mfma_f32_32x32x16_bf16 v[160:175], v[224:227], v[32:35], 0
    ds_read_b128 v[36:39], v3
    ds_read_b64_tr_b16 v[240:241], v6 offset:18432
    ds_read_b64_tr_b16 v[242:243], v6 offset:18944
    s_waitcnt lgkmcnt(7)
    v_mfma_f32_32x32x16_bf16 v[176:191], v[228:231], v[32:35], 0
    ds_read_b64_tr_b16 v[244:245], v6 offset:18688
    ds_read_b64_tr_b16 v[246:247], v6 offset:19200
    s_waitcnt lgkmcnt(7)
    v_mfma_f32_32x32x16_bf16 v[192:207], v[232:235], v[32:35], 0
    ds_read_b64_tr_b16 v[248:249], v6 offset:26624
    ds_read_b64_tr_b16 v[250:251], v6 offset:27136
    s_waitcnt lgkmcnt(7)
    v_mfma_f32_32x32x16_bf16 v[208:223], v[236:239], v[32:35], 0
    ds_read_b64_tr_b16 v[252:253], v6 offset:26880
    ds_read_b64_tr_b16 v[254:255], v6 offset:27392
    s_waitcnt lgkmcnt(6)
    v_mfma_f32_32x32x16_bf16 v[160:175], v[240:243], v[36:39], v[160:175]
    ds_read_b128 v[40:43], v4
    ds_read_b64_tr_b16 v[224:225], v6 offset:20480
    ds_read_b64_tr_b16 v[226:227], v6 offset:20992
    s_waitcnt lgkmcnt(7)
    v_mfma_f32_32x32x16_bf16 v[176:191], v[244:247], v[36:39], v[176:191]
    ds_read_b64_tr_b16 v[228:229], v6 offset:20736
    ds_read_b64_tr_b16 v[230:231], v6 offset:21248
    s_waitcnt lgkmcnt(7)
    v_mfma_f32_32x32x16_bf16 v[192:207], v[248:251], v[36:39], v[192:207]
    ds_read_b64_tr_b16 v[232:233], v6 offset:28672
    ds_read_b64_tr_b16 v[234:235], v6 offset:29184
    s_waitcnt lgkmcnt(7)
    v_mfma_f32_32x32x16_bf16 v[208:223], v[252:255], v[36:39], v[208:223]
    ds_read_b64_tr_b16 v[236:237], v6 offset:28928
    ds_read_b64_tr_b16 v[238:239], v6 offset:29440
    s_waitcnt lgkmcnt(6)
    v_mfma_f32_32x32x16_bf16 v[160:175], v[224:227], v[40:43], v[160:175]
    ds_read_b128 v[44:47], v5
    ds_read_b64_tr_b16 v[240:241], v6 offset:22528
    ds_read_b64_tr_b16 v[242:243], v6 offset:23040
    s_waitcnt lgkmcnt(7)
    v_mfma_f32_32x32x16_bf16 v[176:191], v[228:231], v[40:43], v[176:191]
    ds_read_b64_tr_b16 v[244:245], v6 offset:22784
    ds_read_b64_tr_b16 v[246:247], v6 offset:23296
    s_waitcnt lgkmcnt(7)
    v_mfma_f32_32x32x16_bf16 v[192:207], v[232:235], v[40:43], v[192:207]
    ds_read_b64_tr_b16 v[248:249], v6 offset:30720
    ds_read_b64_tr_b16 v[250:251], v6 offset:31232
    s_waitcnt lgkmcnt(7)
    v_mfma_f32_32x32x16_bf16 v[208:223], v[236:239], v[40:43], v[208:223]
    ds_read_b64_tr_b16 v[252:253], v6 offset:30976
    ds_read_b64_tr_b16 v[254:255], v6 offset:31488
    s_waitcnt lgkmcnt(0)
    s_barrier
    v_add_u32 v2, s55, v2
    v_add_u32 v3, s55, v3
    v_add_u32 v4, s55, v4
    v_add_u32 v5, s55, v5
    v_add_u32 v6, s55, v6
    s_cmp_lg_u32 s26, 3
    s_cbranch_scc1 L_MT_5
    buffer_load_dword v29, v29, s[80:83], 0 offen
    v_and_b32 v28, 15, v1
    v_lshlrev_b32 v28, 7, v28
    buffer_load_dword v29, v28, s[84:87], s88 offen
L_MT_5:
    v_mfma_f32_32x32x16_bf16 v[160:175], v[240:243], v[44:47], v[160:175]
    ds_read_b128 v[48:51], v2
    ds_read_b64_tr_b16 v[224:225], v6 offset:16384
    ds_read_b64_tr_b16 v[226:227], v6 offset:16896
    v_mfma_f32_32x32x16_bf16 v[176:191], v[244:247], v[44:47], v[176:191]
    ds_read_b64_tr_b16 v[228:229], v6 offset:16640
    ds_read_b64_tr_b16 v[230:231], v6 offset:17152
    v_mfma_f32_32x32x16_bf16 v[192:207], v[248:251], v[44:47], v[192:207]
    ds_read_b64_tr_b16 v[232:233], v6 offset:24576
    ds_read_b64_tr_b16 v[234:235], v6 offset:25088
    v_mfma_f32_32x32x16_bf16 v[208:223], v[252:255], v[44:47], v[208:223]
    ds_read_b64_tr_b16 v[236:237], v6 offset:24832
    ds_read_b64_tr_b16 v[238:239], v6 offset:25344
    s_waitcnt lgkmcnt(6)
    v_mfma_f32_32x32x16_bf16 v[160:175], v[224:227], v[48:51], v[160:175]
    ds_read_b128 v[52:55], v3
    ds_read_b64_tr_b16 v[240:241], v6 offset:18432
    ds_read_b64_tr_b16 v[242:243], v6 offset:18944
    s_waitcnt lgkmcnt(7)
    v_mfma_f32_32x32x16_bf16 v[176:191], v[228:231], v[48:51], v[176:191]
    ds_read_b64_tr_b16 v[244:245], v6 offset:18688
    ds_read_b64_tr_b16 v[246:247], v6 offset:19200
    s_waitcnt lgkmcnt(7)
    v_mfma_f32_32x32x16_bf16 v[192:207], v[232:235], v[48:51], v[192:207]
    ds_read_b64_tr_b16 v[248:249], v6 offset:26624
    ds_read_b64_tr_b16 v[250:251], v6 offset:27136
    s_waitcnt lgkmcnt(7)
    v_mfma_f32_32x32x16_bf16 v[208:223], v[236:239], v[48:51], v[208:223]
    ds_read_b64_tr_b16 v[252:253], v6 offset:26880
    ds_read_b64_tr_b16 v[254:255], v6 offset:27392
    s_waitcnt lgkmcnt(6)
    v_mfma_f32_32x32x16_bf16 v[160:175], v[240:243], v[52:55], v[160:175]
    ds_read_b128 v[56:59], v4
    ds_read_b64_tr_b16 v[224:225], v6 offset:20480
    ds_read_b64_tr_b16 v[226:227], v6 offset:20992
    s_waitcnt lgkmcnt(7)
    v_mfma_f32_32x32x16_bf16 v[176:191], v[244:247], v[52:55], v[176:191]
    ds_read_b64_tr_b16 v[228:229], v6 offset:20736
    ds_read_b64_tr_b16 v[230:231], v6 offset:21248
    s_waitcnt lgkmcnt(7)
    v_mfma_f32_32x32x16_bf16 v[192:207], v[248:251], v[52:55], v[192:207]
    ds_read_b64_tr_b16 v[232:233], v6 offset:28672
    ds_read_b64_tr_b16 v[234:235], v6 offset:29184
    s_waitcnt lgkmcnt(7)
    v_mfma_f32_32x32x16_bf16 v[208:223], v[252:255], v[52:55], v[208:223]
    ds_read_b64_tr_b16 v[236:237], v6 offset:28928
    ds_read_b64_tr_b16 v[238:239], v6 offset:29440
    s_waitcnt lgkmcnt(6)
    v_mfma_f32_32x32x16_bf16 v[160:175], v[224:227], v[56:59], v[160:175]
    ds_read_b128 v[60:63], v5
    ds_read_b64_tr_b16 v[240:241], v6 offset:22528
    ds_read_b64_tr_b16 v[242:243], v6 offset:23040
    s_waitcnt lgkmcnt(7)
    v_mfma_f32_32x32x16_bf16 v[176:191], v[228:231], v[56:59], v[176:191]
    ds_read_b64_tr_b16 v[244:245], v6 offset:22784
    ds_read_b64_tr_b16 v[246:247], v6 offset:23296
    s_waitcnt lgkmcnt(7)
    v_mfma_f32_32x32x16_bf16 v[192:207], v[232:235], v[56:59], v[192:207]
    ds_read_b64_tr_b16 v[248:249], v6 offset:30720
    ds_read_b64_tr_b16 v[250:251], v6 offset:31232
    s_waitcnt lgkmcnt(7)
    v_mfma_f32_32x32x16_bf16 v[208:223], v[236:239], v[56:59], v[208:223]
    ds_read_b64_tr_b16 v[252:253], v6 offset:30976
    ds_read_b64_tr_b16 v[254:255], v6 offset:31488
    s_waitcnt lgkmcnt(0)
    s_barrier
    v_add_u32 v2, s55, v2
    v_add_u32 v3, s55, v3
    v_add_u32 v4, s55, v4
    v_add_u32 v5, s55, v5
    v_add_u32 v6, s55, v6
    v_mfma_f32_32x32x16_bf16 v[160:175], v[240:243], v[60:63], v[160:175]
    ds_read_b128 v[64:67], v2
    ds_read_b64_tr_b16 v[224:225], v6 offset:16384
    ds_read_b64_tr_b16 v[226:227], v6 offset:16896
    v_mfma_f32_32x32x16_bf16 v[176:191], v[244:247], v[60:63], v[176:191]
    ds_read_b64_tr_b16 v[228:229], v6 offset:16640
    ds_read_b64_tr_b16 v[230:231], v6 offset:17152
    v_mfma_f32_32x32x16_bf16 v[192:207], v[248:251], v[60:63], v[192:207]
    ds_read_b64_tr_b16 v[232:233], v6 offset:24576
    ds_read_b64_tr_b16 v[234:235], v6 offset:25088
    v_mfma_f32_32x32x16_bf16 v[208:223], v[252:255], v[60:63], v[208:223]
    ds_read_b64_tr_b16 v[236:237], v6 offset:24832
    ds_read_b64_tr_b16 v[238:239], v6 offset:25344
    s_waitcnt lgkmcnt(6)
    v_mfma_f32_32x32x16_bf16 v[160:175], v[224:227], v[64:67], v[160:175]
    ds_read_b128 v[68:71], v3
    ds_read_b64_tr_b16 v[240:241], v6 offset:18432
    ds_read_b64_tr_b16 v[242:243], v6 offset:18944
    s_waitcnt lgkmcnt(7)
    v_mfma_f32_32x32x16_bf16 v[176:191], v[228:231], v[64:67], v[176:191]
    ds_read_b64_tr_b16 v[244:245], v6 offset:18688
    ds_read_b64_tr_b16 v[246:247], v6 offset:19200
    s_waitcnt lgkmcnt(7)
    v_mfma_f32_32x32x16_bf16 v[192:207], v[232:235], v[64:67], v[192:207]
    ds_read_b64_tr_b16 v[248:249], v6 offset:26624
    ds_read_b64_tr_b16 v[250:251], v6 offset:27136
    s_waitcnt lgkmcnt(7)
    v_mfma_f32_32x32x16_bf16 v[208:223], v[236:239], v[64:67], v[208:223]
    ds_read_b64_tr_b16 v[252:253], v6 offset:26880
    ds_read_b64_tr_b16 v[254:255], v6 offset:27392
    s_waitcnt lgkmcnt(6)
    v_mfma_f32_32x32x16_bf16 v[160:175], v[240:243], v[68:71], v[160:175]
    ds_read_b128 v[72:75], v4
    ds_read_b64_tr_b16 v[224:225], v6 offset:20480
    ds_read_b64_tr_b16 v[226:227], v6 offset:20992
    s_waitcnt lgkmcnt(7)
    v_mfma_f32_32x32x16_bf16 v[176:191], v[244:247], v[68:71], v[176:191]
    ds_read_b64_tr_b16 v[228:229], v6 offset:20736
    ds_read_b64_tr_b16 v[230:231], v6 offset:21248
    s_waitcnt lgkmcnt(7)
    v_mfma_f32_32x32x16_bf16 v[192:207], v[248:251], v[68:71], v[192:207]
    ds_read_b64_tr_b16 v[232:233], v6 offset:28672
    ds_read_b64_tr_b16 v[234:235], v6 offset:29184
    s_waitcnt lgkmcnt(7)
    v_mfma_f32_32x32x16_bf16 v[208:223], v[252:255], v[68:71], v[208:223]
    ds_read_b64_tr_b16 v[236:237], v6 offset:28928
    ds_read_b64_tr_b16 v[238:239], v6 offset:29440
    s_waitcnt lgkmcnt(6)
    v_mfma_f32_32x32x16_bf16 v[160:175], v[224:227], v[72:75], v[160:175]
    ds_read_b128 v[76:79], v5
    ds_read_b64_tr_b16 v[240:241], v6 offset:22528
    ds_read_b64_tr_b16 v[242:243], v6 offset:23040
    s_waitcnt lgkmcnt(7)
    v_mfma_f32_32x32x16_bf16 v[176:191], v[228:231], v[72:75], v[176:191]
    ds_read_b64_tr_b16 v[244:245], v6 offset:22784
    ds_read_b64_tr_b16 v[246:247], v6 offset:23296
    s_waitcnt lgkmcnt(7)
    v_mfma_f32_32x32x16_bf16 v[192:207], v[232:235], v[72:75], v[192:207]
    ds_read_b64_tr_b16 v[248:249], v6 offset:30720
    ds_read_b64_tr_b16 v[250:251], v6 offset:31232
    s_waitcnt lgkmcnt(7)
    v_mfma_f32_32x32x16_bf16 v[208:223], v[236:239], v[72:75], v[208:223]
    ds_read_b64_tr_b16 v[252:253], v6 offset:30976
    ds_read_b64_tr_b16 v[254:255], v6 offset:31488
    s_waitcnt lgkmcnt(0)
    s_barrier
    v_add_u32 v2, s55, v2
    v_add_u32 v3, s55, v3
    v_add_u32 v4, s55, v4
    v_add_u32 v5, s55, v5
    v_add_u32 v6, s55, v6
    v_mfma_f32_32x32x16_bf16 v[160:175], v[240:243], v[76:79], v[160:175]
    ds_read_b128 v[80:83], v2
    ds_read_b64_tr_b16 v[224:225], v6 offset:16384
    ds_read_b64_tr_b16 v[226:227], v6 offset:16896
    v_mfma_f32_32x32x16_bf16 v[176:191], v[244:247], v[76:79], v[176:191]
    ds_read_b64_tr_b16 v[228:229], v6 offset:16640
    ds_read_b64_tr_b16 v[230:231], v6 offset:17152
    v_mfma_f32_32x32x16_bf16 v[192:207], v[248:251], v[76:79], v[192:207]
    ds_read_b64_tr_b16 v[232:233], v6 offset:24576
    ds_read_b64_tr_b16 v[234:235], v6 offset:25088
    v_mfma_f32_32x32x16_bf16 v[208:223], v[252:255], v[76:79], v[208:223]
    ds_read_b64_tr_b16 v[236:237], v6 offset:24832
    ds_read_b64_tr_b16 v[238:239], v6 offset:25344
    s_waitcnt lgkmcnt(6)
    v_mfma_f32_32x32x16_bf16 v[160:175], v[224:227], v[80:83], v[160:175]
    ds_read_b128 v[84:87], v3
    ds_read_b64_tr_b16 v[240:241], v6 offset:18432
    ds_read_b64_tr_b16 v[242:243], v6 offset:18944
    s_waitcnt lgkmcnt(7)
    v_mfma_f32_32x32x16_bf16 v[176:191], v[228:231], v[80:83], v[176:191]
    ds_read_b64_tr_b16 v[244:245], v6 offset:18688
    ds_read_b64_tr_b16 v[246:247], v6 offset:19200
    s_waitcnt lgkmcnt(7)
    v_mfma_f32_32x32x16_bf16 v[192:207], v[232:235], v[80:83], v[192:207]
    ds_read_b64_tr_b16 v[248:249], v6 offset:26624
    ds_read_b64_tr_b16 v[250:251], v6 offset:27136
    s_waitcnt lgkmcnt(7)
    v_mfma_f32_32x32x16_bf16 v[208:223], v[236:239], v[80:83], v[208:223]
    ds_read_b64_tr_b16 v[252:253], v6 offset:26880
    ds_read_b64_tr_b16 v[254:255], v6 offset:27392
    s_waitcnt lgkmcnt(6)
    v_mfma_f32_32x32x16_bf16 v[160:175], v[240:243], v[84:87], v[160:175]
    ds_read_b128 v[88:91], v4
    ds_read_b64_tr_b16 v[224:225], v6 offset:20480
    ds_read_b64_tr_b16 v[226:227], v6 offset:20992
    s_waitcnt lgkmcnt(7)
    v_mfma_f32_32x32x16_bf16 v[176:191], v[244:247], v[84:87], v[176:191]
    ds_read_b64_tr_b16 v[228:229], v6 offset:20736
    ds_read_b64_tr_b16 v[230:231], v6 offset:21248
    s_waitcnt lgkmcnt(7)
    v_mfma_f32_32x32x16_bf16 v[192:207], v[248:251], v[84:87], v[192:207]
    ds_read_b64_tr_b16 v[232:233], v6 offset:28672
    ds_read_b64_tr_b16 v[234:235], v6 offset:29184
    s_waitcnt lgkmcnt(7)
    v_mfma_f32_32x32x16_bf16 v[208:223], v[252:255], v[84:87], v[208:223]
    ds_read_b64_tr_b16 v[236:237], v6 offset:28928
    ds_read_b64_tr_b16 v[238:239], v6 offset:29440
    s_waitcnt lgkmcnt(6)
    v_mfma_f32_32x32x16_bf16 v[160:175], v[224:227], v[88:91], v[160:175]
    ds_read_b128 v[92:95], v5
    ds_read_b64_tr_b16 v[240:241], v6 offset:22528
    ds_read_b64_tr_b16 v[242:243], v6 offset:23040
    s_waitcnt lgkmcnt(7)
    v_mfma_f32_32x32x16_bf16 v[176:191], v[228:231], v[88:91], v[176:191]
    ds_read_b64_tr_b16 v[244:245], v6 offset:22784
    ds_read_b64_tr_b16 v[246:247], v6 offset:23296
    s_waitcnt lgkmcnt(7)
    v_mfma_f32_32x32x16_bf16 v[192:207], v[232:235], v[88:91], v[192:207]
    ds_read_b64_tr_b16 v[248:249], v6 offset:30720
    ds_read_b64_tr_b16 v[250:251], v6 offset:31232
    s_waitcnt lgkmcnt(7)
    v_mfma_f32_32x32x16_bf16 v[208:223], v[236:239], v[88:91], v[208:223]
    ds_read_b64_tr_b16 v[252:253], v6 offset:30976
    ds_read_b64_tr_b16 v[254:255], v6 offset:31488
    s_waitcnt lgkmcnt(0)
    s_barrier
    v_add_u32 v2, s55, v2
    v_add_u32 v3, s55, v3
    v_add_u32 v4, s55, v4
    v_add_u32 v5, s55, v5
    v_add_u32 v6, s55, v6
    buffer_load_dwordx2 v[30:31], v7, s[72:75], 0 offen sc1
    v_mfma_f32_32x32x16_bf16 v[160:175], v[240:243], v[92:95], v[160:175]
    ds_read_b128 v[96:99], v2
    ds_read_b64_tr_b16 v[224:225], v6 offset:16384
    ds_read_b64_tr_b16 v[226:227], v6 offset:16896
    v_mfma_f32_32x32x16_bf16 v[176:191], v[244:247], v[92:95], v[176:191]
    ds_read_b64_tr_b16 v[228:229], v6 offset:16640
    ds_read_b64_tr_b16 v[230:231], v6 offset:17152
    v_mfma_f32_32x32x16_bf16 v[192:207], v[248:251], v[92:95], v[192:207]
    ds_read_b64_tr_b16 v[232:233], v6 offset:24576
    ds_read_b64_tr_b16 v[234:235], v6 offset:25088
    v_mfma_f32_32x32x16_bf16 v[208:223], v[252:255], v[92:95], v[208:223]
    ds_read_b64_tr_b16 v[236:237], v6 offset:24832
    ds_read_b64_tr_b16 v[238:239], v6 offset:25344
    s_waitcnt lgkmcnt(6)
    v_mfma_f32_32x32x16_bf16 v[160:175], v[224:227], v[96:99], v[160:175]
    ds_read_b128 v[100:103], v3
    ds_read_b64_tr_b16 v[240:241], v6 offset:18432
    ds_read_b64_tr_b16 v[242:243], v6 offset:18944
    s_waitcnt lgkmcnt(7)
    v_mfma_f32_32x32x16_bf16 v[176:191], v[228:231], v[96:99], v[176:191]
    ds_read_b64_tr_b16 v[244:245], v6 offset:18688
    ds_read_b64_tr_b16 v[246:247], v6 offset:19200
    s_waitcnt lgkmcnt(7)
    v_mfma_f32_32x32x16_bf16 v[192:207], v[232:235], v[96:99], v[192:207]
    ds_read_b64_tr_b16 v[248:249], v6 offset:26624
    ds_read_b64_tr_b16 v[250:251], v6 offset:27136
    s_waitcnt lgkmcnt(7)
    v_mfma_f32_32x32x16_bf16 v[208:223], v[236:239], v[96:99], v[208:223]
    ds_read_b64_tr_b16 v[252:253], v6 offset:26880
    ds_read_b64_tr_b16 v[254:255], v6 offset:27392
    s_waitcnt lgkmcnt(6)
    v_mfma_f32_32x32x16_bf16 v[160:175], v[240:243], v[100:103], v[160:175]
    ds_read_b128 v[104:107], v4
    ds_read_b64_tr_b16 v[224:225], v6 offset:20480
    ds_read_b64_tr_b16 v[226:227], v6 offset:20992
    s_waitcnt lgkmcnt(7)
    v_mfma_f32_32x32x16_bf16 v[176:191], v[244:247], v[100:103], v[176:191]
    ds_read_b64_tr_b16 v[228:229], v6 offset:20736
    ds_read_b64_tr_b16 v[230:231], v6 offset:21248
    s_waitcnt lgkmcnt(7)
    v_mfma_f32_32x32x16_bf16 v[192:207], v[248:251], v[100:103], v[192:207]
    ds_read_b64_tr_b16 v[232:233], v6 offset:28672
    ds_read_b64_tr_b16 v[234:235], v6 offset:29184
    s_waitcnt lgkmcnt(7)
    v_mfma_f32_32x32x16_bf16 v[208:223], v[252:255], v[100:103], v[208:223]
    ds_read_b64_tr_b16 v[236:237], v6 offset:28928
    ds_read_b64_tr_b16 v[238:239], v6 offset:29440
    s_waitcnt lgkmcnt(6)
    v_mfma_f32_32x32x16_bf16 v[160:175], v[224:227], v[104:107], v[160:175]
    ds_read_b128 v[108:111], v5
    ds_read_b64_tr_b16 v[240:241], v6 offset:22528
    ds_read_b64_tr_b16 v[242:243], v6 offset:23040
    s_waitcnt lgkmcnt(7)
    v_mfma_f32_32x32x16_bf16 v[176:191], v[228:231], v[104:107], v[176:191]
    ds_read_b64_tr_b16 v[244:245], v6 offset:22784
    ds_read_b64_tr_b16 v[246:247], v6 offset:23296
    s_waitcnt lgkmcnt(7)
    v_mfma_f32_32x32x16_bf16 v[192:207], v[232:235], v[104:107], v[192:207]
    ds_read_b64_tr_b16 v[248:249], v6 offset:30720
    ds_read_b64_tr_b16 v[250:251], v6 offset:31232
    s_waitcnt lgkmcnt(7)
    v_mfma_f32_32x32x16_bf16 v[208:223], v[236:239], v[104:107], v[208:223]
    ds_read_b64_tr_b16 v[252:253], v6 offset:30976
    ds_read_b64_tr_b16 v[254:255], v6 offset:31488
    s_waitcnt lgkmcnt(0)
    s_barrier
    v_add_u32 v2, s56, v2
    v_add_u32 v3, s56, v3
    v_add_u32 v4, s56, v4
    v_add_u32 v5, s56, v5
    v_add_u32 v6, s56, v6
    v_lshlrev_b32 v18, 3, v9
    buffer_load_dwordx2 v[10:11], v18, s[92:95], s89 offen offset:0
    buffer_load_dwordx2 v[14:15], v18, s[92:95], s89 offen offset:16
    buffer_load_dwordx2 v[16:17], v18, s[92:95], s89 offen offset:32
    buffer_load_dwordx2 v[18:19], v18, s[92:95], s89 offen offset:48
    v_mfma_f32_32x32x16_bf16 v[160:175], v[240:243], v[108:111], v[160:175]
    ds_read_b128 v[112:115], v2
    ds_read_b64_tr_b16 v[224:225], v6 offset:16384
    ds_read_b64_tr_b16 v[226:227], v6 offset:16896
    v_mfma_f32_32x32x16_bf16 v[176:191], v[244:247], v[108:111], v[176:191]
    ds_read_b64_tr_b16 v[228:229], v6 offset:16640
    ds_read_b64_tr_b16 v[230:231], v6 offset:17152
    v_mfma_f32_32x32x16_bf16 v[192:207], v[248:251], v[108:111], v[192:207]
    ds_read_b64_tr_b16 v[232:233], v6 offset:24576
    ds_read_b64_tr_b16 v[234:235], v6 offset:25088
    v_mfma_f32_32x32x16_bf16 v[208:223], v[252:255], v[108:111], v[208:223]
    ds_read_b64_tr_b16 v[236:237], v6 offset:24832
    ds_read_b64_tr_b16 v[238:239], v6 offset:25344
    s_waitcnt lgkmcnt(6)
    v_mfma_f32_32x32x16_bf16 v[160:175], v[224:227], v[112:115], v[160:175]
    ds_read_b128 v[116:119], v3
    ds_read_b64_tr_b16 v[240:241], v6 offset:18432
    ds_read_b64_tr_b16 v[242:243], v6 offset:18944
    s_waitcnt lgkmcnt(7)
    v_mfma_f32_32x32x16_bf16 v[176:191], v[228:231], v[112:115], v[176:191]
    ds_read_b64_tr_b16 v[244:245], v6 offset:18688
    ds_read_b64_tr_b16 v[246:247], v6 offset:19200
    s_waitcnt lgkmcnt(7)
    v_mfma_f32_32x32x16_bf16 v[192:207], v[232:235], v[112:115], v[192:207]
    ds_read_b64_tr_b16 v[248:249], v6 offset:26624
    ds_read_b64_tr_b16 v[250:251], v6 offset:27136
    s_waitcnt lgkmcnt(7)
    v_mfma_f32_32x32x16_bf16 v[208:223], v[236:239], v[112:115], v[208:223]
    ds_read_b64_tr_b16 v[252:253], v6 offset:26880
    ds_read_b64_tr_b16 v[254:255], v6 offset:27392
    s_waitcnt lgkmcnt(6)
    v_mfma_f32_32x32x16_bf16 v[160:175], v[240:243], v[116:119], v[160:175]
    ds_read_b128 v[120:123], v4
    ds_read_b64_tr_b16 v[224:225], v6 offset:20480
    ds_read_b64_tr_b16 v[226:227], v6 offset:20992
    s_waitcnt lgkmcnt(7)
    v_mfma_f32_32x32x16_bf16 v[176:191], v[244:247], v[116:119], v[176:191]
    ds_read_b64_tr_b16 v[228:229], v6 offset:20736
    ds_read_b64_tr_b16 v[230:231], v6 offset:21248
    s_waitcnt lgkmcnt(7)
    v_mfma_f32_32x32x16_bf16 v[192:207], v[248:251], v[116:119], v[192:207]
    ds_read_b64_tr_b16 v[232:233], v6 offset:28672
    ds_read_b64_tr_b16 v[234:235], v6 offset:29184
    s_waitcnt lgkmcnt(7)
    v_mfma_f32_32x32x16_bf16 v[208:223], v[252:255], v[116:119], v[208:223]
    ds_read_b64_tr_b16 v[236:237], v6 offset:28928
    ds_read_b64_tr_b16 v[238:239], v6 offset:29440
    s_waitcnt lgkmcnt(6)
    v_mfma_f32_32x32x16_bf16 v[160:175], v[224:227], v[120:123], v[160:175]
    ds_read_b128 v[124:127], v5
    ds_read_b64_tr_b16 v[240:241], v6 offset:22528
    ds_read_b64_tr_b16 v[242:243], v6 offset:23040
    s_waitcnt lgkmcnt(7)
    v_mfma_f32_32x32x16_bf16 v[176:191], v[228:231], v[120:123], v[176:191]
    ds_read_b64_tr_b16 v[244:245], v6 offset:22784
    ds_read_b64_tr_b16 v[246:247], v6 offset:23296
    s_waitcnt lgkmcnt(7)
    v_mfma_f32_32x32x16_bf16 v[192:207], v[232:235], v[120:123], v[192:207]
    ds_read_b64_tr_b16 v[248:249], v6 offset:30720
    ds_read_b64_tr_b16 v[250:251], v6 offset:31232
    s_waitcnt lgkmcnt(7)
    v_mfma_f32_32x32x16_bf16 v[208:223], v[236:239], v[120:123], v[208:223]
    ds_read_b64_tr_b16 v[252:253], v6 offset:30976
    ds_read_b64_tr_b16 v[254:255], v6 offset:31488
    s_waitcnt lgkmcnt(0)
    s_barrier
    v_add_u32 v2, s55, v2
    v_add_u32 v3, s55, v3
    v_add_u32 v4, s55, v4
    v_add_u32 v5, s55, v5
    v_add_u32 v6, s55, v6
    v_lshlrev_b32 v26, 3, v9
    buffer_load_dwordx2 v[20:21], v26, s[92:95], s89 offen offset:64
    buffer_load_dwordx2 v[22:23], v26, s[92:95], s89 offen offset:80
    buffer_load_dwordx2 v[24:25], v26, s[92:95], s89 offen offset:96
    buffer_load_dwordx2 v[26:27], v26, s[92:95], s89 offen offset:112
    v_mfma_f32_32x32x16_bf16 v[160:175], v[240:243], v[124:127], v[160:175]
    ds_read_b128 v[128:131], v2
    ds_read_b64_tr_b16 v[224:225], v6 offset:16384
    ds_read_b64_tr_b16 v[226:227], v6 offset:16896
    v_mfma_f32_32x32x16_bf16 v[176:191], v[244:247], v[124:127], v[176:191]
    ds_read_b64_tr_b16 v[228:229], v6 offset:16640
    ds_read_b64_tr_b16 v[230:231], v6 offset:17152
    v_mfma_f32_32x32x16_bf16 v[192:207], v[248:251], v[124:127], v[192:207]
    ds_read_b64_tr_b16 v[232:233], v6 offset:24576
    ds_read_b64_tr_b16 v[234:235], v6 offset:25088
    v_mfma_f32_32x32x16_bf16 v[208:223], v[252:255], v[124:127], v[208:223]
    ds_read_b64_tr_b16 v[236:237], v6 offset:24832
    ds_read_b64_tr_b16 v[238:239], v6 offset:25344
    s_waitcnt lgkmcnt(6)
    v_mfma_f32_32x32x16_bf16 v[160:175], v[224:227], v[128:131], v[160:175]
    ds_read_b128 v[132:135], v3
    ds_read_b64_tr_b16 v[240:241], v6 offset:18432
    ds_read_b64_tr_b16 v[242:243], v6 offset:18944
    s_waitcnt lgkmcnt(7)
    v_mfma_f32_32x32x16_bf16 v[176:191], v[228:231], v[128:131], v[176:191]
    ds_read_b64_tr_b16 v[244:245], v6 offset:18688
    ds_read_b64_tr_b16 v[246:247], v6 offset:19200
    s_waitcnt lgkmcnt(7)
    v_mfma_f32_32x32x16_bf16 v[192:207], v[232:235], v[128:131], v[192:207]
    ds_read_b64_tr_b16 v[248:249], v6 offset:26624
    ds_read_b64_tr_b16 v[250:251], v6 offset:27136
    s_waitcnt lgkmcnt(7)
    v_mfma_f32_32x32x16_bf16 v[208:223], v[236:239], v[128:131], v[208:223]
    ds_read_b64_tr_b16 v[252:253], v6 offset:26880
    ds_read_b64_tr_b16 v[254:255], v6 offset:27392
    s_waitcnt lgkmcnt(6)
    v_mfma_f32_32x32x16_bf16 v[160:175], v[240:243], v[132:135], v[160:175]
    ds_read_b128 v[136:139], v4
    ds_read_b64_tr_b16 v[224:225], v6 offset:20480
    ds_read_b64_tr_b16 v[226:227], v6 offset:20992
    s_waitcnt lgkmcnt(7)
    v_mfma_f32_32x32x16_bf16 v[176:191], v[244:247], v[132:135], v[176:191]
    ds_read_b64_tr_b16 v[228:229], v6 offset:20736
    ds_read_b64_tr_b16 v[230:231], v6 offset:21248
    s_waitcnt lgkmcnt(7)
    v_mfma_f32_32x32x16_bf16 v[192:207], v[248:251], v[132:135], v[192:207]
    ds_read_b64_tr_b16 v[232:233], v6 offset:28672
    ds_read_b64_tr_b16 v[234:235], v6 offset:29184
    s_waitcnt lgkmcnt(7)
    v_mfma_f32_32x32x16_bf16 v[208:223], v[252:255], v[132:135], v[208:223]
    ds_read_b64_tr_b16 v[236:237], v6 offset:28928
    ds_read_b64_tr_b16 v[238:239], v6 offset:29440
    s_waitcnt lgkmcnt(6)
    v_mfma_f32_32x32x16_bf16 v[160:175], v[224:227], v[136:139], v[160:175]
    ds_read_b128 v[140:143], v5
    ds_read_b64_tr_b16 v[240:241], v6 offset:22528
    ds_read_b64_tr_b16 v[242:243], v6 offset:23040
    s_waitcnt lgkmcnt(7)
    v_mfma_f32_32x32x16_bf16 v[176:191], v[228:231], v[136:139], v[176:191]
    ds_read_b64_tr_b16 v[244:245], v6 offset:22784
    ds_read_b64_tr_b16 v[246:247], v6 offset:23296
    s_waitcnt lgkmcnt(7)
    v_mfma_f32_32x32x16_bf16 v[192:207], v[232:235], v[136:139], v[192:207]
    ds_read_b64_tr_b16 v[248:249], v6 offset:30720
    ds_read_b64_tr_b16 v[250:251], v6 offset:31232
    s_waitcnt lgkmcnt(7)
    v_mfma_f32_32x32x16_bf16 v[208:223], v[236:239], v[136:139], v[208:223]
    ds_read_b64_tr_b16 v[252:253], v6 offset:30976
    ds_read_b64_tr_b16 v[254:255], v6 offset:31488
    s_waitcnt lgkmcnt(0)
    s_barrier
    v_add_u32 v2, s55, v2
    v_add_u32 v3, s55, v3
    v_add_u32 v4, s55, v4
    v_add_u32 v5, s55, v5
    v_add_u32 v6, s55, v6
    v_mfma_f32_32x32x16_bf16 v[160:175], v[240:243], v[140:143], v[160:175]
    ds_read_b128 v[144:147], v2
    ds_read_b64_tr_b16 v[224:225], v6 offset:16384
    ds_read_b64_tr_b16 v[226:227], v6 offset:16896
    v_mfma_f32_32x32x16_bf16 v[176:191], v[244:247], v[140:143], v[176:191]
    ds_read_b64_tr_b16 v[228:229], v6 offset:16640
    ds_read_b64_tr_b16 v[230:231], v6 offset:17152
    v_mfma_f32_32x32x16_bf16 v[192:207], v[248:251], v[140:143], v[192:207]
    ds_read_b64_tr_b16 v[232:233], v6 offset:24576
    ds_read_b64_tr_b16 v[234:235], v6 offset:25088
    v_mfma_f32_32x32x16_bf16 v[208:223], v[252:255], v[140:143], v[208:223]
    ds_read_b64_tr_b16 v[236:237], v6 offset:24832
    ds_read_b64_tr_b16 v[238:239], v6 offset:25344
    s_waitcnt lgkmcnt(6)
    v_mfma_f32_32x32x16_bf16 v[160:175], v[224:227], v[144:147], v[160:175]
    ds_read_b128 v[148:151], v3
    ds_read_b64_tr_b16 v[240:241], v6 offset:18432
    ds_read_b64_tr_b16 v[242:243], v6 offset:18944
    s_waitcnt lgkmcnt(7)
    v_mfma_f32_32x32x16_bf16 v[176:191], v[228:231], v[144:147], v[176:191]
    ds_read_b64_tr_b16 v[244:245], v6 offset:18688
    ds_read_b64_tr_b16 v[246:247], v6 offset:19200
    s_waitcnt lgkmcnt(7)
    v_mfma_f32_32x32x16_bf16 v[192:207], v[232:235], v[144:147], v[192:207]
    ds_read_b64_tr_b16 v[248:249], v6 offset:26624
    ds_read_b64_tr_b16 v[250:251], v6 offset:27136
    s_waitcnt lgkmcnt(7)
    v_mfma_f32_32x32x16_bf16 v[208:223], v[236:239], v[144:147], v[208:223]
    ds_read_b64_tr_b16 v[252:253], v6 offset:26880
    ds_read_b64_tr_b16 v[254:255], v6 offset:27392
    s_waitcnt lgkmcnt(6)
    v_mfma_f32_32x32x16_bf16 v[160:175], v[240:243], v[148:151], v[160:175]
    ds_read_b128 v[152:155], v4
    ds_read_b64_tr_b16 v[224:225], v6 offset:20480
    ds_read_b64_tr_b16 v[226:227], v6 offset:20992
    s_waitcnt lgkmcnt(7)
    v_mfma_f32_32x32x16_bf16 v[176:191], v[244:247], v[148:151], v[176:191]
    ds_read_b64_tr_b16 v[228:229], v6 offset:20736
    ds_read_b64_tr_b16 v[230:231], v6 offset:21248
    s_waitcnt lgkmcnt(7)
    v_mfma_f32_32x32x16_bf16 v[192:207], v[248:251], v[148:151], v[192:207]
    ds_read_b64_tr_b16 v[232:233], v6 offset:28672
    ds_read_b64_tr_b16 v[234:235], v6 offset:29184
    s_waitcnt lgkmcnt(7)
    v_mfma_f32_32x32x16_bf16 v[208:223], v[252:255], v[148:151], v[208:223]
    ds_read_b64_tr_b16 v[236:237], v6 offset:28928
    ds_read_b64_tr_b16 v[238:239], v6 offset:29440
    s_waitcnt lgkmcnt(6)
    v_mfma_f32_32x32x16_bf16 v[160:175], v[224:227], v[152:155], v[160:175]
    ds_read_b128 v[156:159], v5
    ds_read_b64_tr_b16 v[240:241], v6 offset:22528
    ds_read_b64_tr_b16 v[242:243], v6 offset:23040
    s_waitcnt lgkmcnt(7)
    v_mfma_f32_32x32x16_bf16 v[176:191], v[228:231], v[152:155], v[176:191]
    ds_read_b64_tr_b16 v[244:245], v6 offset:22784
    ds_read_b64_tr_b16 v[246:247], v6 offset:23296
    s_waitcnt lgkmcnt(7)
    v_mfma_f32_32x32x16_bf16 v[192:207], v[232:235], v[152:155], v[192:207]
    ds_read_b64_tr_b16 v[248:249], v6 offset:30720
    ds_read_b64_tr_b16 v[250:251], v6 offset:31232
    s_waitcnt lgkmcnt(7)
    v_mfma_f32_32x32x16_bf16 v[208:223], v[236:239], v[152:155], v[208:223]
    ds_read_b64_tr_b16 v[252:253], v6 offset:30976
    ds_read_b64_tr_b16 v[254:255], v6 offset:31488
    s_waitcnt lgkmcnt(0)
    v_add_u32 v6, s55, v6
    v_mfma_f32_32x32x16_bf16 v[160:175], v[240:243], v[156:159], v[160:175]
    v_mfma_f32_32x32x16_bf16 v[176:191], v[244:247], v[156:159], v[176:191]
    v_mfma_f32_32x32x16_bf16 v[192:207], v[248:251], v[156:159], v[192:207]
    v_mfma_f32_32x32x16_bf16 v[208:223], v[252:255], v[156:159], v[208:223]
    s_waitcnt vmcnt(0)
    v_cmp_eq_u64 vcc, 0, v[30:31]
    s_nop 5
    s_cmp_eq_u64 vcc, 0
    s_cselect_b32 s54, 0, 2
    v_cvt_pk_bf16_f32 v240, v160, v161
    v_cvt_pk_bf16_f32 v241, v162, v163
    v_cvt_pk_bf16_f32 v242, v164, v165
    v_cvt_pk_bf16_f32 v243, v166, v167
    v_cvt_pk_bf16_f32 v244, v168, v169
    v_cvt_pk_bf16_f32 v245, v170, v171
    v_cvt_pk_bf16_f32 v246, v172, v173
    v_cvt_pk_bf16_f32 v247, v174, v175
    s_add_u32 s38, s57, 2097152
    s_add_u32 s39, s57, 2162688
    buffer_store_dwordx4 v[240:243], v12, s[28:31], s38 offen sc1
    buffer_store_dwordx4 v[244:247], v12, s[28:31], s39 offen sc1
    v_cvt_pk_bf16_f32 v248, v176, v177
    v_cvt_pk_bf16_f32 v249, v178, v179
    v_cvt_pk_bf16_f32 v250, v180, v181
    v_cvt_pk_bf16_f32 v251, v182, v183
    v_cvt_pk_bf16_f32 v252, v184, v185
    v_cvt_pk_bf16_f32 v253, v186, v187
    v_cvt_pk_bf16_f32 v254, v188, v189
    v_cvt_pk_bf16_f32 v255, v190, v191
    s_add_u32 s38, s57, 2228224
    s_add_u32 s39, s57, 2293760
    buffer_store_dwordx4 v[248:251], v12, s[28:31], s38 offen sc1
    buffer_store_dwordx4 v[252:255], v12, s[28:31], s39 offen sc1
    v_mov_b32 v28, 0x3eb8aa3b
    v_mov_b32 v29, 0x3eb8aa3b
    v_mul_f32 v192, v192, v28
    v_mul_f32 v193, v193, v28
    v_mul_f32 v194, v194, v28
    v_mul_f32 v195, v195, v28
    v_mul_f32 v196, v196, v28
    v_mul_f32 v197, v197, v28
    v_mul_f32 v198, v198, v28
    v_mul_f32 v199, v199, v28
    v_mul_f32 v200, v200, v28
    v_mul_f32 v201, v201, v28
    v_mul_f32 v202, v202, v28
    v_mul_f32 v203, v203, v28
    v_mul_f32 v204, v204, v28
    v_mul_f32 v205, v205, v28
    v_mul_f32 v206, v206, v28
    v_mul_f32 v207, v207, v28
    v_cvt_pk_bf16_f32 v192, v192, v193
    v_cvt_pk_bf16_f32 v193, v194, v195
    v_cvt_pk_bf16_f32 v194, v196, v197
    v_cvt_pk_bf16_f32 v195, v198, v199
    v_cvt_pk_bf16_f32 v196, v200, v201
    v_cvt_pk_bf16_f32 v197, v202, v203
    v_cvt_pk_bf16_f32 v198, v204, v205
    v_cvt_pk_bf16_f32 v199, v206, v207
    s_add_u32 s38, s57, 0
    s_add_u32 s39, s57, 65536
    buffer_store_dwordx4 v[192:195], v12, s[28:31], s38 offen sc1
    buffer_store_dwordx4 v[196:199], v12, s[28:31], s39 offen sc1
    v_mul_f32 v208, v208, v28
    v_mul_f32 v209, v209, v28
    v_mul_f32 v210, v210, v28
    v_mul_f32 v211, v211, v28
    v_mul_f32 v212, v212, v28
    v_mul_f32 v213, v213, v28
    v_mul_f32 v214, v214, v28
    v_mul_f32 v215, v215, v28
    v_mul_f32 v216, v216, v28
    v_mul_f32 v217, v217, v28
    v_mul_f32 v218, v218, v28
    v_mul_f32 v219, v219, v28
    v_mul_f32 v220, v220, v28
    v_mul_f32 v221, v221, v28
    v_mul_f32 v222, v222, v28
    v_mul_f32 v223, v223, v28
    v_cvt_pk_bf16_f32 v208, v208, v209
    v_cvt_pk_bf16_f32 v209, v210, v211
    v_cvt_pk_bf16_f32 v210, v212, v213
    v_cvt_pk_bf16_f32 v211, v214, v215
    v_cvt_pk_bf16_f32 v212, v216, v217
    v_cvt_pk_bf16_f32 v213, v218, v219
    v_cvt_pk_bf16_f32 v214, v220, v221
    v_cvt_pk_bf16_f32 v215, v222, v223
    s_add_u32 s38, s57, 131072
    s_add_u32 s39, s57, 196608
    buffer_store_dwordx4 v[208:211], v12, s[28:31], s38 offen sc1
    buffer_store_dwordx4 v[212:215], v12, s[28:31], s39 offen sc1
    v_lshlrev_b32 v160, 16, v10
    v_and_b32 v161, 0xffff0000, v10
    v_lshlrev_b32 v162, 16, v11
    v_and_b32 v163, 0xffff0000, v11
    v_lshlrev_b32 v164, 16, v14
    v_and_b32 v165, 0xffff0000, v14
    v_lshlrev_b32 v166, 16, v15
    v_and_b32 v167, 0xffff0000, v15
    v_lshlrev_b32 v168, 16, v16
    v_and_b32 v169, 0xffff0000, v16
    v_lshlrev_b32 v170, 16, v17
    v_and_b32 v171, 0xffff0000, v17
    v_lshlrev_b32 v172, 16, v18
    v_and_b32 v173, 0xffff0000, v18
    v_lshlrev_b32 v174, 16, v19
    v_and_b32 v175, 0xffff0000, v19
    v_lshlrev_b32 v176, 16, v20
    v_and_b32 v177, 0xffff0000, v20
    v_lshlrev_b32 v178, 16, v21
    v_and_b32 v179, 0xffff0000, v21
    v_lshlrev_b32 v180, 16, v22
    v_and_b32 v181, 0xffff0000, v22
    v_lshlrev_b32 v182, 16, v23
    v_and_b32 v183, 0xffff0000, v23
    v_lshlrev_b32 v184, 16, v24
    v_and_b32 v185, 0xffff0000, v24
    v_lshlrev_b32 v186, 16, v25
    v_and_b32 v187, 0xffff0000, v25
    v_lshlrev_b32 v188, 16, v26
    v_and_b32 v189, 0xffff0000, v26
    v_lshlrev_b32 v190, 16, v27
    v_and_b32 v191, 0xffff0000, v27
    s_lshl_b32 s46, s26, 4
    s_add_u32 s46, s46, 128
    v_mov_b32 v2, s46
    v_mov_b32 v3, s97
    ds_write_b64 v2, v[30:31]
    ds_write_b32 v2, v3 offset:8
    s_waitcnt lgkmcnt(0)
    s_barrier
    ds_read_b64_tr_b16 v[224:225], v6 offset:0
    ds_read_b64_tr_b16 v[226:227], v6 offset:512
    ds_read_b64_tr_b16 v[228:229], v6 offset:256
    ds_read_b64_tr_b16 v[230:231], v6 offset:768
    ds_read_b64_tr_b16 v[232:233], v6 offset:2048
    ds_read_b64_tr_b16 v[234:235], v6 offset:2560
    ds_read_b64_tr_b16 v[236:237], v6 offset:2304
    ds_read_b64_tr_b16 v[238:239], v6 offset:2816
    s_nop 0
    s_waitcnt lgkmcnt(6)
    v_mfma_f32_32x32x16_bf16 v[160:175], v[224:227], v[32:35], v[160:175]
    ds_read_b64_tr_b16 v[240:241], v6 offset:4096
    ds_read_b64_tr_b16 v[242:243], v6 offset:4608
    s_mov_b32 s36, s16
    s_and_b32 s37, s17, 0xffff
    s_waitcnt lgkmcnt(6)
    v_mfma_f32_32x32x16_bf16 v[176:191], v[228:231], v[32:35], v[176:191]
    ds_read_b64_tr_b16 v[244:245], v6 offset:4352
    ds_read_b64_tr_b16 v[246:247], v6 offset:4864
    s_mov_b32 s38, 1409024
    s_mov_b32 s39, 0x00020000
    s_waitcnt lgkmcnt(6)
    v_mfma_f32_32x32x16_bf16 v[160:175], v[232:235], v[36:39], v[160:175]
    ds_read_b64_tr_b16 v[224:225], v6 offset:6144
    ds_read_b64_tr_b16 v[226:227], v6 offset:6656
    v_and_b32 v2, 15, v1
    v_lshrrev_b32 v2, 2, v2
    s_waitcnt lgkmcnt(6)
    v_mfma_f32_32x32x16_bf16 v[176:191], v[236:239], v[36:39], v[176:191]
    ds_read_b64_tr_b16 v[228:229], v6 offset:6400
    ds_read_b64_tr_b16 v[230:231], v6 offset:6912
    v_lshrrev_b32 v3, 5, v1
    v_lshl_add_u32 v2, v3, 2, v2
    s_waitcnt lgkmcnt(6)
    v_mfma_f32_32x32x16_bf16 v[160:175], v[240:243], v[40:43], v[160:175]
    ds_read_b64_tr_b16 v[232:233], v6 offset:8192
    ds_read_b64_tr_b16 v[234:235], v6 offset:8704
    v_mul_u32_u24 v4, 1024, v2
    v_bfe_u32 v3, v1, 4, 1
    s_waitcnt lgkmcnt(6)
    v_mfma_f32_32x32x16_bf16 v[176:191], v[244:247], v[40:43], v[176:191]
    ds_read_b64_tr_b16 v[236:237], v6 offset:8448
    ds_read_b64_tr_b16 v[238:239], v6 offset:8960
    v_lshl_add_u32 v4, v3, 6, v4
    v_and_b32 v3, 3, v1
    s_waitcnt lgkmcnt(6)
    v_mfma_f32_32x32x16_bf16 v[160:175], v[224:227], v[44:47], v[160:175]
    ds_read_b64_tr_b16 v[240:241], v6 offset:10240
    ds_read_b64_tr_b16 v[242:243], v6 offset:10752
    v_lshl_add_u32 v4, v3, 4, v4
    s_lshl_b32 s48, s33, 7
    s_waitcnt lgkmcnt(6)
    v_mfma_f32_32x32x16_bf16 v[176:191], v[228:231], v[44:47], v[176:191]
    ds_read_b64_tr_b16 v[244:245], v6 offset:10496
    ds_read_b64_tr_b16 v[246:247], v6 offset:11008
    v_add_u32 v4, s48, v4
    v_add_u32 v5, 7168, v4
    s_waitcnt lgkmcnt(6)
    v_mfma_f32_32x32x16_bf16 v[160:175], v[232:235], v[48:51], v[160:175]
    ds_read_b64_tr_b16 v[224:225], v6 offset:12288
    ds_read_b64_tr_b16 v[226:227], v6 offset:12800
    s_lshl_b32 s62, s26, 11
    s_add_u32 s62, s62, 98304
    s_waitcnt lgkmcnt(6)
    v_mfma_f32_32x32x16_bf16 v[176:191], v[236:239], v[48:51], v[176:191]
    ds_read_b64_tr_b16 v[228:229], v6 offset:12544
    ds_read_b64_tr_b16 v[230:231], v6 offset:13056
    s_mov_b32 s76, 0
    s_lshl_b32 s58, s26, 14
    s_waitcnt lgkmcnt(6)
    v_mfma_f32_32x32x16_bf16 v[160:175], v[240:243], v[52:55], v[160:175]
    ds_read_b64_tr_b16 v[232:233], v6 offset:14336
    ds_read_b64_tr_b16 v[234:235], v6 offset:14848
    s_add_u32 s59, s58, 1441792
    s_and_b32 s46, s32, 3
    s_mul_i32 s46, s46, 5
    s_cmp_eq_u32 s33, 3
    s_cselect_b32 s46, s46, 0
    s_mul_i32 s63, s27, 0
    s_add_u32 s63, s63, s46
    s_sub_u32 s46, s63, 22
    s_cmp_ge_u32 s63, 22
    s_cselect_b32 s63, s46, s63
    s_add_u32 s63, s63, 7
    s_sub_u32 s46, s63, 22
    s_cmp_ge_u32 s63, 22
    s_cselect_b32 s63, s46, s63
    s_lshl_b32 s63, s63, 16
    s_add_u32 s63, s63, s58
    s_waitcnt lgkmcnt(6)
    v_mfma_f32_32x32x16_bf16 v[176:191], v[244:247], v[52:55], v[176:191]
    ds_read_b64_tr_b16 v[236:237], v6 offset:14592
    ds_read_b64_tr_b16 v[238:239], v6 offset:15104
    v_mov_b32 v10, 0x3fb8aa3b
    v_mov_b32 v11, 0x3fb8aa3b
    s_getreg_b32 s46, hwreg(HW_REG_IB_STS)
    s_and_b32 s46, s46, 0x00c0000f
    s_or_b32 s46, s46, s54
    s_cbranch_scc1 L_NBQ_6
    s_waitcnt vmcnt(0)
    v_lshlrev_b32 v13, 3, v1
    s_mov_b64 exec, 255
    buffer_store_dwordx2 v[30:31], v13, s[28:31], s51 offen sc1
    s_mov_b64 exec, -1
    s_mov_b32 s54, 1
    L_NBQ_6:
    s_waitcnt lgkmcnt(6)
    v_mfma_f32_32x32x16_bf16 v[160:175], v[224:227], v[56:59], v[160:175]
    ds_read_b64_tr_b16 v[240:241], v6 offset:16384
    ds_read_b64_tr_b16 v[242:243], v6 offset:16896
    v_mov_b32 v14, 2.0
    v_mov_b32 v15, 2.0
    s_waitcnt lgkmcnt(6)
    v_mfma_f32_32x32x16_bf16 v[176:191], v[228:231], v[56:59], v[176:191]
    ds_read_b64_tr_b16 v[244:245], v6 offset:16640
    ds_read_b64_tr_b16 v[246:247], v6 offset:17152
    s_waitcnt lgkmcnt(6)
    v_mfma_f32_32x32x16_bf16 v[160:175], v[232:235], v[60:63], v[160:175]
    ds_read_b64_tr_b16 v[224:225], v6 offset:18432
    ds_read_b64_tr_b16 v[226:227], v6 offset:18944
    s_waitcnt lgkmcnt(6)
    v_mfma_f32_32x32x16_bf16 v[176:191], v[236:239], v[60:63], v[176:191]
    ds_read_b64_tr_b16 v[228:229], v6 offset:18688
    ds_read_b64_tr_b16 v[230:231], v6 offset:19200
    s_getreg_b32 s46, hwreg(HW_REG_IB_STS)
    s_and_b32 s46, s46, 0x00c0000f
    s_or_b32 s46, s46, s54
    s_cbranch_scc1 L_NBQ_7
    s_waitcnt vmcnt(0)
    v_lshlrev_b32 v13, 3, v1
    s_mov_b64 exec, 255
    buffer_store_dwordx2 v[30:31], v13, s[28:31], s51 offen sc1
    s_mov_b64 exec, -1
    s_mov_b32 s54, 1
    L_NBQ_7:
    s_waitcnt lgkmcnt(6)
    v_mfma_f32_32x32x16_bf16 v[160:175], v[240:243], v[64:67], v[160:175]
    ds_read_b64_tr_b16 v[232:233], v6 offset:20480
    ds_read_b64_tr_b16 v[234:235], v6 offset:20992
    s_waitcnt lgkmcnt(6)
    v_mfma_f32_32x32x16_bf16 v[176:191], v[244:247], v[64:67], v[176:191]
    ds_read_b64_tr_b16 v[236:237], v6 offset:20736
    ds_read_b64_tr_b16 v[238:239], v6 offset:21248
    s_waitcnt lgkmcnt(6)
    v_mfma_f32_32x32x16_bf16 v[160:175], v[224:227], v[68:71], v[160:175]
    ds_read_b64_tr_b16 v[240:241], v6 offset:22528
    ds_read_b64_tr_b16 v[242:243], v6 offset:23040
    s_waitcnt lgkmcnt(6)
    v_mfma_f32_32x32x16_bf16 v[176:191], v[228:231], v[68:71], v[176:191]
    ds_read_b64_tr_b16 v[244:245], v6 offset:22784
    ds_read_b64_tr_b16 v[246:247], v6 offset:23296
    s_getreg_b32 s46, hwreg(HW_REG_IB_STS)
    s_and_b32 s46, s46, 0x00c0000f
    s_or_b32 s46, s46, s54
    s_cbranch_scc1 L_NBQ_8
    s_waitcnt vmcnt(0)
    v_lshlrev_b32 v13, 3, v1
    s_mov_b64 exec, 255
    buffer_store_dwordx2 v[30:31], v13, s[28:31], s51 offen sc1
    s_mov_b64 exec, -1
    s_mov_b32 s54, 1
    L_NBQ_8:
    s_waitcnt lgkmcnt(6)
    v_mfma_f32_32x32x16_bf16 v[160:175], v[232:235], v[72:75], v[160:175]
    ds_read_b64_tr_b16 v[224:225], v6 offset:24576
    ds_read_b64_tr_b16 v[226:227], v6 offset:25088
    s_waitcnt lgkmcnt(6)
    v_mfma_f32_32x32x16_bf16 v[176:191], v[236:239], v[72:75], v[176:191]
    ds_read_b64_tr_b16 v[228:229], v6 offset:24832
    ds_read_b64_tr_b16 v[230:231], v6 offset:25344
    s_waitcnt lgkmcnt(6)
    v_mfma_f32_32x32x16_bf16 v[160:175], v[240:243], v[76:79], v[160:175]
    ds_read_b64_tr_b16 v[232:233], v6 offset:26624
    ds_read_b64_tr_b16 v[234:235], v6 offset:27136
    s_waitcnt lgkmcnt(6)
    v_mfma_f32_32x32x16_bf16 v[176:191], v[244:247], v[76:79], v[176:191]
    ds_read_b64_tr_b16 v[236:237], v6 offset:26880
    ds_read_b64_tr_b16 v[238:239], v6 offset:27392
    s_getreg_b32 s46, hwreg(HW_REG_IB_STS)
    s_and_b32 s46, s46, 0x00c0000f
    s_or_b32 s46, s46, s54
    s_cbranch_scc1 L_NBQ_9
    s_waitcnt vmcnt(0)
    v_lshlrev_b32 v13, 3, v1
    s_mov_b64 exec, 255
    buffer_store_dwordx2 v[30:31], v13, s[28:31], s51 offen sc1
    s_mov_b64 exec, -1
    s_mov_b32 s54, 1
    L_NBQ_9:
    s_waitcnt lgkmcnt(6)
    v_mfma_f32_32x32x16_bf16 v[160:175], v[224:227], v[80:83], v[160:175]
    ds_read_b64_tr_b16 v[240:241], v6 offset:28672
    ds_read_b64_tr_b16 v[242:243], v6 offset:29184
    s_waitcnt lgkmcnt(6)
    v_mfma_f32_32x32x16_bf16 v[176:191], v[228:231], v[80:83], v[176:191]
    ds_read_b64_tr_b16 v[244:245], v6 offset:28928
    ds_read_b64_tr_b16 v[246:247], v6 offset:29440
    s_waitcnt lgkmcnt(6)
    v_mfma_f32_32x32x16_bf16 v[160:175], v[232:235], v[84:87], v[160:175]
    ds_read_b64_tr_b16 v[224:225], v6 offset:30720
    ds_read_b64_tr_b16 v[226:227], v6 offset:31232
    s_waitcnt lgkmcnt(6)
    v_mfma_f32_32x32x16_bf16 v[176:191], v[236:239], v[84:87], v[176:191]
    ds_read_b64_tr_b16 v[228:229], v6 offset:30976
    ds_read_b64_tr_b16 v[230:231], v6 offset:31488
    s_getreg_b32 s46, hwreg(HW_REG_IB_STS)
    s_and_b32 s46, s46, 0x00c0000f
    s_or_b32 s46, s46, s54
    s_cbranch_scc1 L_NBQ_10
    s_waitcnt vmcnt(0)
    v_lshlrev_b32 v13, 3, v1
    s_mov_b64 exec, 255
    buffer_store_dwordx2 v[30:31], v13, s[28:31], s51 offen sc1
    s_mov_b64 exec, -1
    s_mov_b32 s54, 1
    L_NBQ_10:
    s_waitcnt lgkmcnt(6)
    v_mfma_f32_32x32x16_bf16 v[160:175], v[240:243], v[88:91], v[160:175]
    ds_read_b64_tr_b16 v[232:233], v6 offset:32768
    ds_read_b64_tr_b16 v[234:235], v6 offset:33280
    s_waitcnt lgkmcnt(6)
    v_mfma_f32_32x32x16_bf16 v[176:191], v[244:247], v[88:91], v[176:191]
    ds_read_b64_tr_b16 v[236:237], v6 offset:33024
    ds_read_b64_tr_b16 v[238:239], v6 offset:33536
    s_waitcnt lgkmcnt(6)
    v_mfma_f32_32x32x16_bf16 v[160:175], v[224:227], v[92:95], v[160:175]
    ds_read_b64_tr_b16 v[240:241], v6 offset:34816
    ds_read_b64_tr_b16 v[242:243], v6 offset:35328
    s_waitcnt lgkmcnt(6)
    v_mfma_f32_32x32x16_bf16 v[176:191], v[228:231], v[92:95], v[176:191]
    ds_read_b64_tr_b16 v[244:245], v6 offset:35072
    ds_read_b64_tr_b16 v[246:247], v6 offset:35584
    s_getreg_b32 s46, hwreg(HW_REG_IB_STS)
    s_and_b32 s46, s46, 0x00c0000f
    s_or_b32 s46, s46, s54
    s_cbranch_scc1 L_NBQ_11
    s_waitcnt vmcnt(0)
    v_lshlrev_b32 v13, 3, v1
    s_mov_b64 exec, 255
    buffer_store_dwordx2 v[30:31], v13, s[28:31], s51 offen sc1
    s_mov_b64 exec, -1
    s_mov_b32 s54, 1
    L_NBQ_11:
    s_waitcnt lgkmcnt(6)
    v_mfma_f32_32x32x16_bf16 v[160:175], v[232:235], v[96:99], v[160:175]
    ds_read_b64_tr_b16 v[224:225], v6 offset:36864
    ds_read_b64_tr_b16 v[226:227], v6 offset:37376
    s_waitcnt lgkmcnt(6)
    v_mfma_f32_32x32x16_bf16 v[176:191], v[236:239], v[96:99], v[176:191]
    ds_read_b64_tr_b16 v[228:229], v6 offset:37120
    ds_read_b64_tr_b16 v[230:231], v6 offset:37632
    s_waitcnt lgkmcnt(6)
    v_mfma_f32_32x32x16_bf16 v[160:175], v[240:243], v[100:103], v[160:175]
    ds_read_b64_tr_b16 v[232:233], v6 offset:38912
    ds_read_b64_tr_b16 v[234:235], v6 offset:39424
    s_waitcnt lgkmcnt(6)
    v_mfma_f32_32x32x16_bf16 v[176:191], v[244:247], v[100:103], v[176:191]
    ds_read_b64_tr_b16 v[236:237], v6 offset:39168
    ds_read_b64_tr_b16 v[238:239], v6 offset:39680
    s_getreg_b32 s46, hwreg(HW_REG_IB_STS)
    s_and_b32 s46, s46, 0x00c0000f
    s_or_b32 s46, s46, s54
    s_cbranch_scc1 L_NBQ_12
    s_waitcnt vmcnt(0)
    v_lshlrev_b32 v13, 3, v1
    s_mov_b64 exec, 255
    buffer_store_dwordx2 v[30:31], v13, s[28:31], s51 offen sc1
    s_mov_b64 exec, -1
    s_mov_b32 s54, 1
    L_NBQ_12:
    s_waitcnt lgkmcnt(6)
    v_mfma_f32_32x32x16_bf16 v[160:175], v[224:227], v[104:107], v[160:175]
    ds_read_b64_tr_b16 v[240:241], v6 offset:40960
    ds_read_b64_tr_b16 v[242:243], v6 offset:41472
    s_waitcnt lgkmcnt(6)
    v_mfma_f32_32x32x16_bf16 v[176:191], v[228:231], v[104:107], v[176:191]
    ds_read_b64_tr_b16 v[244:245], v6 offset:41216
    ds_read_b64_tr_b16 v[246:247], v6 offset:41728
    s_waitcnt lgkmcnt(6)
    v_mfma_f32_32x32x16_bf16 v[160:175], v[232:235], v[108:111], v[160:175]
    ds_read_b64_tr_b16 v[224:225], v6 offset:43008
    ds_read_b64_tr_b16 v[226:227], v6 offset:43520
    s_waitcnt lgkmcnt(6)
    v_mfma_f32_32x32x16_bf16 v[176:191], v[236:239], v[108:111], v[176:191]
    ds_read_b64_tr_b16 v[228:229], v6 offset:43264
    ds_read_b64_tr_b16 v[230:231], v6 offset:43776
    s_getreg_b32 s46, hwreg(HW_REG_IB_STS)
    s_and_b32 s46, s46, 0x00c0000f
    s_or_b32 s46, s46, s54
    s_cbranch_scc1 L_NBQ_13
    s_waitcnt vmcnt(0)
    v_lshlrev_b32 v13, 3, v1
    s_mov_b64 exec, 255
    buffer_store_dwordx2 v[30:31], v13, s[28:31], s51 offen sc1
    s_mov_b64 exec, -1
    s_mov_b32 s54, 1
    L_NBQ_13:
    s_waitcnt lgkmcnt(6)
    v_mfma_f32_32x32x16_bf16 v[160:175], v[240:243], v[112:115], v[160:175]
    ds_read_b64_tr_b16 v[232:233], v6 offset:45056
    ds_read_b64_tr_b16 v[234:235], v6 offset:45568
    s_waitcnt lgkmcnt(6)
    v_mfma_f32_32x32x16_bf16 v[176:191], v[244:247], v[112:115], v[176:191]
    ds_read_b64_tr_b16 v[236:237], v6 offset:45312
    ds_read_b64_tr_b16 v[238:239], v6 offset:45824
    s_waitcnt lgkmcnt(6)
    v_mfma_f32_32x32x16_bf16 v[160:175], v[224:227], v[116:119], v[160:175]
    ds_read_b64_tr_b16 v[240:241], v6 offset:47104
    ds_read_b64_tr_b16 v[242:243], v6 offset:47616
    s_waitcnt lgkmcnt(6)
    v_mfma_f32_32x32x16_bf16 v[176:191], v[228:231], v[116:119], v[176:191]
    ds_read_b64_tr_b16 v[244:245], v6 offset:47360
    ds_read_b64_tr_b16 v[246:247], v6 offset:47872
    s_getreg_b32 s46, hwreg(HW_REG_IB_STS)
    s_and_b32 s46, s46, 0x00c0000f
    s_or_b32 s46, s46, s54
    s_cbranch_scc1 L_NBQ_14
    s_waitcnt vmcnt(0)
    v_lshlrev_b32 v13, 3, v1
    s_mov_b64 exec, 255
    buffer_store_dwordx2 v[30:31], v13, s[28:31], s51 offen sc1
    s_mov_b64 exec, -1
    s_mov_b32 s54, 1
    L_NBQ_14:
    s_waitcnt lgkmcnt(6)
    v_mfma_f32_32x32x16_bf16 v[160:175], v[232:235], v[120:123], v[160:175]
    ds_read_b64_tr_b16 v[224:225], v6 offset:49152
    ds_read_b64_tr_b16 v[226:227], v6 offset:49664
    s_waitcnt lgkmcnt(6)
    v_mfma_f32_32x32x16_bf16 v[176:191], v[236:239], v[120:123], v[176:191]
    ds_read_b64_tr_b16 v[228:229], v6 offset:49408
    ds_read_b64_tr_b16 v[230:231], v6 offset:49920
    s_waitcnt lgkmcnt(6)
    v_mfma_f32_32x32x16_bf16 v[160:175], v[240:243], v[124:127], v[160:175]
    ds_read_b64_tr_b16 v[232:233], v6 offset:51200
    ds_read_b64_tr_b16 v[234:235], v6 offset:51712
    s_waitcnt lgkmcnt(6)
    v_mfma_f32_32x32x16_bf16 v[176:191], v[244:247], v[124:127], v[176:191]
    ds_read_b64_tr_b16 v[236:237], v6 offset:51456
    ds_read_b64_tr_b16 v[238:239], v6 offset:51968
    s_getreg_b32 s46, hwreg(HW_REG_IB_STS)
    s_and_b32 s46, s46, 0x00c0000f
    s_or_b32 s46, s46, s54
    s_cbranch_scc1 L_NBQ_15
    s_waitcnt vmcnt(0)
    v_lshlrev_b32 v13, 3, v1
    s_mov_b64 exec, 255
    buffer_store_dwordx2 v[30:31], v13, s[28:31], s51 offen sc1
    s_mov_b64 exec, -1
    s_mov_b32 s54, 1
    L_NBQ_15:
    s_waitcnt lgkmcnt(6)
    v_mfma_f32_32x32x16_bf16 v[160:175], v[224:227], v[128:131], v[160:175]
    ds_read_b64_tr_b16 v[240:241], v6 offset:53248
    ds_read_b64_tr_b16 v[242:243], v6 offset:53760
    s_waitcnt lgkmcnt(6)
    v_mfma_f32_32x32x16_bf16 v[176:191], v[228:231], v[128:131], v[176:191]
    ds_read_b64_tr_b16 v[244:245], v6 offset:53504
    ds_read_b64_tr_b16 v[246:247], v6 offset:54016
    s_waitcnt lgkmcnt(6)
    v_mfma_f32_32x32x16_bf16 v[160:175], v[232:235], v[132:135], v[160:175]
    ds_read_b64_tr_b16 v[224:225], v6 offset:55296
    ds_read_b64_tr_b16 v[226:227], v6 offset:55808
    s_waitcnt lgkmcnt(6)
    v_mfma_f32_32x32x16_bf16 v[176:191], v[236:239], v[132:135], v[176:191]
    ds_read_b64_tr_b16 v[228:229], v6 offset:55552
    ds_read_b64_tr_b16 v[230:231], v6 offset:56064
    s_getreg_b32 s46, hwreg(HW_REG_IB_STS)
    s_and_b32 s46, s46, 0x00c0000f
    s_or_b32 s46, s46, s54
    s_cbranch_scc1 L_NBQ_16
    s_waitcnt vmcnt(0)
    v_lshlrev_b32 v13, 3, v1
    s_mov_b64 exec, 255
    buffer_store_dwordx2 v[30:31], v13, s[28:31], s51 offen sc1
    s_mov_b64 exec, -1
    s_mov_b32 s54, 1
    L_NBQ_16:
    s_waitcnt lgkmcnt(6)
    v_mfma_f32_32x32x16_bf16 v[160:175], v[240:243], v[136:139], v[160:175]
    ds_read_b64_tr_b16 v[232:233], v6 offset:57344
    ds_read_b64_tr_b16 v[234:235], v6 offset:57856
    s_waitcnt lgkmcnt(6)
    v_mfma_f32_32x32x16_bf16 v[176:191], v[244:247], v[136:139], v[176:191]
    ds_read_b64_tr_b16 v[236:237], v6 offset:57600
    ds_read_b64_tr_b16 v[238:239], v6 offset:58112
    s_waitcnt lgkmcnt(6)
    v_mfma_f32_32x32x16_bf16 v[160:175], v[224:227], v[140:143], v[160:175]
    ds_read_b64_tr_b16 v[240:241], v6 offset:59392
    ds_read_b64_tr_b16 v[242:243], v6 offset:59904
    s_waitcnt lgkmcnt(6)
    v_mfma_f32_32x32x16_bf16 v[176:191], v[228:231], v[140:143], v[176:191]
    ds_read_b64_tr_b16 v[244:245], v6 offset:59648
    ds_read_b64_tr_b16 v[246:247], v6 offset:60160
    s_getreg_b32 s46, hwreg(HW_REG_IB_STS)
    s_and_b32 s46, s46, 0x00c0000f
    s_or_b32 s46, s46, s54
    s_cbranch_scc1 L_NBQ_17
    s_waitcnt vmcnt(0)
    v_lshlrev_b32 v13, 3, v1
    s_mov_b64 exec, 255
    buffer_store_dwordx2 v[30:31], v13, s[28:31], s51 offen sc1
    s_mov_b64 exec, -1
    s_mov_b32 s54, 1
    L_NBQ_17:
    s_waitcnt lgkmcnt(6)
    v_mfma_f32_32x32x16_bf16 v[160:175], v[232:235], v[144:147], v[160:175]
    ds_read_b64_tr_b16 v[224:225], v6 offset:61440
    ds_read_b64_tr_b16 v[226:227], v6 offset:61952
    s_waitcnt lgkmcnt(6)
    v_mfma_f32_32x32x16_bf16 v[176:191], v[236:239], v[144:147], v[176:191]
    ds_read_b64_tr_b16 v[228:229], v6 offset:61696
    ds_read_b64_tr_b16 v[230:231], v6 offset:62208
    s_waitcnt lgkmcnt(6)
    v_mfma_f32_32x32x16_bf16 v[160:175], v[240:243], v[148:151], v[160:175]
    ds_read_b64_tr_b16 v[232:233], v6 offset:63488
    ds_read_b64_tr_b16 v[234:235], v6 offset:64000
    s_waitcnt lgkmcnt(6)
    v_mfma_f32_32x32x16_bf16 v[176:191], v[244:247], v[148:151], v[176:191]
    ds_read_b64_tr_b16 v[236:237], v6 offset:63744
    ds_read_b64_tr_b16 v[238:239], v6 offset:64256
    s_getreg_b32 s46, hwreg(HW_REG_IB_STS)
    s_and_b32 s46, s46, 0x00c0000f
    s_or_b32 s46, s46, s54
    s_cbranch_scc1 L_NBQ_18
    s_waitcnt vmcnt(0)
    v_lshlrev_b32 v13, 3, v1
    s_mov_b64 exec, 255
    buffer_store_dwordx2 v[30:31], v13, s[28:31], s51 offen sc1
    s_mov_b64 exec, -1
    s_mov_b32 s54, 1
    L_NBQ_18:
    s_waitcnt lgkmcnt(6)
    v_mfma_f32_32x32x16_bf16 v[160:175], v[224:227], v[152:155], v[160:175]
    s_waitcnt lgkmcnt(4)
    v_mfma_f32_32x32x16_bf16 v[176:191], v[228:231], v[152:155], v[176:191]
    s_waitcnt lgkmcnt(2)
    v_mfma_f32_32x32x16_bf16 v[160:175], v[232:235], v[156:159], v[160:175]
    s_waitcnt lgkmcnt(0)
    v_mfma_f32_32x32x16_bf16 v[176:191], v[236:239], v[156:159], v[176:191]
    s_cmp_eq_u32 s54, 1
    s_cbranch_scc1 L_NBQ_19
    s_waitcnt vmcnt(0)
    v_cmp_eq_u64 vcc, 0, v[30:31]
    s_cbranch_vccz L_HN_X
    s_mov_b32 s96, 0
L_PN_X:
    buffer_load_dwordx2 v[30:31], v7, s[72:75], 0 offen sc1
    s_add_u32 s96, s96, 1
    s_waitcnt vmcnt(0)
    v_cmp_eq_u64 vcc, 0, v[30:31]
    s_cmp_ge_u32 s96, 200000
    s_cbranch_scc1 L_PN_X_X
    s_cbranch_vccz L_PN_X_X
    s_sleep 1
    s_branch L_PN_X
L_PN_X_X:
L_HN_X:
    v_lshlrev_b32 v13, 3, v1
    s_mov_b64 exec, 255
    buffer_store_dwordx2 v[30:31], v13, s[28:31], s51 offen sc1
    s_mov_b64 exec, -1
L_NBQ_19:
    s_setprio 3
    s_lshl_b32 s46, s26, 3
    s_add_u32 s46, s46, 64
    v_mov_b32 v28, s46
    ds_write_b64 v28, v[30:31]
    v_lshlrev_b32 v2, 3, v1
    s_mov_b32 s96, 0
    s_mov_b64 exec, 0xf00
L_WGX:
    ds_read_b64 v[28:29], v2
    s_add_u32 s96, s96, 1
    s_waitcnt lgkmcnt(0)
    v_cmp_ne_u64 vcc, v[28:29], v[30:31]
    s_cmp_ge_u32 s96, 800000
    s_cbranch_scc1 L_WGX_X
    s_cbranch_vccz L_WGX_X
    s_sleep 1
    s_branch L_WGX
L_WGX_X:
    s_mov_b64 exec, -1
    s_nop 7
    v_pk_mul_f32 v[16:17], v[160:161], v[10:11]
    v_pk_mul_f32 v[18:19], v[162:163], v[10:11]
    v_min_f32 v16, 0x41f00000, v16
    v_min_f32 v17, 0x41f00000, v17
    v_min_f32 v18, 0x41f00000, v18
    v_min_f32 v19, 0x41f00000, v19
    v_exp_f32 v20, v16
    v_exp_f32 v21, v17
    v_exp_f32 v22, v18
    v_exp_f32 v23, v19
    v_pk_add_f32 v[24:25], v[20:21], v[14:15]
    v_pk_add_f32 v[26:27], v[22:23], v[14:15]
    v_pk_mul_f32 v[20:21], v[20:21], v[24:25]
    v_pk_mul_f32 v[22:23], v[22:23], v[26:27]
    v_pk_add_f32 v[24:25], v[20:21], v[14:15]
    v_pk_add_f32 v[26:27], v[22:23], v[14:15]
    v_rcp_f32 v16, v24
    v_rcp_f32 v17, v25
    v_rcp_f32 v18, v26
    v_rcp_f32 v19, v27
    v_pk_mul_f32 v[20:21], v[20:21], v[16:17]
    v_pk_mul_f32 v[22:23], v[22:23], v[18:19]
    v_pk_mul_f32 v[20:21], v[20:21], v[160:161]
    v_pk_mul_f32 v[22:23], v[22:23], v[162:163]
    v_cvt_pk_bf16_f32 v32, v20, v21
    v_cvt_pk_bf16_f32 v33, v22, v23
    v_pk_mul_f32 v[16:17], v[164:165], v[10:11]
    v_pk_mul_f32 v[18:19], v[166:167], v[10:11]
    v_min_f32 v16, 0x41f00000, v16
    v_min_f32 v17, 0x41f00000, v17
    v_min_f32 v18, 0x41f00000, v18
    v_min_f32 v19, 0x41f00000, v19
    v_exp_f32 v20, v16
    v_exp_f32 v21, v17
    v_exp_f32 v22, v18
    v_exp_f32 v23, v19
    v_pk_add_f32 v[24:25], v[20:21], v[14:15]
    v_pk_add_f32 v[26:27], v[22:23], v[14:15]
    v_pk_mul_f32 v[20:21], v[20:21], v[24:25]
    v_pk_mul_f32 v[22:23], v[22:23], v[26:27]
    v_pk_add_f32 v[24:25], v[20:21], v[14:15]
    v_pk_add_f32 v[26:27], v[22:23], v[14:15]
    v_rcp_f32 v16, v24
    v_rcp_f32 v17, v25
    v_rcp_f32 v18, v26
    v_rcp_f32 v19, v27
    v_pk_mul_f32 v[20:21], v[20:21], v[16:17]
    v_pk_mul_f32 v[22:23], v[22:23], v[18:19]
    v_pk_mul_f32 v[20:21], v[20:21], v[164:165]
    v_pk_mul_f32 v[22:23], v[22:23], v[166:167]
    v_cvt_pk_bf16_f32 v34, v20, v21
    v_cvt_pk_bf16_f32 v35, v22, v23
    v_pk_mul_f32 v[16:17], v[168:169], v[10:11]
    v_pk_mul_f32 v[18:19], v[170:171], v[10:11]
    v_min_f32 v16, 0x41f00000, v16
    v_min_f32 v17, 0x41f00000, v17
    v_min_f32 v18, 0x41f00000, v18
    v_min_f32 v19, 0x41f00000, v19
    v_exp_f32 v20, v16
    v_exp_f32 v21, v17
    v_exp_f32 v22, v18
    v_exp_f32 v23, v19
    v_pk_add_f32 v[24:25], v[20:21], v[14:15]
    v_pk_add_f32 v[26:27], v[22:23], v[14:15]
    v_pk_mul_f32 v[20:21], v[20:21], v[24:25]
    v_pk_mul_f32 v[22:23], v[22:23], v[26:27]
    v_pk_add_f32 v[24:25], v[20:21], v[14:15]
    v_pk_add_f32 v[26:27], v[22:23], v[14:15]
    v_rcp_f32 v16, v24
    v_rcp_f32 v17, v25
    v_rcp_f32 v18, v26
    v_rcp_f32 v19, v27
    v_pk_mul_f32 v[20:21], v[20:21], v[16:17]
    v_pk_mul_f32 v[22:23], v[22:23], v[18:19]
    v_pk_mul_f32 v[20:21], v[20:21], v[168:169]
    v_pk_mul_f32 v[22:23], v[22:23], v[170:171]
    v_cvt_pk_bf16_f32 v36, v20, v21
    v_cvt_pk_bf16_f32 v37, v22, v23
    v_pk_mul_f32 v[16:17], v[172:173], v[10:11]
    v_pk_mul_f32 v[18:19], v[174:175], v[10:11]
    v_min_f32 v16, 0x41f00000, v16
    v_min_f32 v17, 0x41f00000, v17
    v_min_f32 v18, 0x41f00000, v18
    v_min_f32 v19, 0x41f00000, v19
    v_exp_f32 v20, v16
    v_exp_f32 v21, v17
    v_exp_f32 v22, v18
    v_exp_f32 v23, v19
    v_pk_add_f32 v[24:25], v[20:21], v[14:15]
    v_pk_add_f32 v[26:27], v[22:23], v[14:15]
    v_pk_mul_f32 v[20:21], v[20:21], v[24:25]
    v_pk_mul_f32 v[22:23], v[22:23], v[26:27]
    v_pk_add_f32 v[24:25], v[20:21], v[14:15]
    v_pk_add_f32 v[26:27], v[22:23], v[14:15]
    v_rcp_f32 v16, v24
    v_rcp_f32 v17, v25
    v_rcp_f32 v18, v26
    v_rcp_f32 v19, v27
    v_pk_mul_f32 v[20:21], v[20:21], v[16:17]
    v_pk_mul_f32 v[22:23], v[22:23], v[18:19]
    v_pk_mul_f32 v[20:21], v[20:21], v[172:173]
    v_pk_mul_f32 v[22:23], v[22:23], v[174:175]
    v_cvt_pk_bf16_f32 v38, v20, v21
    v_cvt_pk_bf16_f32 v39, v22, v23
    buffer_store_dwordx4 v[32:35], v12, s[28:31], s61 offen offset:0 sc1
    buffer_store_dwordx4 v[36:39], v12, s[28:31], s61 offen offset:1024 sc1
    v_pk_mul_f32 v[16:17], v[176:177], v[10:11]
    v_pk_mul_f32 v[18:19], v[178:179], v[10:11]
    v_min_f32 v16, 0x41f00000, v16
    v_min_f32 v17, 0x41f00000, v17
    v_min_f32 v18, 0x41f00000, v18
    v_min_f32 v19, 0x41f00000, v19
    v_exp_f32 v20, v16
    v_exp_f32 v21, v17
    v_exp_f32 v22, v18
    v_exp_f32 v23, v19
    v_pk_add_f32 v[24:25], v[20:21], v[14:15]
    v_pk_add_f32 v[26:27], v[22:23], v[14:15]
    v_pk_mul_f32 v[20:21], v[20:21], v[24:25]
    v_pk_mul_f32 v[22:23], v[22:23], v[26:27]
    v_pk_add_f32 v[24:25], v[20:21], v[14:15]
    v_pk_add_f32 v[26:27], v[22:23], v[14:15]
    v_rcp_f32 v16, v24
    v_rcp_f32 v17, v25
    v_rcp_f32 v18, v26
    v_rcp_f32 v19, v27
    v_pk_mul_f32 v[20:21], v[20:21], v[16:17]
    v_pk_mul_f32 v[22:23], v[22:23], v[18:19]
    v_pk_mul_f32 v[20:21], v[20:21], v[176:177]
    v_pk_mul_f32 v[22:23], v[22:23], v[178:179]
    v_cvt_pk_bf16_f32 v40, v20, v21
    v_cvt_pk_bf16_f32 v41, v22, v23
    v_pk_mul_f32 v[16:17], v[180:181], v[10:11]
    v_pk_mul_f32 v[18:19], v[182:183], v[10:11]
    v_min_f32 v16, 0x41f00000, v16
    v_min_f32 v17, 0x41f00000, v17
    v_min_f32 v18, 0x41f00000, v18
    v_min_f32 v19, 0x41f00000, v19
    v_exp_f32 v20, v16
    v_exp_f32 v21, v17
    v_exp_f32 v22, v18
    v_exp_f32 v23, v19
    v_pk_add_f32 v[24:25], v[20:21], v[14:15]
    v_pk_add_f32 v[26:27], v[22:23], v[14:15]
    v_pk_mul_f32 v[20:21], v[20:21], v[24:25]
    v_pk_mul_f32 v[22:23], v[22:23], v[26:27]
    v_pk_add_f32 v[24:25], v[20:21], v[14:15]
    v_pk_add_f32 v[26:27], v[22:23], v[14:15]
    v_rcp_f32 v16, v24
    v_rcp_f32 v17, v25
    v_rcp_f32 v18, v26
    v_rcp_f32 v19, v27
    v_pk_mul_f32 v[20:21], v[20:21], v[16:17]
    v_pk_mul_f32 v[22:23], v[22:23], v[18:19]
    v_pk_mul_f32 v[20:21], v[20:21], v[180:181]
    v_pk_mul_f32 v[22:23], v[22:23], v[182:183]
    v_cvt_pk_bf16_f32 v42, v20, v21
    v_cvt_pk_bf16_f32 v43, v22, v23
    v_pk_mul_f32 v[16:17], v[184:185], v[10:11]
    v_pk_mul_f32 v[18:19], v[186:187], v[10:11]
    v_min_f32 v16, 0x41f00000, v16
    v_min_f32 v17, 0x41f00000, v17
    v_min_f32 v18, 0x41f00000, v18
    v_min_f32 v19, 0x41f00000, v19
    v_exp_f32 v20, v16
    v_exp_f32 v21, v17
    v_exp_f32 v22, v18
    v_exp_f32 v23, v19
    v_pk_add_f32 v[24:25], v[20:21], v[14:15]
    v_pk_add_f32 v[26:27], v[22:23], v[14:15]
    v_pk_mul_f32 v[20:21], v[20:21], v[24:25]
    v_pk_mul_f32 v[22:23], v[22:23], v[26:27]
    v_pk_add_f32 v[24:25], v[20:21], v[14:15]
    v_pk_add_f32 v[26:27], v[22:23], v[14:15]
    v_rcp_f32 v16, v24
    v_rcp_f32 v17, v25
    v_rcp_f32 v18, v26
    v_rcp_f32 v19, v27
    v_pk_mul_f32 v[20:21], v[20:21], v[16:17]
    v_pk_mul_f32 v[22:23], v[22:23], v[18:19]
    v_pk_mul_f32 v[20:21], v[20:21], v[184:185]
    v_pk_mul_f32 v[22:23], v[22:23], v[186:187]
    v_cvt_pk_bf16_f32 v44, v20, v21
    v_cvt_pk_bf16_f32 v45, v22, v23
    v_pk_mul_f32 v[16:17], v[188:189], v[10:11]
    v_pk_mul_f32 v[18:19], v[190:191], v[10:11]
    v_min_f32 v16, 0x41f00000, v16
    v_min_f32 v17, 0x41f00000, v17
    v_min_f32 v18, 0x41f00000, v18
    v_min_f32 v19, 0x41f00000, v19
    v_exp_f32 v20, v16
    v_exp_f32 v21, v17
    v_exp_f32 v22, v18
    v_exp_f32 v23, v19
    v_pk_add_f32 v[24:25], v[20:21], v[14:15]
    v_pk_add_f32 v[26:27], v[22:23], v[14:15]
    v_pk_mul_f32 v[20:21], v[20:21], v[24:25]
    v_pk_mul_f32 v[22:23], v[22:23], v[26:27]
    v_pk_add_f32 v[24:25], v[20:21], v[14:15]
    v_pk_add_f32 v[26:27], v[22:23], v[14:15]
    v_rcp_f32 v16, v24
    v_rcp_f32 v17, v25
    v_rcp_f32 v18, v26
    v_rcp_f32 v19, v27
    v_pk_mul_f32 v[20:21], v[20:21], v[16:17]
    v_pk_mul_f32 v[22:23], v[22:23], v[18:19]
    v_pk_mul_f32 v[20:21], v[20:21], v[188:189]
    v_pk_mul_f32 v[22:23], v[22:23], v[190:191]
    v_cvt_pk_bf16_f32 v46, v20, v21
    v_cvt_pk_bf16_f32 v47, v22, v23
    buffer_store_dwordx4 v[40:43], v12, s[28:31], s61 offen offset:2048 sc1
    buffer_store_dwordx4 v[44:47], v12, s[28:31], s61 offen offset:3072 sc1
    s_branch L_C_SIGNAL
L_C_Y:
    v_lshlrev_b32 v192, 16, v224
    v_and_b32 v193, 0xffff0000, v224
    v_lshlrev_b32 v194, 16, v225
    v_and_b32 v195, 0xffff0000, v225
    v_lshlrev_b32 v196, 16, v226
    v_and_b32 v197, 0xffff0000, v226
    v_lshlrev_b32 v198, 16, v227
    v_and_b32 v199, 0xffff0000, v227
    v_lshlrev_b32 v200, 16, v228
    v_and_b32 v201, 0xffff0000, v228
    v_lshlrev_b32 v202, 16, v229
    v_and_b32 v203, 0xffff0000, v229
    v_lshlrev_b32 v204, 16, v230
    v_and_b32 v205, 0xffff0000, v230
    v_lshlrev_b32 v206, 16, v231
    v_and_b32 v207, 0xffff0000, v231
    v_lshlrev_b32 v208, 16, v232
    v_and_b32 v209, 0xffff0000, v232
    v_lshlrev_b32 v210, 16, v233
    v_and_b32 v211, 0xffff0000, v233
    v_lshlrev_b32 v212, 16, v234
    v_and_b32 v213, 0xffff0000, v234
    v_lshlrev_b32 v214, 16, v235
    v_and_b32 v215, 0xffff0000, v235
    v_lshlrev_b32 v216, 16, v236
    v_and_b32 v217, 0xffff0000, v236
    v_lshlrev_b32 v218, 16, v237
    v_and_b32 v219, 0xffff0000, v237
    v_lshlrev_b32 v220, 16, v238
    v_and_b32 v221, 0xffff0000, v238
    v_lshlrev_b32 v222, 16, v239
    v_and_b32 v223, 0xffff0000, v239
    v_bfe_u32 v13, v1, 4, 1
    v_lshlrev_b32 v13, 16, v13
    v_lshl_add_u32 v13, v9, 9, v13
    v_and_b32 v28, 15, v1
    v_lshl_add_u32 v13, v28, 4, v13
    s_barrier
    ds_read_b128 v[32:35], v2
    ds_read_b64_tr_b16 v[224:225], v6 offset:16384
    ds_read_b64_tr_b16 v[226:227], v6 offset:16896
    ds_read_b64_tr_b16 v[228:229], v6 offset:16640
    ds_read_b64_tr_b16 v[230:231], v6 offset:17152
    ds_read_b64_tr_b16 v[232:233], v6 offset:24576
    ds_read_b64_tr_b16 v[234:235], v6 offset:25088
    ds_read_b64_tr_b16 v[236:237], v6 offset:24832
    ds_read_b64_tr_b16 v[238:239], v6 offset:25344
    s_waitcnt lgkmcnt(6)
    v_mfma_f32_32x32x16_bf16 v[160:175], v[32:35], v[224:227], 0
    ds_read_b128 v[36:39], v3
    ds_read_b64_tr_b16 v[240:241], v6 offset:18432
    ds_read_b64_tr_b16 v[242:243], v6 offset:18944
    s_waitcnt lgkmcnt(7)
    v_mfma_f32_32x32x16_bf16 v[176:191], v[32:35], v[228:231], 0
    ds_read_b64_tr_b16 v[244:245], v6 offset:18688
    ds_read_b64_tr_b16 v[246:247], v6 offset:19200
    s_waitcnt lgkmcnt(7)
    v_mfma_f32_32x32x16_bf16 v[192:207], v[232:235], v[32:35], v[192:207]
    ds_read_b64_tr_b16 v[248:249], v6 offset:26624
    ds_read_b64_tr_b16 v[250:251], v6 offset:27136
    s_waitcnt lgkmcnt(7)
    v_mfma_f32_32x32x16_bf16 v[208:223], v[236:239], v[32:35], v[208:223]
    ds_read_b64_tr_b16 v[252:253], v6 offset:26880
    ds_read_b64_tr_b16 v[254:255], v6 offset:27392
    s_waitcnt lgkmcnt(6)
    v_mfma_f32_32x32x16_bf16 v[160:175], v[36:39], v[240:243], v[160:175]
    ds_read_b128 v[40:43], v4
    ds_read_b64_tr_b16 v[224:225], v6 offset:20480
    ds_read_b64_tr_b16 v[226:227], v6 offset:20992
    s_waitcnt lgkmcnt(7)
    v_mfma_f32_32x32x16_bf16 v[176:191], v[36:39], v[244:247], v[176:191]
    ds_read_b64_tr_b16 v[228:229], v6 offset:20736
    ds_read_b64_tr_b16 v[230:231], v6 offset:21248
    s_waitcnt lgkmcnt(7)
    v_mfma_f32_32x32x16_bf16 v[192:207], v[248:251], v[36:39], v[192:207]
    ds_read_b64_tr_b16 v[232:233], v6 offset:28672
    ds_read_b64_tr_b16 v[234:235], v6 offset:29184
    s_waitcnt lgkmcnt(7)
    v_mfma_f32_32x32x16_bf16 v[208:223], v[252:255], v[36:39], v[208:223]
    ds_read_b64_tr_b16 v[236:237], v6 offset:28928
    ds_read_b64_tr_b16 v[238:239], v6 offset:29440
    s_waitcnt lgkmcnt(6)
    v_mfma_f32_32x32x16_bf16 v[160:175], v[40:43], v[224:227], v[160:175]
    ds_read_b128 v[44:47], v5
    ds_read_b64_tr_b16 v[240:241], v6 offset:22528
    ds_read_b64_tr_b16 v[242:243], v6 offset:23040
    s_waitcnt lgkmcnt(7)
    v_mfma_f32_32x32x16_bf16 v[176:191], v[40:43], v[228:231], v[176:191]
    ds_read_b64_tr_b16 v[244:245], v6 offset:22784
    ds_read_b64_tr_b16 v[246:247], v6 offset:23296
    s_waitcnt lgkmcnt(7)
    v_mfma_f32_32x32x16_bf16 v[192:207], v[232:235], v[40:43], v[192:207]
    ds_read_b64_tr_b16 v[248:249], v6 offset:30720
    ds_read_b64_tr_b16 v[250:251], v6 offset:31232
    s_waitcnt lgkmcnt(7)
    v_mfma_f32_32x32x16_bf16 v[208:223], v[236:239], v[40:43], v[208:223]
    ds_read_b64_tr_b16 v[252:253], v6 offset:30976
    ds_read_b64_tr_b16 v[254:255], v6 offset:31488
    s_waitcnt lgkmcnt(0)
    s_barrier
    v_add_u32 v2, s55, v2
    v_add_u32 v3, s55, v3
    v_add_u32 v4, s55, v4
    v_add_u32 v5, s55, v5
    v_add_u32 v6, s55, v6
    s_cmp_lg_u32 s26, 3
    s_cbranch_scc1 L_MT_20
    buffer_load_dword v29, v29, s[80:83], 0 offen
    v_and_b32 v28, 15, v1
    v_lshlrev_b32 v28, 7, v28
    buffer_load_dword v29, v28, s[84:87], s88 offen
L_MT_20:
    v_mfma_f32_32x32x16_bf16 v[160:175], v[44:47], v[240:243], v[160:175]
    ds_read_b128 v[48:51], v2
    ds_read_b64_tr_b16 v[224:225], v6 offset:16384
    ds_read_b64_tr_b16 v[226:227], v6 offset:16896
    v_mfma_f32_32x32x16_bf16 v[176:191], v[44:47], v[244:247], v[176:191]
    ds_read_b64_tr_b16 v[228:229], v6 offset:16640
    ds_read_b64_tr_b16 v[230:231], v6 offset:17152
    v_mfma_f32_32x32x16_bf16 v[192:207], v[248:251], v[44:47], v[192:207]
    ds_read_b64_tr_b16 v[232:233], v6 offset:24576
    ds_read_b64_tr_b16 v[234:235], v6 offset:25088
    v_mfma_f32_32x32x16_bf16 v[208:223], v[252:255], v[44:47], v[208:223]
    ds_read_b64_tr_b16 v[236:237], v6 offset:24832
    ds_read_b64_tr_b16 v[238:239], v6 offset:25344
    s_waitcnt lgkmcnt(6)
    v_mfma_f32_32x32x16_bf16 v[160:175], v[48:51], v[224:227], v[160:175]
    ds_read_b128 v[52:55], v3
    ds_read_b64_tr_b16 v[240:241], v6 offset:18432
    ds_read_b64_tr_b16 v[242:243], v6 offset:18944
    s_waitcnt lgkmcnt(7)
    v_mfma_f32_32x32x16_bf16 v[176:191], v[48:51], v[228:231], v[176:191]
    ds_read_b64_tr_b16 v[244:245], v6 offset:18688
    ds_read_b64_tr_b16 v[246:247], v6 offset:19200
    s_waitcnt lgkmcnt(7)
    v_mfma_f32_32x32x16_bf16 v[192:207], v[232:235], v[48:51], v[192:207]
    ds_read_b64_tr_b16 v[248:249], v6 offset:26624
    ds_read_b64_tr_b16 v[250:251], v6 offset:27136
    s_waitcnt lgkmcnt(7)
    v_mfma_f32_32x32x16_bf16 v[208:223], v[236:239], v[48:51], v[208:223]
    ds_read_b64_tr_b16 v[252:253], v6 offset:26880
    ds_read_b64_tr_b16 v[254:255], v6 offset:27392
    s_waitcnt lgkmcnt(6)
    v_mfma_f32_32x32x16_bf16 v[160:175], v[52:55], v[240:243], v[160:175]
    ds_read_b128 v[56:59], v4
    ds_read_b64_tr_b16 v[224:225], v6 offset:20480
    ds_read_b64_tr_b16 v[226:227], v6 offset:20992
    s_waitcnt lgkmcnt(7)
    v_mfma_f32_32x32x16_bf16 v[176:191], v[52:55], v[244:247], v[176:191]
    ds_read_b64_tr_b16 v[228:229], v6 offset:20736
    ds_read_b64_tr_b16 v[230:231], v6 offset:21248
    s_waitcnt lgkmcnt(7)
    v_mfma_f32_32x32x16_bf16 v[192:207], v[248:251], v[52:55], v[192:207]
    ds_read_b64_tr_b16 v[232:233], v6 offset:28672
    ds_read_b64_tr_b16 v[234:235], v6 offset:29184
    s_waitcnt lgkmcnt(7)
    v_mfma_f32_32x32x16_bf16 v[208:223], v[252:255], v[52:55], v[208:223]
    ds_read_b64_tr_b16 v[236:237], v6 offset:28928
    ds_read_b64_tr_b16 v[238:239], v6 offset:29440
    s_waitcnt lgkmcnt(6)
    v_mfma_f32_32x32x16_bf16 v[160:175], v[56:59], v[224:227], v[160:175]
    ds_read_b128 v[60:63], v5
    ds_read_b64_tr_b16 v[240:241], v6 offset:22528
    ds_read_b64_tr_b16 v[242:243], v6 offset:23040
    s_waitcnt lgkmcnt(7)
    v_mfma_f32_32x32x16_bf16 v[176:191], v[56:59], v[228:231], v[176:191]
    ds_read_b64_tr_b16 v[244:245], v6 offset:22784
    ds_read_b64_tr_b16 v[246:247], v6 offset:23296
    s_waitcnt lgkmcnt(7)
    v_mfma_f32_32x32x16_bf16 v[192:207], v[232:235], v[56:59], v[192:207]
    ds_read_b64_tr_b16 v[248:249], v6 offset:30720
    ds_read_b64_tr_b16 v[250:251], v6 offset:31232
    s_waitcnt lgkmcnt(7)
    v_mfma_f32_32x32x16_bf16 v[208:223], v[236:239], v[56:59], v[208:223]
    ds_read_b64_tr_b16 v[252:253], v6 offset:30976
    ds_read_b64_tr_b16 v[254:255], v6 offset:31488
    s_waitcnt lgkmcnt(0)
    s_barrier
    v_add_u32 v2, s55, v2
    v_add_u32 v3, s55, v3
    v_add_u32 v4, s55, v4
    v_add_u32 v5, s55, v5
    v_add_u32 v6, s55, v6
    v_mfma_f32_32x32x16_bf16 v[160:175], v[60:63], v[240:243], v[160:175]
    ds_read_b128 v[64:67], v2
    ds_read_b64_tr_b16 v[224:225], v6 offset:16384
    ds_read_b64_tr_b16 v[226:227], v6 offset:16896
    v_mfma_f32_32x32x16_bf16 v[176:191], v[60:63], v[244:247], v[176:191]
    ds_read_b64_tr_b16 v[228:229], v6 offset:16640
    ds_read_b64_tr_b16 v[230:231], v6 offset:17152
    v_mfma_f32_32x32x16_bf16 v[192:207], v[248:251], v[60:63], v[192:207]
    ds_read_b64_tr_b16 v[232:233], v6 offset:24576
    ds_read_b64_tr_b16 v[234:235], v6 offset:25088
    v_mfma_f32_32x32x16_bf16 v[208:223], v[252:255], v[60:63], v[208:223]
    ds_read_b64_tr_b16 v[236:237], v6 offset:24832
    ds_read_b64_tr_b16 v[238:239], v6 offset:25344
    s_waitcnt lgkmcnt(6)
    v_mfma_f32_32x32x16_bf16 v[160:175], v[64:67], v[224:227], v[160:175]
    ds_read_b128 v[68:71], v3
    ds_read_b64_tr_b16 v[240:241], v6 offset:18432
    ds_read_b64_tr_b16 v[242:243], v6 offset:18944
    s_waitcnt lgkmcnt(7)
    v_mfma_f32_32x32x16_bf16 v[176:191], v[64:67], v[228:231], v[176:191]
    ds_read_b64_tr_b16 v[244:245], v6 offset:18688
    ds_read_b64_tr_b16 v[246:247], v6 offset:19200
    s_waitcnt lgkmcnt(7)
    v_mfma_f32_32x32x16_bf16 v[192:207], v[232:235], v[64:67], v[192:207]
    ds_read_b64_tr_b16 v[248:249], v6 offset:26624
    ds_read_b64_tr_b16 v[250:251], v6 offset:27136
    s_waitcnt lgkmcnt(7)
    v_mfma_f32_32x32x16_bf16 v[208:223], v[236:239], v[64:67], v[208:223]
    ds_read_b64_tr_b16 v[252:253], v6 offset:26880
    ds_read_b64_tr_b16 v[254:255], v6 offset:27392
    s_waitcnt lgkmcnt(6)
    v_mfma_f32_32x32x16_bf16 v[160:175], v[68:71], v[240:243], v[160:175]
    ds_read_b128 v[72:75], v4
    ds_read_b64_tr_b16 v[224:225], v6 offset:20480
    ds_read_b64_tr_b16 v[226:227], v6 offset:20992
    s_waitcnt lgkmcnt(7)
    v_mfma_f32_32x32x16_bf16 v[176:191], v[68:71], v[244:247], v[176:191]
    ds_read_b64_tr_b16 v[228:229], v6 offset:20736
    ds_read_b64_tr_b16 v[230:231], v6 offset:21248
    s_waitcnt lgkmcnt(7)
    v_mfma_f32_32x32x16_bf16 v[192:207], v[248:251], v[68:71], v[192:207]
    ds_read_b64_tr_b16 v[232:233], v6 offset:28672
    ds_read_b64_tr_b16 v[234:235], v6 offset:29184
    s_waitcnt lgkmcnt(7)
    v_mfma_f32_32x32x16_bf16 v[208:223], v[252:255], v[68:71], v[208:223]
    ds_read_b64_tr_b16 v[236:237], v6 offset:28928
    ds_read_b64_tr_b16 v[238:239], v6 offset:29440
    s_waitcnt lgkmcnt(6)
    v_mfma_f32_32x32x16_bf16 v[160:175], v[72:75], v[224:227], v[160:175]
    ds_read_b128 v[76:79], v5
    ds_read_b64_tr_b16 v[240:241], v6 offset:22528
    ds_read_b64_tr_b16 v[242:243], v6 offset:23040
    s_waitcnt lgkmcnt(7)
    v_mfma_f32_32x32x16_bf16 v[176:191], v[72:75], v[228:231], v[176:191]
    ds_read_b64_tr_b16 v[244:245], v6 offset:22784
    ds_read_b64_tr_b16 v[246:247], v6 offset:23296
    s_waitcnt lgkmcnt(7)
    v_mfma_f32_32x32x16_bf16 v[192:207], v[232:235], v[72:75], v[192:207]
    ds_read_b64_tr_b16 v[248:249], v6 offset:30720
    ds_read_b64_tr_b16 v[250:251], v6 offset:31232
    s_waitcnt lgkmcnt(7)
    v_mfma_f32_32x32x16_bf16 v[208:223], v[236:239], v[72:75], v[208:223]
    ds_read_b64_tr_b16 v[252:253], v6 offset:30976
    ds_read_b64_tr_b16 v[254:255], v6 offset:31488
    s_waitcnt lgkmcnt(0)
    s_barrier
    v_add_u32 v2, s55, v2
    v_add_u32 v3, s55, v3
    v_add_u32 v4, s55, v4
    v_add_u32 v5, s55, v5
    v_add_u32 v6, s55, v6
    v_mfma_f32_32x32x16_bf16 v[160:175], v[76:79], v[240:243], v[160:175]
    ds_read_b128 v[80:83], v2
    ds_read_b64_tr_b16 v[224:225], v6 offset:16384
    ds_read_b64_tr_b16 v[226:227], v6 offset:16896
    v_mfma_f32_32x32x16_bf16 v[176:191], v[76:79], v[244:247], v[176:191]
    ds_read_b64_tr_b16 v[228:229], v6 offset:16640
    ds_read_b64_tr_b16 v[230:231], v6 offset:17152
    v_mfma_f32_32x32x16_bf16 v[192:207], v[248:251], v[76:79], v[192:207]
    ds_read_b64_tr_b16 v[232:233], v6 offset:24576
    ds_read_b64_tr_b16 v[234:235], v6 offset:25088
    v_mfma_f32_32x32x16_bf16 v[208:223], v[252:255], v[76:79], v[208:223]
    ds_read_b64_tr_b16 v[236:237], v6 offset:24832
    ds_read_b64_tr_b16 v[238:239], v6 offset:25344
    s_waitcnt lgkmcnt(6)
    v_mfma_f32_32x32x16_bf16 v[160:175], v[80:83], v[224:227], v[160:175]
    ds_read_b128 v[84:87], v3
    ds_read_b64_tr_b16 v[240:241], v6 offset:18432
    ds_read_b64_tr_b16 v[242:243], v6 offset:18944
    s_waitcnt lgkmcnt(7)
    v_mfma_f32_32x32x16_bf16 v[176:191], v[80:83], v[228:231], v[176:191]
    ds_read_b64_tr_b16 v[244:245], v6 offset:18688
    ds_read_b64_tr_b16 v[246:247], v6 offset:19200
    s_waitcnt lgkmcnt(7)
    v_mfma_f32_32x32x16_bf16 v[192:207], v[232:235], v[80:83], v[192:207]
    ds_read_b64_tr_b16 v[248:249], v6 offset:26624
    ds_read_b64_tr_b16 v[250:251], v6 offset:27136
    s_waitcnt lgkmcnt(7)
    v_mfma_f32_32x32x16_bf16 v[208:223], v[236:239], v[80:83], v[208:223]
    ds_read_b64_tr_b16 v[252:253], v6 offset:26880
    ds_read_b64_tr_b16 v[254:255], v6 offset:27392
    s_waitcnt lgkmcnt(6)
    v_mfma_f32_32x32x16_bf16 v[160:175], v[84:87], v[240:243], v[160:175]
    ds_read_b128 v[88:91], v4
    ds_read_b64_tr_b16 v[224:225], v6 offset:20480
    ds_read_b64_tr_b16 v[226:227], v6 offset:20992
    s_waitcnt lgkmcnt(7)
    v_mfma_f32_32x32x16_bf16 v[176:191], v[84:87], v[244:247], v[176:191]
    ds_read_b64_tr_b16 v[228:229], v6 offset:20736
    ds_read_b64_tr_b16 v[230:231], v6 offset:21248
    s_waitcnt lgkmcnt(7)
    v_mfma_f32_32x32x16_bf16 v[192:207], v[248:251], v[84:87], v[192:207]
    ds_read_b64_tr_b16 v[232:233], v6 offset:28672
    ds_read_b64_tr_b16 v[234:235], v6 offset:29184
    s_waitcnt lgkmcnt(7)
    v_mfma_f32_32x32x16_bf16 v[208:223], v[252:255], v[84:87], v[208:223]
    ds_read_b64_tr_b16 v[236:237], v6 offset:28928
    ds_read_b64_tr_b16 v[238:239], v6 offset:29440
    s_waitcnt lgkmcnt(6)
    v_mfma_f32_32x32x16_bf16 v[160:175], v[88:91], v[224:227], v[160:175]
    ds_read_b128 v[92:95], v5
    ds_read_b64_tr_b16 v[240:241], v6 offset:22528
    ds_read_b64_tr_b16 v[242:243], v6 offset:23040
    s_waitcnt lgkmcnt(7)
    v_mfma_f32_32x32x16_bf16 v[176:191], v[88:91], v[228:231], v[176:191]
    ds_read_b64_tr_b16 v[244:245], v6 offset:22784
    ds_read_b64_tr_b16 v[246:247], v6 offset:23296
    s_waitcnt lgkmcnt(7)
    v_mfma_f32_32x32x16_bf16 v[192:207], v[232:235], v[88:91], v[192:207]
    ds_read_b64_tr_b16 v[248:249], v6 offset:30720
    ds_read_b64_tr_b16 v[250:251], v6 offset:31232
    s_waitcnt lgkmcnt(7)
    v_mfma_f32_32x32x16_bf16 v[208:223], v[236:239], v[88:91], v[208:223]
    ds_read_b64_tr_b16 v[252:253], v6 offset:30976
    ds_read_b64_tr_b16 v[254:255], v6 offset:31488
    s_waitcnt lgkmcnt(0)
    s_barrier
    v_add_u32 v2, s55, v2
    v_add_u32 v3, s55, v3
    v_add_u32 v4, s55, v4
    v_add_u32 v5, s55, v5
    v_add_u32 v6, s55, v6
    buffer_load_dwordx2 v[30:31], v7, s[72:75], 0 offen sc1
    v_mfma_f32_32x32x16_bf16 v[160:175], v[92:95], v[240:243], v[160:175]
    ds_read_b128 v[96:99], v2
    ds_read_b64_tr_b16 v[224:225], v6 offset:16384
    ds_read_b64_tr_b16 v[226:227], v6 offset:16896
    v_mfma_f32_32x32x16_bf16 v[176:191], v[92:95], v[244:247], v[176:191]
    ds_read_b64_tr_b16 v[228:229], v6 offset:16640
    ds_read_b64_tr_b16 v[230:231], v6 offset:17152
    v_mfma_f32_32x32x16_bf16 v[192:207], v[248:251], v[92:95], v[192:207]
    ds_read_b64_tr_b16 v[232:233], v6 offset:24576
    ds_read_b64_tr_b16 v[234:235], v6 offset:25088
    v_mfma_f32_32x32x16_bf16 v[208:223], v[252:255], v[92:95], v[208:223]
    ds_read_b64_tr_b16 v[236:237], v6 offset:24832
    ds_read_b64_tr_b16 v[238:239], v6 offset:25344
    s_waitcnt lgkmcnt(6)
    v_mfma_f32_32x32x16_bf16 v[160:175], v[96:99], v[224:227], v[160:175]
    ds_read_b128 v[100:103], v3
    ds_read_b64_tr_b16 v[240:241], v6 offset:18432
    ds_read_b64_tr_b16 v[242:243], v6 offset:18944
    s_waitcnt lgkmcnt(7)
    v_mfma_f32_32x32x16_bf16 v[176:191], v[96:99], v[228:231], v[176:191]
    ds_read_b64_tr_b16 v[244:245], v6 offset:18688
    ds_read_b64_tr_b16 v[246:247], v6 offset:19200
    s_waitcnt lgkmcnt(7)
    v_mfma_f32_32x32x16_bf16 v[192:207], v[232:235], v[96:99], v[192:207]
    ds_read_b64_tr_b16 v[248:249], v6 offset:26624
    ds_read_b64_tr_b16 v[250:251], v6 offset:27136
    s_waitcnt lgkmcnt(7)
    v_mfma_f32_32x32x16_bf16 v[208:223], v[236:239], v[96:99], v[208:223]
    ds_read_b64_tr_b16 v[252:253], v6 offset:26880
    ds_read_b64_tr_b16 v[254:255], v6 offset:27392
    s_waitcnt lgkmcnt(6)
    v_mfma_f32_32x32x16_bf16 v[160:175], v[100:103], v[240:243], v[160:175]
    ds_read_b128 v[104:107], v4
    ds_read_b64_tr_b16 v[224:225], v6 offset:20480
    ds_read_b64_tr_b16 v[226:227], v6 offset:20992
    s_waitcnt lgkmcnt(7)
    v_mfma_f32_32x32x16_bf16 v[176:191], v[100:103], v[244:247], v[176:191]
    ds_read_b64_tr_b16 v[228:229], v6 offset:20736
    ds_read_b64_tr_b16 v[230:231], v6 offset:21248
    s_waitcnt lgkmcnt(7)
    v_mfma_f32_32x32x16_bf16 v[192:207], v[248:251], v[100:103], v[192:207]
    ds_read_b64_tr_b16 v[232:233], v6 offset:28672
    ds_read_b64_tr_b16 v[234:235], v6 offset:29184
    s_waitcnt lgkmcnt(7)
    v_mfma_f32_32x32x16_bf16 v[208:223], v[252:255], v[100:103], v[208:223]
    ds_read_b64_tr_b16 v[236:237], v6 offset:28928
    ds_read_b64_tr_b16 v[238:239], v6 offset:29440
    s_waitcnt lgkmcnt(6)
    v_mfma_f32_32x32x16_bf16 v[160:175], v[104:107], v[224:227], v[160:175]
    ds_read_b128 v[108:111], v5
    ds_read_b64_tr_b16 v[240:241], v6 offset:22528
    ds_read_b64_tr_b16 v[242:243], v6 offset:23040
    s_waitcnt lgkmcnt(7)
    v_mfma_f32_32x32x16_bf16 v[176:191], v[104:107], v[228:231], v[176:191]
    ds_read_b64_tr_b16 v[244:245], v6 offset:22784
    ds_read_b64_tr_b16 v[246:247], v6 offset:23296
    s_waitcnt lgkmcnt(7)
    v_mfma_f32_32x32x16_bf16 v[192:207], v[232:235], v[104:107], v[192:207]
    ds_read_b64_tr_b16 v[248:249], v6 offset:30720
    ds_read_b64_tr_b16 v[250:251], v6 offset:31232
    s_waitcnt lgkmcnt(7)
    v_mfma_f32_32x32x16_bf16 v[208:223], v[236:239], v[104:107], v[208:223]
    ds_read_b64_tr_b16 v[252:253], v6 offset:30976
    ds_read_b64_tr_b16 v[254:255], v6 offset:31488
    s_waitcnt lgkmcnt(0)
    s_barrier
    v_add_u32 v2, s56, v2
    v_add_u32 v3, s56, v3
    v_add_u32 v4, s56, v4
    v_add_u32 v5, s56, v5
    v_add_u32 v6, s56, v6
    v_lshlrev_b32 v18, 3, v9
    buffer_load_dwordx2 v[10:11], v18, s[92:95], s89 offen offset:0
    buffer_load_dwordx2 v[14:15], v18, s[92:95], s89 offen offset:16
    buffer_load_dwordx2 v[16:17], v18, s[92:95], s89 offen offset:32
    buffer_load_dwordx2 v[18:19], v18, s[92:95], s89 offen offset:48
    v_mfma_f32_32x32x16_bf16 v[160:175], v[108:111], v[240:243], v[160:175]
    ds_read_b128 v[112:115], v2
    ds_read_b64_tr_b16 v[224:225], v6 offset:16384
    ds_read_b64_tr_b16 v[226:227], v6 offset:16896
    v_mfma_f32_32x32x16_bf16 v[176:191], v[108:111], v[244:247], v[176:191]
    ds_read_b64_tr_b16 v[228:229], v6 offset:16640
    ds_read_b64_tr_b16 v[230:231], v6 offset:17152
    v_mfma_f32_32x32x16_bf16 v[192:207], v[248:251], v[108:111], v[192:207]
    ds_read_b64_tr_b16 v[232:233], v6 offset:24576
    ds_read_b64_tr_b16 v[234:235], v6 offset:25088
    v_mfma_f32_32x32x16_bf16 v[208:223], v[252:255], v[108:111], v[208:223]
    ds_read_b64_tr_b16 v[236:237], v6 offset:24832
    ds_read_b64_tr_b16 v[238:239], v6 offset:25344
    s_waitcnt lgkmcnt(6)
    v_mfma_f32_32x32x16_bf16 v[160:175], v[112:115], v[224:227], v[160:175]
    ds_read_b128 v[116:119], v3
    ds_read_b64_tr_b16 v[240:241], v6 offset:18432
    ds_read_b64_tr_b16 v[242:243], v6 offset:18944
    s_waitcnt lgkmcnt(7)
    v_mfma_f32_32x32x16_bf16 v[176:191], v[112:115], v[228:231], v[176:191]
    ds_read_b64_tr_b16 v[244:245], v6 offset:18688
    ds_read_b64_tr_b16 v[246:247], v6 offset:19200
    s_waitcnt lgkmcnt(7)
    v_mfma_f32_32x32x16_bf16 v[192:207], v[232:235], v[112:115], v[192:207]
    ds_read_b64_tr_b16 v[248:249], v6 offset:26624
    ds_read_b64_tr_b16 v[250:251], v6 offset:27136
    s_waitcnt lgkmcnt(7)
    v_mfma_f32_32x32x16_bf16 v[208:223], v[236:239], v[112:115], v[208:223]
    ds_read_b64_tr_b16 v[252:253], v6 offset:26880
    ds_read_b64_tr_b16 v[254:255], v6 offset:27392
    s_waitcnt lgkmcnt(6)
    v_mfma_f32_32x32x16_bf16 v[160:175], v[116:119], v[240:243], v[160:175]
    ds_read_b128 v[120:123], v4
    ds_read_b64_tr_b16 v[224:225], v6 offset:20480
    ds_read_b64_tr_b16 v[226:227], v6 offset:20992
    s_waitcnt lgkmcnt(7)
    v_mfma_f32_32x32x16_bf16 v[176:191], v[116:119], v[244:247], v[176:191]
    ds_read_b64_tr_b16 v[228:229], v6 offset:20736
    ds_read_b64_tr_b16 v[230:231], v6 offset:21248
    s_waitcnt lgkmcnt(7)
    v_mfma_f32_32x32x16_bf16 v[192:207], v[248:251], v[116:119], v[192:207]
    ds_read_b64_tr_b16 v[232:233], v6 offset:28672
    ds_read_b64_tr_b16 v[234:235], v6 offset:29184
    s_waitcnt lgkmcnt(7)
    v_mfma_f32_32x32x16_bf16 v[208:223], v[252:255], v[116:119], v[208:223]
    ds_read_b64_tr_b16 v[236:237], v6 offset:28928
    ds_read_b64_tr_b16 v[238:239], v6 offset:29440
    s_waitcnt lgkmcnt(6)
    v_mfma_f32_32x32x16_bf16 v[160:175], v[120:123], v[224:227], v[160:175]
    ds_read_b128 v[124:127], v5
    ds_read_b64_tr_b16 v[240:241], v6 offset:22528
    ds_read_b64_tr_b16 v[242:243], v6 offset:23040
    s_waitcnt lgkmcnt(7)
    v_mfma_f32_32x32x16_bf16 v[176:191], v[120:123], v[228:231], v[176:191]
    ds_read_b64_tr_b16 v[244:245], v6 offset:22784
    ds_read_b64_tr_b16 v[246:247], v6 offset:23296
    s_waitcnt lgkmcnt(7)
    v_mfma_f32_32x32x16_bf16 v[192:207], v[232:235], v[120:123], v[192:207]
    ds_read_b64_tr_b16 v[248:249], v6 offset:30720
    ds_read_b64_tr_b16 v[250:251], v6 offset:31232
    s_waitcnt lgkmcnt(7)
    v_mfma_f32_32x32x16_bf16 v[208:223], v[236:239], v[120:123], v[208:223]
    ds_read_b64_tr_b16 v[252:253], v6 offset:30976
    ds_read_b64_tr_b16 v[254:255], v6 offset:31488
    s_waitcnt lgkmcnt(0)
    s_barrier
    v_add_u32 v2, s55, v2
    v_add_u32 v3, s55, v3
    v_add_u32 v4, s55, v4
    v_add_u32 v5, s55, v5
    v_add_u32 v6, s55, v6
    v_lshlrev_b32 v26, 3, v9
    buffer_load_dwordx2 v[20:21], v26, s[92:95], s89 offen offset:64
    buffer_load_dwordx2 v[22:23], v26, s[92:95], s89 offen offset:80
    buffer_load_dwordx2 v[24:25], v26, s[92:95], s89 offen offset:96
    buffer_load_dwordx2 v[26:27], v26, s[92:95], s89 offen offset:112
    v_mfma_f32_32x32x16_bf16 v[160:175], v[124:127], v[240:243], v[160:175]
    ds_read_b128 v[128:131], v2
    ds_read_b64_tr_b16 v[224:225], v6 offset:16384
    ds_read_b64_tr_b16 v[226:227], v6 offset:16896
    v_mfma_f32_32x32x16_bf16 v[176:191], v[124:127], v[244:247], v[176:191]
    ds_read_b64_tr_b16 v[228:229], v6 offset:16640
    ds_read_b64_tr_b16 v[230:231], v6 offset:17152
    v_mfma_f32_32x32x16_bf16 v[192:207], v[248:251], v[124:127], v[192:207]
    ds_read_b64_tr_b16 v[232:233], v6 offset:24576
    ds_read_b64_tr_b16 v[234:235], v6 offset:25088
    v_mfma_f32_32x32x16_bf16 v[208:223], v[252:255], v[124:127], v[208:223]
    ds_read_b64_tr_b16 v[236:237], v6 offset:24832
    ds_read_b64_tr_b16 v[238:239], v6 offset:25344
    s_waitcnt lgkmcnt(6)
    v_mfma_f32_32x32x16_bf16 v[160:175], v[128:131], v[224:227], v[160:175]
    ds_read_b128 v[132:135], v3
    ds_read_b64_tr_b16 v[240:241], v6 offset:18432
    ds_read_b64_tr_b16 v[242:243], v6 offset:18944
    s_waitcnt lgkmcnt(7)
    v_mfma_f32_32x32x16_bf16 v[176:191], v[128:131], v[228:231], v[176:191]
    ds_read_b64_tr_b16 v[244:245], v6 offset:18688
    ds_read_b64_tr_b16 v[246:247], v6 offset:19200
    s_waitcnt lgkmcnt(7)
    v_mfma_f32_32x32x16_bf16 v[192:207], v[232:235], v[128:131], v[192:207]
    ds_read_b64_tr_b16 v[248:249], v6 offset:26624
    ds_read_b64_tr_b16 v[250:251], v6 offset:27136
    s_waitcnt lgkmcnt(7)
    v_mfma_f32_32x32x16_bf16 v[208:223], v[236:239], v[128:131], v[208:223]
    ds_read_b64_tr_b16 v[252:253], v6 offset:26880
    ds_read_b64_tr_b16 v[254:255], v6 offset:27392
    s_waitcnt lgkmcnt(6)
    v_mfma_f32_32x32x16_bf16 v[160:175], v[132:135], v[240:243], v[160:175]
    ds_read_b128 v[136:139], v4
    ds_read_b64_tr_b16 v[224:225], v6 offset:20480
    ds_read_b64_tr_b16 v[226:227], v6 offset:20992
    s_waitcnt lgkmcnt(7)
    v_mfma_f32_32x32x16_bf16 v[176:191], v[132:135], v[244:247], v[176:191]
    ds_read_b64_tr_b16 v[228:229], v6 offset:20736
    ds_read_b64_tr_b16 v[230:231], v6 offset:21248
    s_waitcnt lgkmcnt(7)
    v_mfma_f32_32x32x16_bf16 v[192:207], v[248:251], v[132:135], v[192:207]
    ds_read_b64_tr_b16 v[232:233], v6 offset:28672
    ds_read_b64_tr_b16 v[234:235], v6 offset:29184
    s_waitcnt lgkmcnt(7)
    v_mfma_f32_32x32x16_bf16 v[208:223], v[252:255], v[132:135], v[208:223]
    ds_read_b64_tr_b16 v[236:237], v6 offset:28928
    ds_read_b64_tr_b16 v[238:239], v6 offset:29440
    s_waitcnt lgkmcnt(6)
    v_mfma_f32_32x32x16_bf16 v[160:175], v[136:139], v[224:227], v[160:175]
    ds_read_b128 v[140:143], v5
    ds_read_b64_tr_b16 v[240:241], v6 offset:22528
    ds_read_b64_tr_b16 v[242:243], v6 offset:23040
    s_waitcnt lgkmcnt(7)
    v_mfma_f32_32x32x16_bf16 v[176:191], v[136:139], v[228:231], v[176:191]
    ds_read_b64_tr_b16 v[244:245], v6 offset:22784
    ds_read_b64_tr_b16 v[246:247], v6 offset:23296
    s_waitcnt lgkmcnt(7)
    v_mfma_f32_32x32x16_bf16 v[192:207], v[232:235], v[136:139], v[192:207]
    ds_read_b64_tr_b16 v[248:249], v6 offset:30720
    ds_read_b64_tr_b16 v[250:251], v6 offset:31232
    s_waitcnt lgkmcnt(7)
    v_mfma_f32_32x32x16_bf16 v[208:223], v[236:239], v[136:139], v[208:223]
    ds_read_b64_tr_b16 v[252:253], v6 offset:30976
    ds_read_b64_tr_b16 v[254:255], v6 offset:31488
    s_waitcnt lgkmcnt(0)
    s_barrier
    v_add_u32 v2, s55, v2
    v_add_u32 v3, s55, v3
    v_add_u32 v4, s55, v4
    v_add_u32 v5, s55, v5
    v_add_u32 v6, s55, v6
    v_mfma_f32_32x32x16_bf16 v[160:175], v[140:143], v[240:243], v[160:175]
    ds_read_b128 v[144:147], v2
    ds_read_b64_tr_b16 v[224:225], v6 offset:16384
    ds_read_b64_tr_b16 v[226:227], v6 offset:16896
    v_mfma_f32_32x32x16_bf16 v[176:191], v[140:143], v[244:247], v[176:191]
    ds_read_b64_tr_b16 v[228:229], v6 offset:16640
    ds_read_b64_tr_b16 v[230:231], v6 offset:17152
    v_mfma_f32_32x32x16_bf16 v[192:207], v[248:251], v[140:143], v[192:207]
    ds_read_b64_tr_b16 v[232:233], v6 offset:24576
    ds_read_b64_tr_b16 v[234:235], v6 offset:25088
    v_mfma_f32_32x32x16_bf16 v[208:223], v[252:255], v[140:143], v[208:223]
    ds_read_b64_tr_b16 v[236:237], v6 offset:24832
    ds_read_b64_tr_b16 v[238:239], v6 offset:25344
    s_waitcnt lgkmcnt(6)
    v_mfma_f32_32x32x16_bf16 v[160:175], v[144:147], v[224:227], v[160:175]
    ds_read_b128 v[148:151], v3
    ds_read_b64_tr_b16 v[240:241], v6 offset:18432
    ds_read_b64_tr_b16 v[242:243], v6 offset:18944
    s_waitcnt lgkmcnt(7)
    v_mfma_f32_32x32x16_bf16 v[176:191], v[144:147], v[228:231], v[176:191]
    ds_read_b64_tr_b16 v[244:245], v6 offset:18688
    ds_read_b64_tr_b16 v[246:247], v6 offset:19200
    s_waitcnt lgkmcnt(7)
    v_mfma_f32_32x32x16_bf16 v[192:207], v[232:235], v[144:147], v[192:207]
    ds_read_b64_tr_b16 v[248:249], v6 offset:26624
    ds_read_b64_tr_b16 v[250:251], v6 offset:27136
    s_waitcnt lgkmcnt(7)
    v_mfma_f32_32x32x16_bf16 v[208:223], v[236:239], v[144:147], v[208:223]
    ds_read_b64_tr_b16 v[252:253], v6 offset:26880
    ds_read_b64_tr_b16 v[254:255], v6 offset:27392
    s_waitcnt lgkmcnt(6)
    v_mfma_f32_32x32x16_bf16 v[160:175], v[148:151], v[240:243], v[160:175]
    ds_read_b128 v[152:155], v4
    ds_read_b64_tr_b16 v[224:225], v6 offset:20480
    ds_read_b64_tr_b16 v[226:227], v6 offset:20992
    s_waitcnt lgkmcnt(7)
    v_mfma_f32_32x32x16_bf16 v[176:191], v[148:151], v[244:247], v[176:191]
    ds_read_b64_tr_b16 v[228:229], v6 offset:20736
    ds_read_b64_tr_b16 v[230:231], v6 offset:21248
    s_waitcnt lgkmcnt(7)
    v_mfma_f32_32x32x16_bf16 v[192:207], v[248:251], v[148:151], v[192:207]
    ds_read_b64_tr_b16 v[232:233], v6 offset:28672
    ds_read_b64_tr_b16 v[234:235], v6 offset:29184
    s_waitcnt lgkmcnt(7)
    v_mfma_f32_32x32x16_bf16 v[208:223], v[252:255], v[148:151], v[208:223]
    ds_read_b64_tr_b16 v[236:237], v6 offset:28928
    ds_read_b64_tr_b16 v[238:239], v6 offset:29440
    s_waitcnt lgkmcnt(6)
    v_mfma_f32_32x32x16_bf16 v[160:175], v[152:155], v[224:227], v[160:175]
    ds_read_b128 v[156:159], v5
    ds_read_b64_tr_b16 v[240:241], v6 offset:22528
    ds_read_b64_tr_b16 v[242:243], v6 offset:23040
    s_waitcnt lgkmcnt(7)
    v_mfma_f32_32x32x16_bf16 v[176:191], v[152:155], v[228:231], v[176:191]
    ds_read_b64_tr_b16 v[244:245], v6 offset:22784
    ds_read_b64_tr_b16 v[246:247], v6 offset:23296
    s_waitcnt lgkmcnt(7)
    v_mfma_f32_32x32x16_bf16 v[192:207], v[232:235], v[152:155], v[192:207]
    ds_read_b64_tr_b16 v[248:249], v6 offset:30720
    ds_read_b64_tr_b16 v[250:251], v6 offset:31232
    s_waitcnt lgkmcnt(7)
    v_mfma_f32_32x32x16_bf16 v[208:223], v[236:239], v[152:155], v[208:223]
    ds_read_b64_tr_b16 v[252:253], v6 offset:30976
    ds_read_b64_tr_b16 v[254:255], v6 offset:31488
    s_waitcnt lgkmcnt(0)
    v_add_u32 v6, s55, v6
    v_mfma_f32_32x32x16_bf16 v[160:175], v[156:159], v[240:243], v[160:175]
    v_mfma_f32_32x32x16_bf16 v[176:191], v[156:159], v[244:247], v[176:191]
    v_mfma_f32_32x32x16_bf16 v[192:207], v[248:251], v[156:159], v[192:207]
    v_mfma_f32_32x32x16_bf16 v[208:223], v[252:255], v[156:159], v[208:223]
    s_waitcnt vmcnt(0)
    v_cmp_eq_u64 vcc, 0, v[30:31]
    s_nop 5
    s_cmp_eq_u64 vcc, 0
    s_cselect_b32 s54, 0, 2
    v_cvt_pk_bf16_f32 v240, v160, v161
    v_cvt_pk_bf16_f32 v241, v162, v163
    v_cvt_pk_bf16_f32 v242, v164, v165
    v_cvt_pk_bf16_f32 v243, v166, v167
    v_cvt_pk_bf16_f32 v244, v168, v169
    v_cvt_pk_bf16_f32 v245, v170, v171
    v_cvt_pk_bf16_f32 v246, v172, v173
    v_cvt_pk_bf16_f32 v247, v174, v175
    s_add_u32 s38, s57, 4194304
    buffer_store_dwordx4 v[240:243], v13, s[28:31], s38 offen sc1
    buffer_store_dwordx4 v[244:247], v13, s[28:31], s38 offen offset:256 sc1
    v_cvt_pk_bf16_f32 v248, v176, v177
    v_cvt_pk_bf16_f32 v249, v178, v179
    v_cvt_pk_bf16_f32 v250, v180, v181
    v_cvt_pk_bf16_f32 v251, v182, v183
    v_cvt_pk_bf16_f32 v252, v184, v185
    v_cvt_pk_bf16_f32 v253, v186, v187
    v_cvt_pk_bf16_f32 v254, v188, v189
    v_cvt_pk_bf16_f32 v255, v190, v191
    s_add_u32 s38, s57, 4325376
    buffer_store_dwordx4 v[248:251], v13, s[28:31], s38 offen sc1
    buffer_store_dwordx4 v[252:255], v13, s[28:31], s38 offen offset:256 sc1
    v_lshlrev_b32 v160, 16, v10
    v_and_b32 v161, 0xffff0000, v10
    v_lshlrev_b32 v162, 16, v11
    v_and_b32 v163, 0xffff0000, v11
    v_lshlrev_b32 v164, 16, v14
    v_and_b32 v165, 0xffff0000, v14
    v_lshlrev_b32 v166, 16, v15
    v_and_b32 v167, 0xffff0000, v15
    v_lshlrev_b32 v168, 16, v16
    v_and_b32 v169, 0xffff0000, v16
    v_lshlrev_b32 v170, 16, v17
    v_and_b32 v171, 0xffff0000, v17
    v_lshlrev_b32 v172, 16, v18
    v_and_b32 v173, 0xffff0000, v18
    v_lshlrev_b32 v174, 16, v19
    v_and_b32 v175, 0xffff0000, v19
    v_lshlrev_b32 v176, 16, v20
    v_and_b32 v177, 0xffff0000, v20
    v_lshlrev_b32 v178, 16, v21
    v_and_b32 v179, 0xffff0000, v21
    v_lshlrev_b32 v180, 16, v22
    v_and_b32 v181, 0xffff0000, v22
    v_lshlrev_b32 v182, 16, v23
    v_and_b32 v183, 0xffff0000, v23
    v_lshlrev_b32 v184, 16, v24
    v_and_b32 v185, 0xffff0000, v24
    v_lshlrev_b32 v186, 16, v25
    v_and_b32 v187, 0xffff0000, v25
    v_lshlrev_b32 v188, 16, v26
    v_and_b32 v189, 0xffff0000, v26
    v_lshlrev_b32 v190, 16, v27
    v_and_b32 v191, 0xffff0000, v27
    v_mov_b32 v10, 0x3fb8aa3b
    v_mov_b32 v11, 0x3fb8aa3b
    v_mov_b32 v14, 2.0
    v_mov_b32 v15, 2.0
    v_pk_mul_f32 v[16:17], v[192:193], v[10:11]
    v_pk_mul_f32 v[18:19], v[194:195], v[10:11]
    v_min_f32 v16, 0x41f00000, v16
    v_min_f32 v17, 0x41f00000, v17
    v_min_f32 v18, 0x41f00000, v18
    v_min_f32 v19, 0x41f00000, v19
    v_exp_f32 v20, v16
    v_exp_f32 v21, v17
    v_exp_f32 v22, v18
    v_exp_f32 v23, v19
    v_pk_add_f32 v[24:25], v[20:21], v[14:15]
    v_pk_add_f32 v[26:27], v[22:23], v[14:15]
    v_pk_mul_f32 v[20:21], v[20:21], v[24:25]
    v_pk_mul_f32 v[22:23], v[22:23], v[26:27]
    v_pk_add_f32 v[24:25], v[20:21], v[14:15]
    v_pk_add_f32 v[26:27], v[22:23], v[14:15]
    v_rcp_f32 v16, v24
    v_rcp_f32 v17, v25
    v_rcp_f32 v18, v26
    v_rcp_f32 v19, v27
    v_pk_mul_f32 v[20:21], v[20:21], v[16:17]
    v_pk_mul_f32 v[22:23], v[22:23], v[18:19]
    v_pk_mul_f32 v[20:21], v[20:21], v[192:193]
    v_pk_mul_f32 v[22:23], v[22:23], v[194:195]
    v_cvt_pk_bf16_f32 v192, v20, v21
    v_cvt_pk_bf16_f32 v193, v22, v23
    v_pk_mul_f32 v[16:17], v[196:197], v[10:11]
    v_pk_mul_f32 v[18:19], v[198:199], v[10:11]
    v_min_f32 v16, 0x41f00000, v16
    v_min_f32 v17, 0x41f00000, v17
    v_min_f32 v18, 0x41f00000, v18
    v_min_f32 v19, 0x41f00000, v19
    v_exp_f32 v20, v16
    v_exp_f32 v21, v17
    v_exp_f32 v22, v18
    v_exp_f32 v23, v19
    v_pk_add_f32 v[24:25], v[20:21], v[14:15]
    v_pk_add_f32 v[26:27], v[22:23], v[14:15]
    v_pk_mul_f32 v[20:21], v[20:21], v[24:25]
    v_pk_mul_f32 v[22:23], v[22:23], v[26:27]
    v_pk_add_f32 v[24:25], v[20:21], v[14:15]
    v_pk_add_f32 v[26:27], v[22:23], v[14:15]
    v_rcp_f32 v16, v24
    v_rcp_f32 v17, v25
    v_rcp_f32 v18, v26
    v_rcp_f32 v19, v27
    v_pk_mul_f32 v[20:21], v[20:21], v[16:17]
    v_pk_mul_f32 v[22:23], v[22:23], v[18:19]
    v_pk_mul_f32 v[20:21], v[20:21], v[196:197]
    v_pk_mul_f32 v[22:23], v[22:23], v[198:199]
    v_cvt_pk_bf16_f32 v194, v20, v21
    v_cvt_pk_bf16_f32 v195, v22, v23
    v_pk_mul_f32 v[16:17], v[200:201], v[10:11]
    v_pk_mul_f32 v[18:19], v[202:203], v[10:11]
    v_min_f32 v16, 0x41f00000, v16
    v_min_f32 v17, 0x41f00000, v17
    v_min_f32 v18, 0x41f00000, v18
    v_min_f32 v19, 0x41f00000, v19
    v_exp_f32 v20, v16
    v_exp_f32 v21, v17
    v_exp_f32 v22, v18
    v_exp_f32 v23, v19
    v_pk_add_f32 v[24:25], v[20:21], v[14:15]
    v_pk_add_f32 v[26:27], v[22:23], v[14:15]
    v_pk_mul_f32 v[20:21], v[20:21], v[24:25]
    v_pk_mul_f32 v[22:23], v[22:23], v[26:27]
    v_pk_add_f32 v[24:25], v[20:21], v[14:15]
    v_pk_add_f32 v[26:27], v[22:23], v[14:15]
    v_rcp_f32 v16, v24
    v_rcp_f32 v17, v25
    v_rcp_f32 v18, v26
    v_rcp_f32 v19, v27
    v_pk_mul_f32 v[20:21], v[20:21], v[16:17]
    v_pk_mul_f32 v[22:23], v[22:23], v[18:19]
    v_pk_mul_f32 v[20:21], v[20:21], v[200:201]
    v_pk_mul_f32 v[22:23], v[22:23], v[202:203]
    v_cvt_pk_bf16_f32 v196, v20, v21
    v_cvt_pk_bf16_f32 v197, v22, v23
    v_pk_mul_f32 v[16:17], v[204:205], v[10:11]
    v_pk_mul_f32 v[18:19], v[206:207], v[10:11]
    v_min_f32 v16, 0x41f00000, v16
    v_min_f32 v17, 0x41f00000, v17
    v_min_f32 v18, 0x41f00000, v18
    v_min_f32 v19, 0x41f00000, v19
    v_exp_f32 v20, v16
    v_exp_f32 v21, v17
    v_exp_f32 v22, v18
    v_exp_f32 v23, v19
    v_pk_add_f32 v[24:25], v[20:21], v[14:15]
    v_pk_add_f32 v[26:27], v[22:23], v[14:15]
    v_pk_mul_f32 v[20:21], v[20:21], v[24:25]
    v_pk_mul_f32 v[22:23], v[22:23], v[26:27]
    v_pk_add_f32 v[24:25], v[20:21], v[14:15]
    v_pk_add_f32 v[26:27], v[22:23], v[14:15]
    v_rcp_f32 v16, v24
    v_rcp_f32 v17, v25
    v_rcp_f32 v18, v26
    v_rcp_f32 v19, v27
    v_pk_mul_f32 v[20:21], v[20:21], v[16:17]
    v_pk_mul_f32 v[22:23], v[22:23], v[18:19]
    v_pk_mul_f32 v[20:21], v[20:21], v[204:205]
    v_pk_mul_f32 v[22:23], v[22:23], v[206:207]
    v_cvt_pk_bf16_f32 v198, v20, v21
    v_cvt_pk_bf16_f32 v199, v22, v23
    s_getreg_b32 s46, hwreg(HW_REG_IB_STS)
    s_and_b32 s46, s46, 0x00c0000f
    s_or_b32 s46, s46, s54
    s_cbranch_scc1 L_NBQ_21
    s_waitcnt vmcnt(0)
    v_lshlrev_b32 v13, 3, v1
    s_mov_b64 exec, 255
    buffer_store_dwordx2 v[30:31], v13, s[28:31], s51 offen sc1
    s_mov_b64 exec, -1
    s_mov_b32 s54, 1
    L_NBQ_21:
    v_pk_mul_f32 v[16:17], v[208:209], v[10:11]
    v_pk_mul_f32 v[18:19], v[210:211], v[10:11]
    v_min_f32 v16, 0x41f00000, v16
    v_min_f32 v17, 0x41f00000, v17
    v_min_f32 v18, 0x41f00000, v18
    v_min_f32 v19, 0x41f00000, v19
    v_exp_f32 v20, v16
    v_exp_f32 v21, v17
    v_exp_f32 v22, v18
    v_exp_f32 v23, v19
    v_pk_add_f32 v[24:25], v[20:21], v[14:15]
    v_pk_add_f32 v[26:27], v[22:23], v[14:15]
    v_pk_mul_f32 v[20:21], v[20:21], v[24:25]
    v_pk_mul_f32 v[22:23], v[22:23], v[26:27]
    v_pk_add_f32 v[24:25], v[20:21], v[14:15]
    v_pk_add_f32 v[26:27], v[22:23], v[14:15]
    v_rcp_f32 v16, v24
    v_rcp_f32 v17, v25
    v_rcp_f32 v18, v26
    v_rcp_f32 v19, v27
    v_pk_mul_f32 v[20:21], v[20:21], v[16:17]
    v_pk_mul_f32 v[22:23], v[22:23], v[18:19]
    v_pk_mul_f32 v[20:21], v[20:21], v[208:209]
    v_pk_mul_f32 v[22:23], v[22:23], v[210:211]
    v_cvt_pk_bf16_f32 v208, v20, v21
    v_cvt_pk_bf16_f32 v209, v22, v23
    v_pk_mul_f32 v[16:17], v[212:213], v[10:11]
    v_pk_mul_f32 v[18:19], v[214:215], v[10:11]
    v_min_f32 v16, 0x41f00000, v16
    v_min_f32 v17, 0x41f00000, v17
    v_min_f32 v18, 0x41f00000, v18
    v_min_f32 v19, 0x41f00000, v19
    v_exp_f32 v20, v16
    v_exp_f32 v21, v17
    v_exp_f32 v22, v18
    v_exp_f32 v23, v19
    v_pk_add_f32 v[24:25], v[20:21], v[14:15]
    v_pk_add_f32 v[26:27], v[22:23], v[14:15]
    v_pk_mul_f32 v[20:21], v[20:21], v[24:25]
    v_pk_mul_f32 v[22:23], v[22:23], v[26:27]
    v_pk_add_f32 v[24:25], v[20:21], v[14:15]
    v_pk_add_f32 v[26:27], v[22:23], v[14:15]
    v_rcp_f32 v16, v24
    v_rcp_f32 v17, v25
    v_rcp_f32 v18, v26
    v_rcp_f32 v19, v27
    v_pk_mul_f32 v[20:21], v[20:21], v[16:17]
    v_pk_mul_f32 v[22:23], v[22:23], v[18:19]
    v_pk_mul_f32 v[20:21], v[20:21], v[212:213]
    v_pk_mul_f32 v[22:23], v[22:23], v[214:215]
    v_cvt_pk_bf16_f32 v210, v20, v21
    v_cvt_pk_bf16_f32 v211, v22, v23
    s_getreg_b32 s46, hwreg(HW_REG_IB_STS)
    s_and_b32 s46, s46, 0x00c0000f
    s_or_b32 s46, s46, s54
    s_cbranch_scc1 L_NBQ_22
    s_waitcnt vmcnt(0)
    v_lshlrev_b32 v13, 3, v1
    s_mov_b64 exec, 255
    buffer_store_dwordx2 v[30:31], v13, s[28:31], s51 offen sc1
    s_mov_b64 exec, -1
    s_mov_b32 s54, 1
    L_NBQ_22:
    v_pk_mul_f32 v[16:17], v[216:217], v[10:11]
    v_pk_mul_f32 v[18:19], v[218:219], v[10:11]
    v_min_f32 v16, 0x41f00000, v16
    v_min_f32 v17, 0x41f00000, v17
    v_min_f32 v18, 0x41f00000, v18
    v_min_f32 v19, 0x41f00000, v19
    v_exp_f32 v20, v16
    v_exp_f32 v21, v17
    v_exp_f32 v22, v18
    v_exp_f32 v23, v19
    v_pk_add_f32 v[24:25], v[20:21], v[14:15]
    v_pk_add_f32 v[26:27], v[22:23], v[14:15]
    v_pk_mul_f32 v[20:21], v[20:21], v[24:25]
    v_pk_mul_f32 v[22:23], v[22:23], v[26:27]
    v_pk_add_f32 v[24:25], v[20:21], v[14:15]
    v_pk_add_f32 v[26:27], v[22:23], v[14:15]
    v_rcp_f32 v16, v24
    v_rcp_f32 v17, v25
    v_rcp_f32 v18, v26
    v_rcp_f32 v19, v27
    v_pk_mul_f32 v[20:21], v[20:21], v[16:17]
    v_pk_mul_f32 v[22:23], v[22:23], v[18:19]
    v_pk_mul_f32 v[20:21], v[20:21], v[216:217]
    v_pk_mul_f32 v[22:23], v[22:23], v[218:219]
    v_cvt_pk_bf16_f32 v212, v20, v21
    v_cvt_pk_bf16_f32 v213, v22, v23
    v_pk_mul_f32 v[16:17], v[220:221], v[10:11]
    v_pk_mul_f32 v[18:19], v[222:223], v[10:11]
    v_min_f32 v16, 0x41f00000, v16
    v_min_f32 v17, 0x41f00000, v17
    v_min_f32 v18, 0x41f00000, v18
    v_min_f32 v19, 0x41f00000, v19
    v_exp_f32 v20, v16
    v_exp_f32 v21, v17
    v_exp_f32 v22, v18
    v_exp_f32 v23, v19
    v_pk_add_f32 v[24:25], v[20:21], v[14:15]
    v_pk_add_f32 v[26:27], v[22:23], v[14:15]
    v_pk_mul_f32 v[20:21], v[20:21], v[24:25]
    v_pk_mul_f32 v[22:23], v[22:23], v[26:27]
    v_pk_add_f32 v[24:25], v[20:21], v[14:15]
    v_pk_add_f32 v[26:27], v[22:23], v[14:15]
    v_rcp_f32 v16, v24
    v_rcp_f32 v17, v25
    v_rcp_f32 v18, v26
    v_rcp_f32 v19, v27
    v_pk_mul_f32 v[20:21], v[20:21], v[16:17]
    v_pk_mul_f32 v[22:23], v[22:23], v[18:19]
    v_pk_mul_f32 v[20:21], v[20:21], v[220:221]
    v_pk_mul_f32 v[22:23], v[22:23], v[222:223]
    v_cvt_pk_bf16_f32 v214, v20, v21
    v_cvt_pk_bf16_f32 v215, v22, v23
    s_getreg_b32 s46, hwreg(HW_REG_IB_STS)
    s_and_b32 s46, s46, 0x00c0000f
    s_or_b32 s46, s46, s54
    s_cbranch_scc1 L_NBQ_23
    s_waitcnt vmcnt(0)
    v_lshlrev_b32 v13, 3, v1
    s_mov_b64 exec, 255
    buffer_store_dwordx2 v[30:31], v13, s[28:31], s51 offen sc1
    s_mov_b64 exec, -1
    s_mov_b32 s54, 1
    L_NBQ_23:
    s_lshl_b32 s46, s26, 4
    s_add_u32 s46, s46, 128
    v_mov_b32 v2, s46
    v_mov_b32 v3, s97
    ds_write_b64 v2, v[30:31]
    ds_write_b32 v2, v3 offset:8
    s_waitcnt lgkmcnt(0)
    s_barrier
    ds_read_b64_tr_b16 v[224:225], v6 offset:0
    ds_read_b64_tr_b16 v[226:227], v6 offset:512
    ds_read_b64_tr_b16 v[228:229], v6 offset:256
    ds_read_b64_tr_b16 v[230:231], v6 offset:768
    ds_read_b64_tr_b16 v[232:233], v6 offset:2048
    ds_read_b64_tr_b16 v[234:235], v6 offset:2560
    ds_read_b64_tr_b16 v[236:237], v6 offset:2304
    ds_read_b64_tr_b16 v[238:239], v6 offset:2816
    s_nop 0
    s_cmp_lt_u32 s45, 22
    s_cbranch_scc1 L_P1Y
    s_mov_b32 s36, s16
    s_and_b32 s37, s17, 0xffff
    s_mov_b32 s38, 1409024
    s_mov_b32 s39, 0x00020000
    v_and_b32 v2, 15, v1
    v_lshrrev_b32 v2, 2, v2
    v_lshrrev_b32 v3, 5, v1
    v_lshl_add_u32 v2, v3, 2, v2
    v_mul_u32_u24 v4, 1024, v2
    v_bfe_u32 v3, v1, 4, 1
    v_lshl_add_u32 v4, v3, 6, v4
    v_and_b32 v3, 3, v1
    v_lshl_add_u32 v4, v3, 4, v4
    s_lshl_b32 s48, s33, 7
    v_add_u32 v4, s48, v4
    v_add_u32 v5, 7168, v4
    s_lshl_b32 s62, s26, 11
    s_add_u32 s62, s62, 98304
    s_mov_b32 s76, 0
    s_lshl_b32 s58, s26, 14
    s_add_u32 s59, s58, 1441792
    s_and_b32 s46, s32, 3
    s_mul_i32 s46, s46, 5
    s_cmp_eq_u32 s33, 3
    s_cselect_b32 s46, s46, 0
    s_mul_i32 s63, s27, 0
    s_add_u32 s63, s63, s46
    s_sub_u32 s46, s63, 22
    s_cmp_ge_u32 s63, 22
    s_cselect_b32 s63, s46, s63
    s_add_u32 s63, s63, 7
    s_sub_u32 s46, s63, 22
    s_cmp_ge_u32 s63, 22
    s_cselect_b32 s63, s46, s63
    s_lshl_b32 s63, s63, 16
    s_add_u32 s63, s63, s58
    s_waitcnt lgkmcnt(0)
    s_cmp_eq_u32 s54, 1
    s_cbranch_scc1 L_P1YX
    s_waitcnt vmcnt(0)
    v_cmp_eq_u64 vcc, 0, v[30:31]
    s_cbranch_vccz L_HN_YL
    s_mov_b32 s96, 0
L_PN_YL:
    buffer_load_dwordx2 v[30:31], v7, s[72:75], 0 offen sc1
    s_add_u32 s96, s96, 1
    s_waitcnt vmcnt(0)
    v_cmp_eq_u64 vcc, 0, v[30:31]
    s_cmp_ge_u32 s96, 200000
    s_cbranch_scc1 L_PN_YL_X
    s_cbranch_vccz L_PN_YL_X
    s_sleep 1
    s_branch L_PN_YL
L_PN_YL_X:
L_HN_YL:
    v_lshlrev_b32 v13, 3, v1
    s_mov_b64 exec, 255
    buffer_store_dwordx2 v[30:31], v13, s[28:31], s51 offen sc1
    s_mov_b64 exec, -1
    s_branch L_P1YX
L_P1Y:
    s_waitcnt lgkmcnt(6)
    v_mfma_f32_32x32x16_bf16 v[160:175], v[224:227], v[32:35], v[160:175]
    ds_read_b64_tr_b16 v[240:241], v6 offset:4096
    ds_read_b64_tr_b16 v[242:243], v6 offset:4608
    s_mov_b32 s36, s16
    s_and_b32 s37, s17, 0xffff
    s_waitcnt lgkmcnt(6)
    v_mfma_f32_32x32x16_bf16 v[176:191], v[228:231], v[32:35], v[176:191]
    ds_read_b64_tr_b16 v[244:245], v6 offset:4352
    ds_read_b64_tr_b16 v[246:247], v6 offset:4864
    s_mov_b32 s38, 1409024
    s_mov_b32 s39, 0x00020000
    s_waitcnt lgkmcnt(6)
    v_mfma_f32_32x32x16_bf16 v[160:175], v[232:235], v[36:39], v[160:175]
    ds_read_b64_tr_b16 v[224:225], v6 offset:6144
    ds_read_b64_tr_b16 v[226:227], v6 offset:6656
    v_and_b32 v2, 15, v1
    v_lshrrev_b32 v2, 2, v2
    s_waitcnt lgkmcnt(6)
    v_mfma_f32_32x32x16_bf16 v[176:191], v[236:239], v[36:39], v[176:191]
    ds_read_b64_tr_b16 v[228:229], v6 offset:6400
    ds_read_b64_tr_b16 v[230:231], v6 offset:6912
    v_lshrrev_b32 v3, 5, v1
    v_lshl_add_u32 v2, v3, 2, v2
    s_getreg_b32 s46, hwreg(HW_REG_IB_STS)
    s_and_b32 s46, s46, 0x00c0000f
    s_or_b32 s46, s46, s54
    s_cbranch_scc1 L_NBQ_24
    s_waitcnt vmcnt(0)
    v_lshlrev_b32 v13, 3, v1
    s_mov_b64 exec, 255
    buffer_store_dwordx2 v[30:31], v13, s[28:31], s51 offen sc1
    s_mov_b64 exec, -1
    s_mov_b32 s54, 1
    L_NBQ_24:
    s_waitcnt lgkmcnt(6)
    v_mfma_f32_32x32x16_bf16 v[160:175], v[240:243], v[40:43], v[160:175]
    ds_read_b64_tr_b16 v[232:233], v6 offset:8192
    ds_read_b64_tr_b16 v[234:235], v6 offset:8704
    v_mul_u32_u24 v4, 1024, v2
    v_bfe_u32 v3, v1, 4, 1
    s_waitcnt lgkmcnt(6)
    v_mfma_f32_32x32x16_bf16 v[176:191], v[244:247], v[40:43], v[176:191]
    ds_read_b64_tr_b16 v[236:237], v6 offset:8448
    ds_read_b64_tr_b16 v[238:239], v6 offset:8960
    v_lshl_add_u32 v4, v3, 6, v4
    v_and_b32 v3, 3, v1
    s_waitcnt lgkmcnt(6)
    v_mfma_f32_32x32x16_bf16 v[160:175], v[224:227], v[44:47], v[160:175]
    ds_read_b64_tr_b16 v[240:241], v6 offset:10240
    ds_read_b64_tr_b16 v[242:243], v6 offset:10752
    v_lshl_add_u32 v4, v3, 4, v4
    s_lshl_b32 s48, s33, 7
    s_waitcnt lgkmcnt(6)
    v_mfma_f32_32x32x16_bf16 v[176:191], v[228:231], v[44:47], v[176:191]
    ds_read_b64_tr_b16 v[244:245], v6 offset:10496
    ds_read_b64_tr_b16 v[246:247], v6 offset:11008
    v_add_u32 v4, s48, v4
    v_add_u32 v5, 7168, v4
    s_getreg_b32 s46, hwreg(HW_REG_IB_STS)
    s_and_b32 s46, s46, 0x00c0000f
    s_or_b32 s46, s46, s54
    s_cbranch_scc1 L_NBQ_25
    s_waitcnt vmcnt(0)
    v_lshlrev_b32 v13, 3, v1
    s_mov_b64 exec, 255
    buffer_store_dwordx2 v[30:31], v13, s[28:31], s51 offen sc1
    s_mov_b64 exec, -1
    s_mov_b32 s54, 1
    L_NBQ_25:
    s_waitcnt lgkmcnt(6)
    v_mfma_f32_32x32x16_bf16 v[160:175], v[232:235], v[48:51], v[160:175]
    ds_read_b64_tr_b16 v[224:225], v6 offset:12288
    ds_read_b64_tr_b16 v[226:227], v6 offset:12800
    s_lshl_b32 s62, s26, 11
    s_add_u32 s62, s62, 98304
    s_waitcnt lgkmcnt(6)
    v_mfma_f32_32x32x16_bf16 v[176:191], v[236:239], v[48:51], v[176:191]
    ds_read_b64_tr_b16 v[228:229], v6 offset:12544
    ds_read_b64_tr_b16 v[230:231], v6 offset:13056
    s_mov_b32 s76, 0
    s_lshl_b32 s58, s26, 14
    s_waitcnt lgkmcnt(6)
    v_mfma_f32_32x32x16_bf16 v[160:175], v[240:243], v[52:55], v[160:175]
    ds_read_b64_tr_b16 v[232:233], v6 offset:14336
    ds_read_b64_tr_b16 v[234:235], v6 offset:14848
    s_add_u32 s59, s58, 1441792
    s_and_b32 s46, s32, 3
    s_mul_i32 s46, s46, 5
    s_cmp_eq_u32 s33, 3
    s_cselect_b32 s46, s46, 0
    s_mul_i32 s63, s27, 0
    s_add_u32 s63, s63, s46
    s_sub_u32 s46, s63, 22
    s_cmp_ge_u32 s63, 22
    s_cselect_b32 s63, s46, s63
    s_add_u32 s63, s63, 7
    s_sub_u32 s46, s63, 22
    s_cmp_ge_u32 s63, 22
    s_cselect_b32 s63, s46, s63
    s_lshl_b32 s63, s63, 16
    s_add_u32 s63, s63, s58
    s_waitcnt lgkmcnt(6)
    v_mfma_f32_32x32x16_bf16 v[176:191], v[244:247], v[52:55], v[176:191]
    ds_read_b64_tr_b16 v[236:237], v6 offset:14592
    ds_read_b64_tr_b16 v[238:239], v6 offset:15104
    s_getreg_b32 s46, hwreg(HW_REG_IB_STS)
    s_and_b32 s46, s46, 0x00c0000f
    s_or_b32 s46, s46, s54
    s_cbranch_scc1 L_NBQ_26
    s_waitcnt vmcnt(0)
    v_lshlrev_b32 v13, 3, v1
    s_mov_b64 exec, 255
    buffer_store_dwordx2 v[30:31], v13, s[28:31], s51 offen sc1
    s_mov_b64 exec, -1
    s_mov_b32 s54, 1
    L_NBQ_26:
    s_waitcnt lgkmcnt(6)
    v_mfma_f32_32x32x16_bf16 v[160:175], v[224:227], v[56:59], v[160:175]
    ds_read_b64_tr_b16 v[240:241], v6 offset:16384
    ds_read_b64_tr_b16 v[242:243], v6 offset:16896
    s_waitcnt lgkmcnt(6)
    v_mfma_f32_32x32x16_bf16 v[176:191], v[228:231], v[56:59], v[176:191]
    ds_read_b64_tr_b16 v[244:245], v6 offset:16640
    ds_read_b64_tr_b16 v[246:247], v6 offset:17152
    s_waitcnt lgkmcnt(6)
    v_mfma_f32_32x32x16_bf16 v[160:175], v[232:235], v[60:63], v[160:175]
    ds_read_b64_tr_b16 v[224:225], v6 offset:18432
    ds_read_b64_tr_b16 v[226:227], v6 offset:18944
    s_waitcnt lgkmcnt(6)
    v_mfma_f32_32x32x16_bf16 v[176:191], v[236:239], v[60:63], v[176:191]
    ds_read_b64_tr_b16 v[228:229], v6 offset:18688
    ds_read_b64_tr_b16 v[230:231], v6 offset:19200
    s_getreg_b32 s46, hwreg(HW_REG_IB_STS)
    s_and_b32 s46, s46, 0x00c0000f
    s_or_b32 s46, s46, s54
    s_cbranch_scc1 L_NBQ_27
    s_waitcnt vmcnt(0)
    v_lshlrev_b32 v13, 3, v1
    s_mov_b64 exec, 255
    buffer_store_dwordx2 v[30:31], v13, s[28:31], s51 offen sc1
    s_mov_b64 exec, -1
    s_mov_b32 s54, 1
    L_NBQ_27:
    s_waitcnt lgkmcnt(6)
    v_mfma_f32_32x32x16_bf16 v[160:175], v[240:243], v[64:67], v[160:175]
    ds_read_b64_tr_b16 v[232:233], v6 offset:20480
    ds_read_b64_tr_b16 v[234:235], v6 offset:20992
    s_waitcnt lgkmcnt(6)
    v_mfma_f32_32x32x16_bf16 v[176:191], v[244:247], v[64:67], v[176:191]
    ds_read_b64_tr_b16 v[236:237], v6 offset:20736
    ds_read_b64_tr_b16 v[238:239], v6 offset:21248
    s_waitcnt lgkmcnt(6)
    v_mfma_f32_32x32x16_bf16 v[160:175], v[224:227], v[68:71], v[160:175]
    ds_read_b64_tr_b16 v[240:241], v6 offset:22528
    ds_read_b64_tr_b16 v[242:243], v6 offset:23040
    s_waitcnt lgkmcnt(6)
    v_mfma_f32_32x32x16_bf16 v[176:191], v[228:231], v[68:71], v[176:191]
    ds_read_b64_tr_b16 v[244:245], v6 offset:22784
    ds_read_b64_tr_b16 v[246:247], v6 offset:23296
    s_getreg_b32 s46, hwreg(HW_REG_IB_STS)
    s_and_b32 s46, s46, 0x00c0000f
    s_or_b32 s46, s46, s54
    s_cbranch_scc1 L_NBQ_28
    s_waitcnt vmcnt(0)
    v_lshlrev_b32 v13, 3, v1
    s_mov_b64 exec, 255
    buffer_store_dwordx2 v[30:31], v13, s[28:31], s51 offen sc1
    s_mov_b64 exec, -1
    s_mov_b32 s54, 1
    L_NBQ_28:
    s_waitcnt lgkmcnt(6)
    v_mfma_f32_32x32x16_bf16 v[160:175], v[232:235], v[72:75], v[160:175]
    ds_read_b64_tr_b16 v[224:225], v6 offset:24576
    ds_read_b64_tr_b16 v[226:227], v6 offset:25088
    s_waitcnt lgkmcnt(6)
    v_mfma_f32_32x32x16_bf16 v[176:191], v[236:239], v[72:75], v[176:191]
    ds_read_b64_tr_b16 v[228:229], v6 offset:24832
    ds_read_b64_tr_b16 v[230:231], v6 offset:25344
    s_waitcnt lgkmcnt(6)
    v_mfma_f32_32x32x16_bf16 v[160:175], v[240:243], v[76:79], v[160:175]
    ds_read_b64_tr_b16 v[232:233], v6 offset:26624
    ds_read_b64_tr_b16 v[234:235], v6 offset:27136
    s_waitcnt lgkmcnt(6)
    v_mfma_f32_32x32x16_bf16 v[176:191], v[244:247], v[76:79], v[176:191]
    ds_read_b64_tr_b16 v[236:237], v6 offset:26880
    ds_read_b64_tr_b16 v[238:239], v6 offset:27392
    s_getreg_b32 s46, hwreg(HW_REG_IB_STS)
    s_and_b32 s46, s46, 0x00c0000f
    s_or_b32 s46, s46, s54
    s_cbranch_scc1 L_NBQ_29
    s_waitcnt vmcnt(0)
    v_lshlrev_b32 v13, 3, v1
    s_mov_b64 exec, 255
    buffer_store_dwordx2 v[30:31], v13, s[28:31], s51 offen sc1
    s_mov_b64 exec, -1
    s_mov_b32 s54, 1
    L_NBQ_29:
    s_waitcnt lgkmcnt(6)
    v_mfma_f32_32x32x16_bf16 v[160:175], v[224:227], v[80:83], v[160:175]
    ds_read_b64_tr_b16 v[240:241], v6 offset:28672
    ds_read_b64_tr_b16 v[242:243], v6 offset:29184
    s_waitcnt lgkmcnt(6)
    v_mfma_f32_32x32x16_bf16 v[176:191], v[228:231], v[80:83], v[176:191]
    ds_read_b64_tr_b16 v[244:245], v6 offset:28928
    ds_read_b64_tr_b16 v[246:247], v6 offset:29440
    s_waitcnt lgkmcnt(6)
    v_mfma_f32_32x32x16_bf16 v[160:175], v[232:235], v[84:87], v[160:175]
    ds_read_b64_tr_b16 v[224:225], v6 offset:30720
    ds_read_b64_tr_b16 v[226:227], v6 offset:31232
    s_waitcnt lgkmcnt(6)
    v_mfma_f32_32x32x16_bf16 v[176:191], v[236:239], v[84:87], v[176:191]
    ds_read_b64_tr_b16 v[228:229], v6 offset:30976
    ds_read_b64_tr_b16 v[230:231], v6 offset:31488
    s_getreg_b32 s46, hwreg(HW_REG_IB_STS)
    s_and_b32 s46, s46, 0x00c0000f
    s_or_b32 s46, s46, s54
    s_cbranch_scc1 L_NBQ_30
    s_waitcnt vmcnt(0)
    v_lshlrev_b32 v13, 3, v1
    s_mov_b64 exec, 255
    buffer_store_dwordx2 v[30:31], v13, s[28:31], s51 offen sc1
    s_mov_b64 exec, -1
    s_mov_b32 s54, 1
    L_NBQ_30:
    s_waitcnt lgkmcnt(6)
    v_mfma_f32_32x32x16_bf16 v[160:175], v[240:243], v[88:91], v[160:175]
    ds_read_b64_tr_b16 v[232:233], v6 offset:32768
    ds_read_b64_tr_b16 v[234:235], v6 offset:33280
    s_waitcnt lgkmcnt(6)
    v_mfma_f32_32x32x16_bf16 v[176:191], v[244:247], v[88:91], v[176:191]
    ds_read_b64_tr_b16 v[236:237], v6 offset:33024
    ds_read_b64_tr_b16 v[238:239], v6 offset:33536
    s_waitcnt lgkmcnt(6)
    v_mfma_f32_32x32x16_bf16 v[160:175], v[224:227], v[92:95], v[160:175]
    ds_read_b64_tr_b16 v[240:241], v6 offset:34816
    ds_read_b64_tr_b16 v[242:243], v6 offset:35328
    s_waitcnt lgkmcnt(6)
    v_mfma_f32_32x32x16_bf16 v[176:191], v[228:231], v[92:95], v[176:191]
    ds_read_b64_tr_b16 v[244:245], v6 offset:35072
    ds_read_b64_tr_b16 v[246:247], v6 offset:35584
    s_getreg_b32 s46, hwreg(HW_REG_IB_STS)
    s_and_b32 s46, s46, 0x00c0000f
    s_or_b32 s46, s46, s54
    s_cbranch_scc1 L_NBQ_31
    s_waitcnt vmcnt(0)
    v_lshlrev_b32 v13, 3, v1
    s_mov_b64 exec, 255
    buffer_store_dwordx2 v[30:31], v13, s[28:31], s51 offen sc1
    s_mov_b64 exec, -1
    s_mov_b32 s54, 1
    L_NBQ_31:
    s_waitcnt lgkmcnt(6)
    v_mfma_f32_32x32x16_bf16 v[160:175], v[232:235], v[96:99], v[160:175]
    ds_read_b64_tr_b16 v[224:225], v6 offset:36864
    ds_read_b64_tr_b16 v[226:227], v6 offset:37376
    s_waitcnt lgkmcnt(6)
    v_mfma_f32_32x32x16_bf16 v[176:191], v[236:239], v[96:99], v[176:191]
    ds_read_b64_tr_b16 v[228:229], v6 offset:37120
    ds_read_b64_tr_b16 v[230:231], v6 offset:37632
    s_waitcnt lgkmcnt(6)
    v_mfma_f32_32x32x16_bf16 v[160:175], v[240:243], v[100:103], v[160:175]
    ds_read_b64_tr_b16 v[232:233], v6 offset:38912
    ds_read_b64_tr_b16 v[234:235], v6 offset:39424
    s_waitcnt lgkmcnt(6)
    v_mfma_f32_32x32x16_bf16 v[176:191], v[244:247], v[100:103], v[176:191]
    ds_read_b64_tr_b16 v[236:237], v6 offset:39168
    ds_read_b64_tr_b16 v[238:239], v6 offset:39680
    s_getreg_b32 s46, hwreg(HW_REG_IB_STS)
    s_and_b32 s46, s46, 0x00c0000f
    s_or_b32 s46, s46, s54
    s_cbranch_scc1 L_NBQ_32
    s_waitcnt vmcnt(0)
    v_lshlrev_b32 v13, 3, v1
    s_mov_b64 exec, 255
    buffer_store_dwordx2 v[30:31], v13, s[28:31], s51 offen sc1
    s_mov_b64 exec, -1
    s_mov_b32 s54, 1
    L_NBQ_32:
    s_waitcnt lgkmcnt(6)
    v_mfma_f32_32x32x16_bf16 v[160:175], v[224:227], v[104:107], v[160:175]
    ds_read_b64_tr_b16 v[240:241], v6 offset:40960
    ds_read_b64_tr_b16 v[242:243], v6 offset:41472
    s_waitcnt lgkmcnt(6)
    v_mfma_f32_32x32x16_bf16 v[176:191], v[228:231], v[104:107], v[176:191]
    ds_read_b64_tr_b16 v[244:245], v6 offset:41216
    ds_read_b64_tr_b16 v[246:247], v6 offset:41728
    s_waitcnt lgkmcnt(6)
    v_mfma_f32_32x32x16_bf16 v[160:175], v[232:235], v[108:111], v[160:175]
    ds_read_b64_tr_b16 v[224:225], v6 offset:43008
    ds_read_b64_tr_b16 v[226:227], v6 offset:43520
    s_waitcnt lgkmcnt(6)
    v_mfma_f32_32x32x16_bf16 v[176:191], v[236:239], v[108:111], v[176:191]
    ds_read_b64_tr_b16 v[228:229], v6 offset:43264
    ds_read_b64_tr_b16 v[230:231], v6 offset:43776
    s_getreg_b32 s46, hwreg(HW_REG_IB_STS)
    s_and_b32 s46, s46, 0x00c0000f
    s_or_b32 s46, s46, s54
    s_cbranch_scc1 L_NBQ_33
    s_waitcnt vmcnt(0)
    v_lshlrev_b32 v13, 3, v1
    s_mov_b64 exec, 255
    buffer_store_dwordx2 v[30:31], v13, s[28:31], s51 offen sc1
    s_mov_b64 exec, -1
    s_mov_b32 s54, 1
    L_NBQ_33:
    s_waitcnt lgkmcnt(6)
    v_mfma_f32_32x32x16_bf16 v[160:175], v[240:243], v[112:115], v[160:175]
    ds_read_b64_tr_b16 v[232:233], v6 offset:45056
    ds_read_b64_tr_b16 v[234:235], v6 offset:45568
    s_waitcnt lgkmcnt(6)
    v_mfma_f32_32x32x16_bf16 v[176:191], v[244:247], v[112:115], v[176:191]
    ds_read_b64_tr_b16 v[236:237], v6 offset:45312
    ds_read_b64_tr_b16 v[238:239], v6 offset:45824
    s_waitcnt lgkmcnt(6)
    v_mfma_f32_32x32x16_bf16 v[160:175], v[224:227], v[116:119], v[160:175]
    ds_read_b64_tr_b16 v[240:241], v6 offset:47104
    ds_read_b64_tr_b16 v[242:243], v6 offset:47616
    s_waitcnt lgkmcnt(6)
    v_mfma_f32_32x32x16_bf16 v[176:191], v[228:231], v[116:119], v[176:191]
    ds_read_b64_tr_b16 v[244:245], v6 offset:47360
    ds_read_b64_tr_b16 v[246:247], v6 offset:47872
    s_getreg_b32 s46, hwreg(HW_REG_IB_STS)
    s_and_b32 s46, s46, 0x00c0000f
    s_or_b32 s46, s46, s54
    s_cbranch_scc1 L_NBQ_34
    s_waitcnt vmcnt(0)
    v_lshlrev_b32 v13, 3, v1
    s_mov_b64 exec, 255
    buffer_store_dwordx2 v[30:31], v13, s[28:31], s51 offen sc1
    s_mov_b64 exec, -1
    s_mov_b32 s54, 1
    L_NBQ_34:
    s_waitcnt lgkmcnt(6)
    v_mfma_f32_32x32x16_bf16 v[160:175], v[232:235], v[120:123], v[160:175]
    ds_read_b64_tr_b16 v[224:225], v6 offset:49152
    ds_read_b64_tr_b16 v[226:227], v6 offset:49664
    s_waitcnt lgkmcnt(6)
    v_mfma_f32_32x32x16_bf16 v[176:191], v[236:239], v[120:123], v[176:191]
    ds_read_b64_tr_b16 v[228:229], v6 offset:49408
    ds_read_b64_tr_b16 v[230:231], v6 offset:49920
    s_waitcnt lgkmcnt(6)
    v_mfma_f32_32x32x16_bf16 v[160:175], v[240:243], v[124:127], v[160:175]
    ds_read_b64_tr_b16 v[232:233], v6 offset:51200
    ds_read_b64_tr_b16 v[234:235], v6 offset:51712
    s_waitcnt lgkmcnt(6)
    v_mfma_f32_32x32x16_bf16 v[176:191], v[244:247], v[124:127], v[176:191]
    ds_read_b64_tr_b16 v[236:237], v6 offset:51456
    ds_read_b64_tr_b16 v[238:239], v6 offset:51968
    s_getreg_b32 s46, hwreg(HW_REG_IB_STS)
    s_and_b32 s46, s46, 0x00c0000f
    s_or_b32 s46, s46, s54
    s_cbranch_scc1 L_NBQ_35
    s_waitcnt vmcnt(0)
    v_lshlrev_b32 v13, 3, v1
    s_mov_b64 exec, 255
    buffer_store_dwordx2 v[30:31], v13, s[28:31], s51 offen sc1
    s_mov_b64 exec, -1
    s_mov_b32 s54, 1
    L_NBQ_35:
    s_waitcnt lgkmcnt(6)
    v_mfma_f32_32x32x16_bf16 v[160:175], v[224:227], v[128:131], v[160:175]
    ds_read_b64_tr_b16 v[240:241], v6 offset:53248
    ds_read_b64_tr_b16 v[242:243], v6 offset:53760
    s_waitcnt lgkmcnt(6)
    v_mfma_f32_32x32x16_bf16 v[176:191], v[228:231], v[128:131], v[176:191]
    ds_read_b64_tr_b16 v[244:245], v6 offset:53504
    ds_read_b64_tr_b16 v[246:247], v6 offset:54016
    s_waitcnt lgkmcnt(6)
    v_mfma_f32_32x32x16_bf16 v[160:175], v[232:235], v[132:135], v[160:175]
    ds_read_b64_tr_b16 v[224:225], v6 offset:55296
    ds_read_b64_tr_b16 v[226:227], v6 offset:55808
    s_waitcnt lgkmcnt(6)
    v_mfma_f32_32x32x16_bf16 v[176:191], v[236:239], v[132:135], v[176:191]
    ds_read_b64_tr_b16 v[228:229], v6 offset:55552
    ds_read_b64_tr_b16 v[230:231], v6 offset:56064
    s_getreg_b32 s46, hwreg(HW_REG_IB_STS)
    s_and_b32 s46, s46, 0x00c0000f
    s_or_b32 s46, s46, s54
    s_cbranch_scc1 L_NBQ_36
    s_waitcnt vmcnt(0)
    v_lshlrev_b32 v13, 3, v1
    s_mov_b64 exec, 255
    buffer_store_dwordx2 v[30:31], v13, s[28:31], s51 offen sc1
    s_mov_b64 exec, -1
    s_mov_b32 s54, 1
    L_NBQ_36:
    s_waitcnt lgkmcnt(6)
    v_mfma_f32_32x32x16_bf16 v[160:175], v[240:243], v[136:139], v[160:175]
    ds_read_b64_tr_b16 v[232:233], v6 offset:57344
    ds_read_b64_tr_b16 v[234:235], v6 offset:57856
    s_waitcnt lgkmcnt(6)
    v_mfma_f32_32x32x16_bf16 v[176:191], v[244:247], v[136:139], v[176:191]
    ds_read_b64_tr_b16 v[236:237], v6 offset:57600
    ds_read_b64_tr_b16 v[238:239], v6 offset:58112
    s_waitcnt lgkmcnt(6)
    v_mfma_f32_32x32x16_bf16 v[160:175], v[224:227], v[140:143], v[160:175]
    ds_read_b64_tr_b16 v[240:241], v6 offset:59392
    ds_read_b64_tr_b16 v[242:243], v6 offset:59904
    s_waitcnt lgkmcnt(6)
    v_mfma_f32_32x32x16_bf16 v[176:191], v[228:231], v[140:143], v[176:191]
    ds_read_b64_tr_b16 v[244:245], v6 offset:59648
    ds_read_b64_tr_b16 v[246:247], v6 offset:60160
    s_getreg_b32 s46, hwreg(HW_REG_IB_STS)
    s_and_b32 s46, s46, 0x00c0000f
    s_or_b32 s46, s46, s54
    s_cbranch_scc1 L_NBQ_37
    s_waitcnt vmcnt(0)
    v_lshlrev_b32 v13, 3, v1
    s_mov_b64 exec, 255
    buffer_store_dwordx2 v[30:31], v13, s[28:31], s51 offen sc1
    s_mov_b64 exec, -1
    s_mov_b32 s54, 1
    L_NBQ_37:
    s_waitcnt lgkmcnt(6)
    v_mfma_f32_32x32x16_bf16 v[160:175], v[232:235], v[144:147], v[160:175]
    ds_read_b64_tr_b16 v[224:225], v6 offset:61440
    ds_read_b64_tr_b16 v[226:227], v6 offset:61952
    s_waitcnt lgkmcnt(6)
    v_mfma_f32_32x32x16_bf16 v[176:191], v[236:239], v[144:147], v[176:191]
    ds_read_b64_tr_b16 v[228:229], v6 offset:61696
    ds_read_b64_tr_b16 v[230:231], v6 offset:62208
    s_waitcnt lgkmcnt(6)
    v_mfma_f32_32x32x16_bf16 v[160:175], v[240:243], v[148:151], v[160:175]
    ds_read_b64_tr_b16 v[232:233], v6 offset:63488
    ds_read_b64_tr_b16 v[234:235], v6 offset:64000
    s_waitcnt lgkmcnt(6)
    v_mfma_f32_32x32x16_bf16 v[176:191], v[244:247], v[148:151], v[176:191]
    ds_read_b64_tr_b16 v[236:237], v6 offset:63744
    ds_read_b64_tr_b16 v[238:239], v6 offset:64256
    s_getreg_b32 s46, hwreg(HW_REG_IB_STS)
    s_and_b32 s46, s46, 0x00c0000f
    s_or_b32 s46, s46, s54
    s_cbranch_scc1 L_NBQ_38
    s_waitcnt vmcnt(0)
    v_lshlrev_b32 v13, 3, v1
    s_mov_b64 exec, 255
    buffer_store_dwordx2 v[30:31], v13, s[28:31], s51 offen sc1
    s_mov_b64 exec, -1
    s_mov_b32 s54, 1
    L_NBQ_38:
    s_waitcnt lgkmcnt(6)
    v_mfma_f32_32x32x16_bf16 v[160:175], v[224:227], v[152:155], v[160:175]
    s_waitcnt lgkmcnt(4)
    v_mfma_f32_32x32x16_bf16 v[176:191], v[228:231], v[152:155], v[176:191]
    s_waitcnt lgkmcnt(2)
    v_mfma_f32_32x32x16_bf16 v[160:175], v[232:235], v[156:159], v[160:175]
    s_waitcnt lgkmcnt(0)
    v_mfma_f32_32x32x16_bf16 v[176:191], v[236:239], v[156:159], v[176:191]
    s_cmp_eq_u32 s54, 1
    s_cbranch_scc1 L_NBQ_39
    s_waitcnt vmcnt(0)
    v_cmp_eq_u64 vcc, 0, v[30:31]
    s_cbranch_vccz L_HN_Y
    s_mov_b32 s96, 0
L_PN_Y:
    buffer_load_dwordx2 v[30:31], v7, s[72:75], 0 offen sc1
    s_add_u32 s96, s96, 1
    s_waitcnt vmcnt(0)
    v_cmp_eq_u64 vcc, 0, v[30:31]
    s_cmp_ge_u32 s96, 200000
    s_cbranch_scc1 L_PN_Y_X
    s_cbranch_vccz L_PN_Y_X
    s_sleep 1
    s_branch L_PN_Y
L_PN_Y_X:
L_HN_Y:
    v_lshlrev_b32 v13, 3, v1
    s_mov_b64 exec, 255
    buffer_store_dwordx2 v[30:31], v13, s[28:31], s51 offen sc1
    s_mov_b64 exec, -1
L_NBQ_39:
L_P1YX:
    s_setprio 3
    s_lshl_b32 s46, s26, 3
    s_add_u32 s46, s46, 64
    v_mov_b32 v28, s46
    ds_write_b64 v28, v[30:31]
    v_lshlrev_b32 v2, 3, v1
    s_mov_b32 s96, 0
    s_mov_b64 exec, 0xf00
L_WGY:
    ds_read_b64 v[28:29], v2
    s_add_u32 s96, s96, 1
    s_waitcnt lgkmcnt(0)
    v_cmp_ne_u64 vcc, v[28:29], v[30:31]
    s_cmp_ge_u32 s96, 800000
    s_cbranch_scc1 L_WGY_X
    s_cbranch_vccz L_WGY_X
    s_sleep 1
    s_branch L_WGY
L_WGY_X:
    s_mov_b64 exec, -1
    s_nop 7
    buffer_store_dwordx4 v[192:195], v12, s[28:31], s60 offen offset:0 sc1
    buffer_store_dwordx4 v[196:199], v12, s[28:31], s60 offen offset:1024 sc1
    buffer_store_dwordx4 v[208:211], v12, s[28:31], s60 offen offset:2048 sc1
    buffer_store_dwordx4 v[212:215], v12, s[28:31], s60 offen offset:3072 sc1
    s_cmp_ge_u32 s45, 22
    s_cbranch_scc1 L_C_SIGNAL
    s_nop 3
    v_pk_mul_f32 v[16:17], v[160:161], v[10:11]
    v_pk_mul_f32 v[18:19], v[162:163], v[10:11]
    v_min_f32 v16, 0x41f00000, v16
    v_min_f32 v17, 0x41f00000, v17
    v_min_f32 v18, 0x41f00000, v18
    v_min_f32 v19, 0x41f00000, v19
    v_exp_f32 v20, v16
    v_exp_f32 v21, v17
    v_exp_f32 v22, v18
    v_exp_f32 v23, v19
    v_pk_add_f32 v[24:25], v[20:21], v[14:15]
    v_pk_add_f32 v[26:27], v[22:23], v[14:15]
    v_pk_mul_f32 v[20:21], v[20:21], v[24:25]
    v_pk_mul_f32 v[22:23], v[22:23], v[26:27]
    v_pk_add_f32 v[24:25], v[20:21], v[14:15]
    v_pk_add_f32 v[26:27], v[22:23], v[14:15]
    v_rcp_f32 v16, v24
    v_rcp_f32 v17, v25
    v_rcp_f32 v18, v26
    v_rcp_f32 v19, v27
    v_pk_mul_f32 v[20:21], v[20:21], v[16:17]
    v_pk_mul_f32 v[22:23], v[22:23], v[18:19]
    v_pk_mul_f32 v[20:21], v[20:21], v[160:161]
    v_pk_mul_f32 v[22:23], v[22:23], v[162:163]
    v_cvt_pk_bf16_f32 v32, v20, v21
    v_cvt_pk_bf16_f32 v33, v22, v23
    v_pk_mul_f32 v[16:17], v[164:165], v[10:11]
    v_pk_mul_f32 v[18:19], v[166:167], v[10:11]
    v_min_f32 v16, 0x41f00000, v16
    v_min_f32 v17, 0x41f00000, v17
    v_min_f32 v18, 0x41f00000, v18
    v_min_f32 v19, 0x41f00000, v19
    v_exp_f32 v20, v16
    v_exp_f32 v21, v17
    v_exp_f32 v22, v18
    v_exp_f32 v23, v19
    v_pk_add_f32 v[24:25], v[20:21], v[14:15]
    v_pk_add_f32 v[26:27], v[22:23], v[14:15]
    v_pk_mul_f32 v[20:21], v[20:21], v[24:25]
    v_pk_mul_f32 v[22:23], v[22:23], v[26:27]
    v_pk_add_f32 v[24:25], v[20:21], v[14:15]
    v_pk_add_f32 v[26:27], v[22:23], v[14:15]
    v_rcp_f32 v16, v24
    v_rcp_f32 v17, v25
    v_rcp_f32 v18, v26
    v_rcp_f32 v19, v27
    v_pk_mul_f32 v[20:21], v[20:21], v[16:17]
    v_pk_mul_f32 v[22:23], v[22:23], v[18:19]
    v_pk_mul_f32 v[20:21], v[20:21], v[164:165]
    v_pk_mul_f32 v[22:23], v[22:23], v[166:167]
    v_cvt_pk_bf16_f32 v34, v20, v21
    v_cvt_pk_bf16_f32 v35, v22, v23
    v_pk_mul_f32 v[16:17], v[168:169], v[10:11]
    v_pk_mul_f32 v[18:19], v[170:171], v[10:11]
    v_min_f32 v16, 0x41f00000, v16
    v_min_f32 v17, 0x41f00000, v17
    v_min_f32 v18, 0x41f00000, v18
    v_min_f32 v19, 0x41f00000, v19
    v_exp_f32 v20, v16
    v_exp_f32 v21, v17
    v_exp_f32 v22, v18
    v_exp_f32 v23, v19
    v_pk_add_f32 v[24:25], v[20:21], v[14:15]
    v_pk_add_f32 v[26:27], v[22:23], v[14:15]
    v_pk_mul_f32 v[20:21], v[20:21], v[24:25]
    v_pk_mul_f32 v[22:23], v[22:23], v[26:27]
    v_pk_add_f32 v[24:25], v[20:21], v[14:15]
    v_pk_add_f32 v[26:27], v[22:23], v[14:15]
    v_rcp_f32 v16, v24
    v_rcp_f32 v17, v25
    v_rcp_f32 v18, v26
    v_rcp_f32 v19, v27
    v_pk_mul_f32 v[20:21], v[20:21], v[16:17]
    v_pk_mul_f32 v[22:23], v[22:23], v[18:19]
    v_pk_mul_f32 v[20:21], v[20:21], v[168:169]
    v_pk_mul_f32 v[22:23], v[22:23], v[170:171]
    v_cvt_pk_bf16_f32 v36, v20, v21
    v_cvt_pk_bf16_f32 v37, v22, v23
    v_pk_mul_f32 v[16:17], v[172:173], v[10:11]
    v_pk_mul_f32 v[18:19], v[174:175], v[10:11]
    v_min_f32 v16, 0x41f00000, v16
    v_min_f32 v17, 0x41f00000, v17
    v_min_f32 v18, 0x41f00000, v18
    v_min_f32 v19, 0x41f00000, v19
    v_exp_f32 v20, v16
    v_exp_f32 v21, v17
    v_exp_f32 v22, v18
    v_exp_f32 v23, v19
    v_pk_add_f32 v[24:25], v[20:21], v[14:15]
    v_pk_add_f32 v[26:27], v[22:23], v[14:15]
    v_pk_mul_f32 v[20:21], v[20:21], v[24:25]
    v_pk_mul_f32 v[22:23], v[22:23], v[26:27]
    v_pk_add_f32 v[24:25], v[20:21], v[14:15]
    v_pk_add_f32 v[26:27], v[22:23], v[14:15]
    v_rcp_f32 v16, v24
    v_rcp_f32 v17, v25
    v_rcp_f32 v18, v26
    v_rcp_f32 v19, v27
    v_pk_mul_f32 v[20:21], v[20:21], v[16:17]
    v_pk_mul_f32 v[22:23], v[22:23], v[18:19]
    v_pk_mul_f32 v[20:21], v[20:21], v[172:173]
    v_pk_mul_f32 v[22:23], v[22:23], v[174:175]
    v_cvt_pk_bf16_f32 v38, v20, v21
    v_cvt_pk_bf16_f32 v39, v22, v23
    buffer_store_dwordx4 v[32:35], v12, s[28:31], s61 offen offset:0 sc1
    buffer_store_dwordx4 v[36:39], v12, s[28:31], s61 offen offset:1024 sc1
    s_cmp_eq_u32 s45, 21
    s_cbranch_scc1 L_C_GATE
    v_pk_mul_f32 v[16:17], v[176:177], v[10:11]
    v_pk_mul_f32 v[18:19], v[178:179], v[10:11]
    v_min_f32 v16, 0x41f00000, v16
    v_min_f32 v17, 0x41f00000, v17
    v_min_f32 v18, 0x41f00000, v18
    v_min_f32 v19, 0x41f00000, v19
    v_exp_f32 v20, v16
    v_exp_f32 v21, v17
    v_exp_f32 v22, v18
    v_exp_f32 v23, v19
    v_pk_add_f32 v[24:25], v[20:21], v[14:15]
    v_pk_add_f32 v[26:27], v[22:23], v[14:15]
    v_pk_mul_f32 v[20:21], v[20:21], v[24:25]
    v_pk_mul_f32 v[22:23], v[22:23], v[26:27]
    v_pk_add_f32 v[24:25], v[20:21], v[14:15]
    v_pk_add_f32 v[26:27], v[22:23], v[14:15]
    v_rcp_f32 v16, v24
    v_rcp_f32 v17, v25
    v_rcp_f32 v18, v26
    v_rcp_f32 v19, v27
    v_pk_mul_f32 v[20:21], v[20:21], v[16:17]
    v_pk_mul_f32 v[22:23], v[22:23], v[18:19]
    v_pk_mul_f32 v[20:21], v[20:21], v[176:177]
    v_pk_mul_f32 v[22:23], v[22:23], v[178:179]
    v_cvt_pk_bf16_f32 v40, v20, v21
    v_cvt_pk_bf16_f32 v41, v22, v23
    v_pk_mul_f32 v[16:17], v[180:181], v[10:11]
    v_pk_mul_f32 v[18:19], v[182:183], v[10:11]
    v_min_f32 v16, 0x41f00000, v16
    v_min_f32 v17, 0x41f00000, v17
    v_min_f32 v18, 0x41f00000, v18
    v_min_f32 v19, 0x41f00000, v19
    v_exp_f32 v20, v16
    v_exp_f32 v21, v17
    v_exp_f32 v22, v18
    v_exp_f32 v23, v19
    v_pk_add_f32 v[24:25], v[20:21], v[14:15]
    v_pk_add_f32 v[26:27], v[22:23], v[14:15]
    v_pk_mul_f32 v[20:21], v[20:21], v[24:25]
    v_pk_mul_f32 v[22:23], v[22:23], v[26:27]
    v_pk_add_f32 v[24:25], v[20:21], v[14:15]
    v_pk_add_f32 v[26:27], v[22:23], v[14:15]
    v_rcp_f32 v16, v24
    v_rcp_f32 v17, v25
    v_rcp_f32 v18, v26
    v_rcp_f32 v19, v27
    v_pk_mul_f32 v[20:21], v[20:21], v[16:17]
    v_pk_mul_f32 v[22:23], v[22:23], v[18:19]
    v_pk_mul_f32 v[20:21], v[20:21], v[180:181]
    v_pk_mul_f32 v[22:23], v[22:23], v[182:183]
    v_cvt_pk_bf16_f32 v42, v20, v21
    v_cvt_pk_bf16_f32 v43, v22, v23
    v_pk_mul_f32 v[16:17], v[184:185], v[10:11]
    v_pk_mul_f32 v[18:19], v[186:187], v[10:11]
    v_min_f32 v16, 0x41f00000, v16
    v_min_f32 v17, 0x41f00000, v17
    v_min_f32 v18, 0x41f00000, v18
    v_min_f32 v19, 0x41f00000, v19
    v_exp_f32 v20, v16
    v_exp_f32 v21, v17
    v_exp_f32 v22, v18
    v_exp_f32 v23, v19
    v_pk_add_f32 v[24:25], v[20:21], v[14:15]
    v_pk_add_f32 v[26:27], v[22:23], v[14:15]
    v_pk_mul_f32 v[20:21], v[20:21], v[24:25]
    v_pk_mul_f32 v[22:23], v[22:23], v[26:27]
    v_pk_add_f32 v[24:25], v[20:21], v[14:15]
    v_pk_add_f32 v[26:27], v[22:23], v[14:15]
    v_rcp_f32 v16, v24
    v_rcp_f32 v17, v25
    v_rcp_f32 v18, v26
    v_rcp_f32 v19, v27
    v_pk_mul_f32 v[20:21], v[20:21], v[16:17]
    v_pk_mul_f32 v[22:23], v[22:23], v[18:19]
    v_pk_mul_f32 v[20:21], v[20:21], v[184:185]
    v_pk_mul_f32 v[22:23], v[22:23], v[186:187]
    v_cvt_pk_bf16_f32 v44, v20, v21
    v_cvt_pk_bf16_f32 v45, v22, v23
    v_pk_mul_f32 v[16:17], v[188:189], v[10:11]
    v_pk_mul_f32 v[18:19], v[190:191], v[10:11]
    v_min_f32 v16, 0x41f00000, v16
    v_min_f32 v17, 0x41f00000, v17
    v_min_f32 v18, 0x41f00000, v18
    v_min_f32 v19, 0x41f00000, v19
    v_exp_f32 v20, v16
    v_exp_f32 v21, v17
    v_exp_f32 v22, v18
    v_exp_f32 v23, v19
    v_pk_add_f32 v[24:25], v[20:21], v[14:15]
    v_pk_add_f32 v[26:27], v[22:23], v[14:15]
    v_pk_mul_f32 v[20:21], v[20:21], v[24:25]
    v_pk_mul_f32 v[22:23], v[22:23], v[26:27]
    v_pk_add_f32 v[24:25], v[20:21], v[14:15]
    v_pk_add_f32 v[26:27], v[22:23], v[14:15]
    v_rcp_f32 v16, v24
    v_rcp_f32 v17, v25
    v_rcp_f32 v18, v26
    v_rcp_f32 v19, v27
    v_pk_mul_f32 v[20:21], v[20:21], v[16:17]
    v_pk_mul_f32 v[22:23], v[22:23], v[18:19]
    v_pk_mul_f32 v[20:21], v[20:21], v[188:189]
    v_pk_mul_f32 v[22:23], v[22:23], v[190:191]
    v_cvt_pk_bf16_f32 v46, v20, v21
    v_cvt_pk_bf16_f32 v47, v22, v23
    buffer_store_dwordx4 v[40:43], v12, s[28:31], s61 offen offset:2048 sc1
    buffer_store_dwordx4 v[44:47], v12, s[28:31], s61 offen offset:3072 sc1
    s_branch L_C_SIGNAL
L_C_GATE:
    v_mul_f32 v16, 0xbfb8aa3b, v176
    v_min_f32 v16, 0x4266d4ca, v16
    v_exp_f32 v16, v16
    v_lshlrev_b32 v18, 2, v1
    s_lshl_b32 s46, s50, 7
    s_add_u32 s46, s46, 14680064
    s_mov_b32 exec_hi, 0
    buffer_store_dword v16, v18, s[28:31], s46 offen sc1
    s_mov_b64 exec, -1
L_C_SIGNAL:
    v_mov_b32 v252, v30
    v_mov_b32 v253, v31
    v_lshlrev_b32 v2, 4, v1
    v_add_u32 v3, 120832, v2
    v_and_b32 v10, 15, v1
    v_lshrrev_b32 v10, 2, v10
    v_lshrrev_b32 v11, 5, v1
    v_lshl_add_u32 v10, v11, 2, v10
    v_mul_u32_u24 v4, 1024, v10
    v_bfe_u32 v11, v1, 4, 1
    v_lshl_add_u32 v4, v11, 6, v4
    v_and_b32 v11, 3, v1
    v_lshl_add_u32 v4, v11, 4, v4
    s_lshl_b32 s48, s33, 7
    v_add_u32 v4, s48, v4
    v_add_u32 v5, 7168, v4
    v_lshlrev_b32 v6, 9, v9
    v_and_b32 v10, 15, v1
    v_lshrrev_b32 v10, 2, v10
    v_lshl_add_u32 v6, v10, 6, v6
    v_bfe_u32 v10, v1, 4, 1
    v_lshl_add_u32 v6, v10, 5, v6
    v_and_b32 v10, 3, v1
    v_lshl_add_u32 v6, v10, 3, v6
    s_lshl_b32 s49, s26, 11
    v_add_u32 v6, s49, v6
    v_add_u32 v248, 65536, v6
    v_add_u32 v249, 65536, v248
    s_mov_b32 s36, s16
    s_and_b32 s37, s17, 0xffff
    s_mov_b32 s38, 1409024
    s_mov_b32 s39, 0x00020000
    s_mov_b32 s40, s8
    s_and_b32 s41, s9, 0xffff
    s_mov_b32 s42, 524288
    s_mov_b32 s43, 0x00020000
    s_mov_b32 s44, s20
    s_and_b32 s45, s21, 0xffff
    s_mov_b32 s46, 2097152
    s_mov_b32 s47, 0x00020000
    s_mul_i32 s50, s32, 236
    s_lshl_b32 s50, s50, 10
    s_add_u32 s50, s50, 6291456
    s_lshl_b32 s51, s26, 14
    s_add_u32 s60, s51, 1441792
    s_add_u32 s61, s51, 524288
    s_mov_b32 s71, s62
    s_mov_b32 s72, s63
    s_and_b32 s63, s32, 3
    s_mul_i32 s63, s63, 5
    s_cmp_eq_u32 s33, 3
    s_cselect_b32 s63, s63, 0
    s_mul_i32 s62, s27, 0
    s_add_u32 s62, s62, s63
    s_sub_u32 s63, s62, 22
    s_cmp_ge_u32 s62, 22
    s_cselect_b32 s62, s63, s62
    s_lshl_b32 s65, s26, 10
    s_add_u32 s66, s65, 90112
    s_lshl_b32 s64, s62, 12
    s_add_u32 s64, s64, s65
    s_add_u32 s62, s62, 15
    s_sub_u32 s63, s62, 22
    s_cmp_ge_u32 s62, 22
    s_cselect_b32 s62, s63, s62
    s_lshl_b32 s67, s62, 16
    s_add_u32 s67, s67, s51
    s_and_b32 s63, s32, 3
    s_lshl_b32 s63, s63, 1
    s_cmp_eq_u32 s33, 3
    s_cselect_b32 s63, s63, 0
    s_nop 0
    s_and_b32 s63, s63, 7
    s_lshl_b32 s68, s63, 16
    s_add_u32 s68, s68, s51
    s_lshl_b32 s69, s63, 12
    s_add_u32 s69, s69, s65
    s_add_u32 s70, s65, 32768
    s_waitcnt vmcnt(0)
    v_lshlrev_b32 v13, 3, v1
    s_mov_b64 exec, 255
    buffer_store_dwordx2 v[252:253], v13, s[28:31], s52 offen sc1
    s_mov_b64 exec, -1
    s_setprio 0
L_UPR:
    s_cmp_ge_u32 s76, 8
    s_cbranch_scc1 L_UPRX
    s_mov_b32 m0, s71
    s_add_u32 s71, s71, 8192
    buffer_load_dwordx4 v4, s[36:39], s72 offen lds
    buffer_load_dwordx4 v5, s[36:39], s72 offen offset:1024 lds
    s_add_u32 s76, s76, 1
    s_add_u32 s72, s72, 65536
    s_cmp_ge_u32 s72, s59
    s_cselect_b32 s72, s58, s72
    s_branch L_UPR
L_UPRX:
    v_lshlrev_b32 v10, 3, v1
    s_mov_b32 s96, 0
    s_lshl_b64 exec, 1, s26
L_WT1:
    ds_read_b64 v[12:13], v10
    s_add_u32 s96, s96, 1
    s_waitcnt lgkmcnt(0)
    v_cmp_ne_u64 vcc, v[12:13], v[252:253]
    s_cmp_ge_u32 s96, 800000
    s_cbranch_scc1 L_WT1_X
    s_cbranch_vccz L_WT1_X
    s_sleep 1
    s_branch L_WT1
L_WT1_X:
    s_mov_b64 exec, -1
    ds_read_b64_tr_b16 v[80:81], v6 offset:40960
    ds_read_b64_tr_b16 v[82:83], v6 offset:41984
    ds_read_b64_tr_b16 v[84:85], v6 offset:41216
    ds_read_b64_tr_b16 v[86:87], v6 offset:42240
    ds_read_b64_tr_b16 v[88:89], v6 offset:49152
    ds_read_b64_tr_b16 v[90:91], v6 offset:50176
    ds_read_b64_tr_b16 v[92:93], v6 offset:49408
    ds_read_b64_tr_b16 v[94:95], v6 offset:50432
    s_waitcnt lgkmcnt(0)
    s_add_u32 m0, s49, 40960
    s_nop 0
    buffer_load_dwordx4 v4, s[36:39], s67 offen lds
    buffer_load_dwordx4 v5, s[36:39], s67 offen offset:1024 lds
    s_add_u32 s67, s67, 65536
    s_cmp_ge_u32 s67, s60
    s_cselect_b32 s67, s51, s67
    s_add_u32 m0, s49, 49152
    s_nop 0
    buffer_load_dwordx4 v4, s[36:39], s67 offen lds
    buffer_load_dwordx4 v5, s[36:39], s67 offen offset:1024 lds
    s_add_u32 s67, s67, 65536
    s_cmp_ge_u32 s67, s60
    s_cselect_b32 s67, s51, s67
    ds_read_b64_tr_b16 v[96:97], v6 offset:57344
    ds_read_b64_tr_b16 v[98:99], v6 offset:58368
    ds_read_b64_tr_b16 v[100:101], v6 offset:57600
    ds_read_b64_tr_b16 v[102:103], v6 offset:58624
    ds_read_b64_tr_b16 v[104:105], v248 offset:0
    ds_read_b64_tr_b16 v[106:107], v248 offset:1024
    ds_read_b64_tr_b16 v[108:109], v248 offset:256
    ds_read_b64_tr_b16 v[110:111], v248 offset:1280
    s_waitcnt lgkmcnt(0)
    s_add_u32 m0, s49, 57344
    s_nop 0
    buffer_load_dwordx4 v4, s[36:39], s67 offen lds
    buffer_load_dwordx4 v5, s[36:39], s67 offen offset:1024 lds
    s_add_u32 s67, s67, 65536
    s_cmp_ge_u32 s67, s60
    s_cselect_b32 s67, s51, s67
    s_add_u32 m0, s49, 65536
    s_nop 0
    buffer_load_dwordx4 v4, s[36:39], s67 offen lds
    buffer_load_dwordx4 v5, s[36:39], s67 offen offset:1024 lds
    s_add_u32 s67, s67, 65536
    s_cmp_ge_u32 s67, s60
    s_cselect_b32 s67, s51, s67
    ds_read_b64_tr_b16 v[112:113], v248 offset:8192
    ds_read_b64_tr_b16 v[114:115], v248 offset:9216
    ds_read_b64_tr_b16 v[116:117], v248 offset:8448
    ds_read_b64_tr_b16 v[118:119], v248 offset:9472
    ds_read_b64_tr_b16 v[120:121], v248 offset:16384
    ds_read_b64_tr_b16 v[122:123], v248 offset:17408
    ds_read_b64_tr_b16 v[124:125], v248 offset:16640
    ds_read_b64_tr_b16 v[126:127], v248 offset:17664
    s_waitcnt lgkmcnt(0)
    s_add_u32 m0, s49, 73728
    s_nop 0
    buffer_load_dwordx4 v4, s[36:39], s67 offen lds
    buffer_load_dwordx4 v5, s[36:39], s67 offen offset:1024 lds
    s_add_u32 s67, s67, 65536
    s_cmp_ge_u32 s67, s60
    s_cselect_b32 s67, s51, s67
    s_add_u32 m0, s49, 81920
    s_nop 0
    buffer_load_dwordx4 v4, s[36:39], s67 offen lds
    buffer_load_dwordx4 v5, s[36:39], s67 offen offset:1024 lds
    s_add_u32 s67, s67, 65536
    s_cmp_ge_u32 s67, s60
    s_cselect_b32 s67, s51, s67
    ds_read_b64_tr_b16 v[128:129], v248 offset:24576
    ds_read_b64_tr_b16 v[130:131], v248 offset:25600
    ds_read_b64_tr_b16 v[132:133], v248 offset:24832
    ds_read_b64_tr_b16 v[134:135], v248 offset:25856
    s_waitcnt lgkmcnt(0)
    v_lshrrev_b32 v11, 3, v1
    s_lshl_b32 s52, s26, 4
    v_add_u32 v11, s52, v11
    v_lshlrev_b32 v239, 2, v11
    v_and_b32 v12, 7, v8
    v_lshrrev_b32 v13, 3, v8
    v_lshlrev_b32 v240, 13, v13
    v_lshl_add_u32 v240, v12, 8, v240
    s_add_u32 s52, s49, 40960
    v_add_u32 v240, s52, v240
    v_xor_b32 v12, v12, v9
    v_xor_b32 v13, 0, v12
    v_lshl_add_u32 v241, v13, 4, v240
    v_xor_b32 v13, 2, v12
    v_lshl_add_u32 v242, v13, 4, v240
    v_xor_b32 v13, 4, v12
    v_lshl_add_u32 v243, v13, 4, v240
    v_xor_b32 v13, 6, v12
    v_lshl_add_u32 v244, v13, 4, v240
    v_lshrrev_b32 v12, 3, v1
    v_and_b32 v13, 3, v1
    v_lshlrev_b32 v13, 1, v13
    v_xor_b32 v13, v13, v12
    v_lshlrev_b32 v245, 4, v13
    v_lshl_add_u32 v245, v12, 8, v245
    v_bfe_u32 v13, v1, 2, 1
    v_lshl_add_u32 v245, v13, 7, v245
    s_lshl_b32 s52, s26, 14
    s_add_u32 s52, s52, 40960
    v_add_u32 v245, s52, v245
    v_xor_b32 v240, 16, v245
    v_and_b32 v13, 7, v1
    v_lshlrev_b32 v11, 10, v11
    v_lshl_add_u32 v11, v13, 4, v11
    s_lshl_b32 s56, s32, 16
    s_add_u32 s56, s56, s48
    s_add_u32 s57, s56, 8192
    v_lshlrev_b32 v10, 6, v1
    s_lshl_b32 s54, s32, 11
    s_add_u32 s55, s54, 14942208
    s_mov_b32 s96, 0
    s_mov_b32 exec_lo, -1
    s_mov_b32 exec_hi, 0
L_PA:
    buffer_load_dwordx2 v[12:13], v10, s[28:31], s55 offen sc1
    s_add_u32 s96, s96, 1
    s_waitcnt vmcnt(0)
    v_cmp_ne_u64 vcc, v[12:13], v[252:253]
    s_cmp_ge_u32 s96, 200000
    s_cbranch_scc1 L_PA_X
    s_cbranch_vccz L_PA_X
    s_sleep 2
    s_branch L_PA
L_PA_X:
    s_mov_b64 exec, -1
    s_lshl_b32 s54, s32, 2
    s_add_u32 s54, s54, s26
    s_lshl_b32 s54, s54, 9
    s_add_u32 s55, s54, 15073280
    s_min_u32 s52, s64, 87040
    s_add_u32 s52, s52, s50
    buffer_load_dwordx4 v[144:147], v2, s[28:31], s52 offen sc1
    buffer_load_dwordx4 v[148:151], v3, s[28:31], s52 offen sc1
    s_add_u32 s64, s64, 4096
    s_cmp_ge_u32 s64, s66
    s_cselect_b32 s64, s65, s64
    s_min_u32 s52, s64, 87040
    s_add_u32 s52, s52, s50
    buffer_load_dwordx4 v[152:155], v2, s[28:31], s52 offen sc1
    buffer_load_dwordx4 v[156:159], v3, s[28:31], s52 offen sc1
    s_add_u32 s64, s64, 4096
    s_cmp_ge_u32 s64, s66
    s_cselect_b32 s64, s65, s64
    s_min_u32 s52, s64, 87040
    s_add_u32 s52, s52, s50
    buffer_load_dwordx4 v[160:163], v2, s[28:31], s52 offen sc1
    buffer_load_dwordx4 v[164:167], v3, s[28:31], s52 offen sc1
    s_add_u32 s64, s64, 4096
    s_cmp_ge_u32 s64, s66
    s_cselect_b32 s64, s65, s64
    s_min_u32 s52, s64, 87040
    s_add_u32 s52, s52, s50
    buffer_load_dwordx4 v[168:171], v2, s[28:31], s52 offen sc1
    buffer_load_dwordx4 v[172:175], v3, s[28:31], s52 offen sc1
    s_add_u32 s64, s64, 4096
    s_cmp_ge_u32 s64, s66
    s_cselect_b32 s64, s65, s64
    s_min_u32 s52, s64, 87040
    s_add_u32 s52, s52, s50
    buffer_load_dwordx4 v[176:179], v2, s[28:31], s52 offen sc1
    buffer_load_dwordx4 v[180:183], v3, s[28:31], s52 offen sc1
    s_add_u32 s64, s64, 4096
    s_cmp_ge_u32 s64, s66
    s_cselect_b32 s64, s65, s64
    s_min_u32 s52, s64, 87040
    s_add_u32 s52, s52, s50
    buffer_load_dwordx4 v[184:187], v2, s[28:31], s52 offen sc1
    buffer_load_dwordx4 v[188:191], v3, s[28:31], s52 offen sc1
    s_add_u32 s64, s64, 4096
    s_cmp_ge_u32 s64, s66
    s_cselect_b32 s64, s65, s64
    s_min_u32 s52, s64, 87040
    s_add_u32 s52, s52, s50
    buffer_load_dwordx4 v[192:195], v2, s[28:31], s52 offen sc1
    buffer_load_dwordx4 v[196:199], v3, s[28:31], s52 offen sc1
    s_add_u32 s64, s64, 4096
    s_cmp_ge_u32 s64, s66
    s_cselect_b32 s64, s65, s64
    s_min_u32 s52, s64, 87040
    s_add_u32 s52, s52, s50
    buffer_load_dwordx4 v[200:203], v2, s[28:31], s52 offen sc1
    buffer_load_dwordx4 v[204:207], v3, s[28:31], s52 offen sc1
    s_add_u32 s64, s64, 4096
    s_cmp_ge_u32 s64, s66
    s_cselect_b32 s64, s65, s64
    v_lshlrev_b32 v238, 2, v8
    s_lshl_b32 s53, s32, 8
    s_add_u32 s53, s53, 14680064
    buffer_load_dword v14, v238, s[28:31], s53 offen sc1
    buffer_load_dword v15, v238, s[28:31], s53 offen offset:128 sc1
    buffer_load_dword v246, v239, s[28:31], s53 offen sc1
    buffer_load_dword v247, v239, s[28:31], s53 offen offset:32 sc1
    s_waitcnt vmcnt(18)
    v_mfma_f32_32x32x16_bf16 v[16:31], v[80:83], v[144:147], 0
    v_mfma_f32_32x32x16_bf16 v[48:63], v[80:83], v[148:151], 0
    v_mfma_f32_32x32x16_bf16 v[32:47], v[84:87], v[144:147], 0
    v_mfma_f32_32x32x16_bf16 v[64:79], v[84:87], v[148:151], 0
    s_min_u32 s52, s64, 87040
    s_add_u32 s52, s52, s50
    buffer_load_dwordx4 v[144:147], v2, s[28:31], s52 offen sc1
    buffer_load_dwordx4 v[148:151], v3, s[28:31], s52 offen sc1
    s_add_u32 s64, s64, 4096
    s_cmp_ge_u32 s64, s66
    s_cselect_b32 s64, s65, s64
    s_add_u32 m0, s49, 90112
    s_nop 0
    buffer_load_dwordx4 v4, s[36:39], s67 offen lds
    buffer_load_dwordx4 v5, s[36:39], s67 offen offset:1024 lds
    s_add_u32 s67, s67, 65536
    s_cmp_ge_u32 s67, s60
    s_cselect_b32 s67, s51, s67
    s_waitcnt vmcnt(20)
    v_mfma_f32_32x32x16_bf16 v[16:31], v[88:91], v[152:155], v[16:31]
    v_mfma_f32_32x32x16_bf16 v[48:63], v[88:91], v[156:159], v[48:63]
    v_mfma_f32_32x32x16_bf16 v[32:47], v[92:95], v[152:155], v[32:47]
    v_mfma_f32_32x32x16_bf16 v[64:79], v[92:95], v[156:159], v[64:79]
    s_min_u32 s52, s64, 87040
    s_add_u32 s52, s52, s50
    buffer_load_dwordx4 v[152:155], v2, s[28:31], s52 offen sc1
    buffer_load_dwordx4 v[156:159], v3, s[28:31], s52 offen sc1
    s_add_u32 s64, s64, 4096
    s_cmp_ge_u32 s64, s66
    s_cselect_b32 s64, s65, s64
    s_waitcnt vmcnt(20)
    v_mfma_f32_32x32x16_bf16 v[16:31], v[96:99], v[160:163], v[16:31]
    v_mfma_f32_32x32x16_bf16 v[48:63], v[96:99], v[164:167], v[48:63]
    v_mfma_f32_32x32x16_bf16 v[32:47], v[100:103], v[160:163], v[32:47]
    v_mfma_f32_32x32x16_bf16 v[64:79], v[100:103], v[164:167], v[64:79]
    s_min_u32 s52, s64, 87040
    s_add_u32 s52, s52, s50
    buffer_load_dwordx4 v[160:163], v2, s[28:31], s52 offen sc1
    buffer_load_dwordx4 v[164:167], v3, s[28:31], s52 offen sc1
    s_add_u32 s64, s64, 4096
    s_cmp_ge_u32 s64, s66
    s_cselect_b32 s64, s65, s64
    s_waitcnt vmcnt(20)
    v_mfma_f32_32x32x16_bf16 v[16:31], v[104:107], v[168:171], v[16:31]
    v_mfma_f32_32x32x16_bf16 v[48:63], v[104:107], v[172:175], v[48:63]
    v_mfma_f32_32x32x16_bf16 v[32:47], v[108:111], v[168:171], v[32:47]
    v_mfma_f32_32x32x16_bf16 v[64:79], v[108:111], v[172:175], v[64:79]
    s_min_u32 s52, s64, 87040
    s_add_u32 s52, s52, s50
    buffer_load_dwordx4 v[168:171], v2, s[28:31], s52 offen sc1
    buffer_load_dwordx4 v[172:175], v3, s[28:31], s52 offen sc1
    s_add_u32 s64, s64, 4096
    s_cmp_ge_u32 s64, s66
    s_cselect_b32 s64, s65, s64
    s_waitcnt vmcnt(20)
    v_mfma_f32_32x32x16_bf16 v[16:31], v[112:115], v[176:179], v[16:31]
    v_mfma_f32_32x32x16_bf16 v[48:63], v[112:115], v[180:183], v[48:63]
    v_mfma_f32_32x32x16_bf16 v[32:47], v[116:119], v[176:179], v[32:47]
    v_mfma_f32_32x32x16_bf16 v[64:79], v[116:119], v[180:183], v[64:79]
    s_min_u32 s52, s64, 87040
    s_add_u32 s52, s52, s50
    buffer_load_dwordx4 v[176:179], v2, s[28:31], s52 offen sc1
    buffer_load_dwordx4 v[180:183], v3, s[28:31], s52 offen sc1
    s_add_u32 s64, s64, 4096
    s_cmp_ge_u32 s64, s66
    s_cselect_b32 s64, s65, s64
    s_waitcnt vmcnt(20)
    v_mfma_f32_32x32x16_bf16 v[16:31], v[120:123], v[184:187], v[16:31]
    v_mfma_f32_32x32x16_bf16 v[48:63], v[120:123], v[188:191], v[48:63]
    v_mfma_f32_32x32x16_bf16 v[32:47], v[124:127], v[184:187], v[32:47]
    v_mfma_f32_32x32x16_bf16 v[64:79], v[124:127], v[188:191], v[64:79]
    s_min_u32 s52, s64, 87040
    s_add_u32 s52, s52, s50
    buffer_load_dwordx4 v[184:187], v2, s[28:31], s52 offen sc1
    buffer_load_dwordx4 v[188:191], v3, s[28:31], s52 offen sc1
    s_add_u32 s64, s64, 4096
    s_cmp_ge_u32 s64, s66
    s_cselect_b32 s64, s65, s64
    ds_read_b64_tr_b16 v[216:217], v248 offset:32768
    ds_read_b64_tr_b16 v[218:219], v248 offset:33792
    ds_read_b64_tr_b16 v[220:221], v248 offset:33024
    ds_read_b64_tr_b16 v[222:223], v248 offset:34048
    s_waitcnt vmcnt(20)
    v_mfma_f32_32x32x16_bf16 v[16:31], v[128:131], v[192:195], v[16:31]
    v_mfma_f32_32x32x16_bf16 v[48:63], v[128:131], v[196:199], v[48:63]
    v_mfma_f32_32x32x16_bf16 v[32:47], v[132:135], v[192:195], v[32:47]
    v_mfma_f32_32x32x16_bf16 v[64:79], v[132:135], v[196:199], v[64:79]
    s_min_u32 s52, s64, 87040
    s_add_u32 s52, s52, s50
    buffer_load_dwordx4 v[192:195], v2, s[28:31], s52 offen sc1
    buffer_load_dwordx4 v[196:199], v3, s[28:31], s52 offen sc1
    s_add_u32 s64, s64, 4096
    s_cmp_ge_u32 s64, s66
    s_cselect_b32 s64, s65, s64
    ds_read_b64_tr_b16 v[208:209], v248 offset:40960
    ds_read_b64_tr_b16 v[210:211], v248 offset:41984
    ds_read_b64_tr_b16 v[212:213], v248 offset:41216
    ds_read_b64_tr_b16 v[214:215], v248 offset:42240
    s_waitcnt vmcnt(20)
    s_waitcnt lgkmcnt(4)
    v_mfma_f32_32x32x16_bf16 v[16:31], v[216:219], v[200:203], v[16:31]
    v_mfma_f32_32x32x16_bf16 v[48:63], v[216:219], v[204:207], v[48:63]
    v_mfma_f32_32x32x16_bf16 v[32:47], v[220:223], v[200:203], v[32:47]
    v_mfma_f32_32x32x16_bf16 v[64:79], v[220:223], v[204:207], v[64:79]
    s_min_u32 s52, s64, 87040
    s_add_u32 s52, s52, s50
    buffer_load_dwordx4 v[200:203], v2, s[28:31], s52 offen sc1
    buffer_load_dwordx4 v[204:207], v3, s[28:31], s52 offen sc1
    s_add_u32 s64, s64, 4096
    s_cmp_ge_u32 s64, s66
    s_cselect_b32 s64, s65, s64
    s_add_u32 m0, s49, 98304
    s_nop 0
    buffer_load_dwordx4 v4, s[40:43], s68 offen lds
    buffer_load_dwordx4 v5, s[40:43], s68 offen offset:1024 lds
    s_add_u32 s68, s68, 65536
    s_cmp_ge_u32 s68, s61
    s_cselect_b32 s68, s51, s68
    ds_read_b64_tr_b16 v[216:217], v248 offset:49152
    ds_read_b64_tr_b16 v[218:219], v248 offset:50176
    ds_read_b64_tr_b16 v[220:221], v248 offset:49408
    ds_read_b64_tr_b16 v[222:223], v248 offset:50432
    s_waitcnt vmcnt(18)
    s_waitcnt lgkmcnt(4)
    v_mfma_f32_32x32x16_bf16 v[16:31], v[208:211], v[144:147], v[16:31]
    v_mfma_f32_32x32x16_bf16 v[48:63], v[208:211], v[148:151], v[48:63]
    v_mfma_f32_32x32x16_bf16 v[32:47], v[212:215], v[144:147], v[32:47]
    v_mfma_f32_32x32x16_bf16 v[64:79], v[212:215], v[148:151], v[64:79]
    s_min_u32 s52, s64, 87040
    s_add_u32 s52, s52, s50
    buffer_load_dwordx4 v[144:147], v2, s[28:31], s52 offen sc1
    buffer_load_dwordx4 v[148:151], v3, s[28:31], s52 offen sc1
    s_add_u32 s64, s64, 4096
    s_cmp_ge_u32 s64, s66
    s_cselect_b32 s64, s65, s64
    s_add_u32 m0, s49, 106496
    s_nop 0
    buffer_load_dwordx4 v4, s[40:43], s68 offen lds
    buffer_load_dwordx4 v5, s[40:43], s68 offen offset:1024 lds
    s_add_u32 s68, s68, 65536
    s_cmp_ge_u32 s68, s61
    s_cselect_b32 s68, s51, s68
    ds_read_b64_tr_b16 v[208:209], v248 offset:57344
    ds_read_b64_tr_b16 v[210:211], v248 offset:58368
    ds_read_b64_tr_b16 v[212:213], v248 offset:57600
    ds_read_b64_tr_b16 v[214:215], v248 offset:58624
    s_waitcnt vmcnt(18)
    s_waitcnt lgkmcnt(4)
    v_mfma_f32_32x32x16_bf16 v[16:31], v[216:219], v[152:155], v[16:31]
    v_mfma_f32_32x32x16_bf16 v[48:63], v[216:219], v[156:159], v[48:63]
    v_mfma_f32_32x32x16_bf16 v[32:47], v[220:223], v[152:155], v[32:47]
    v_mfma_f32_32x32x16_bf16 v[64:79], v[220:223], v[156:159], v[64:79]
    s_min_u32 s52, s64, 87040
    s_add_u32 s52, s52, s50
    buffer_load_dwordx4 v[152:155], v2, s[28:31], s52 offen sc1
    buffer_load_dwordx4 v[156:159], v3, s[28:31], s52 offen sc1
    s_add_u32 s64, s64, 4096
    s_cmp_ge_u32 s64, s66
    s_cselect_b32 s64, s65, s64
    s_add_u32 m0, s49, 114688
    s_nop 0
    buffer_load_dwordx4 v4, s[40:43], s68 offen lds
    buffer_load_dwordx4 v5, s[40:43], s68 offen offset:1024 lds
    s_add_u32 s68, s68, 65536
    s_cmp_ge_u32 s68, s61
    s_cselect_b32 s68, s51, s68
    ds_read_b64_tr_b16 v[216:217], v249 offset:0
    ds_read_b64_tr_b16 v[218:219], v249 offset:1024
    ds_read_b64_tr_b16 v[220:221], v249 offset:256
    ds_read_b64_tr_b16 v[222:223], v249 offset:1280
    s_waitcnt vmcnt(20)
    s_waitcnt lgkmcnt(4)
    v_mfma_f32_32x32x16_bf16 v[16:31], v[208:211], v[160:163], v[16:31]
    v_mfma_f32_32x32x16_bf16 v[48:63], v[208:211], v[164:167], v[48:63]
    v_mfma_f32_32x32x16_bf16 v[32:47], v[212:215], v[160:163], v[32:47]
    v_mfma_f32_32x32x16_bf16 v[64:79], v[212:215], v[164:167], v[64:79]
    s_min_u32 s52, s64, 87040
    s_add_u32 s52, s52, s50
    buffer_load_dwordx4 v[160:163], v2, s[28:31], s52 offen sc1
    buffer_load_dwordx4 v[164:167], v3, s[28:31], s52 offen sc1
    s_add_u32 s64, s64, 4096
    s_cmp_ge_u32 s64, s66
    s_cselect_b32 s64, s65, s64
    s_add_u32 m0, s49, 122880
    s_nop 0
    buffer_load_dwordx4 v4, s[40:43], s68 offen lds
    buffer_load_dwordx4 v5, s[40:43], s68 offen offset:1024 lds
    s_add_u32 s68, s68, 65536
    s_cmp_ge_u32 s68, s61
    s_cselect_b32 s68, s51, s68
    ds_read_b64_tr_b16 v[208:209], v249 offset:8192
    ds_read_b64_tr_b16 v[210:211], v249 offset:9216
    ds_read_b64_tr_b16 v[212:213], v249 offset:8448
    ds_read_b64_tr_b16 v[214:215], v249 offset:9472
    s_waitcnt vmcnt(22)
    s_waitcnt lgkmcnt(4)
    v_mfma_f32_32x32x16_bf16 v[16:31], v[216:219], v[168:171], v[16:31]
    v_mfma_f32_32x32x16_bf16 v[48:63], v[216:219], v[172:175], v[48:63]
    v_mfma_f32_32x32x16_bf16 v[32:47], v[220:223], v[168:171], v[32:47]
    v_mfma_f32_32x32x16_bf16 v[64:79], v[220:223], v[172:175], v[64:79]
    s_min_u32 s52, s64, 87040
    s_add_u32 s52, s52, s50
    buffer_load_dwordx4 v[168:171], v2, s[28:31], s52 offen sc1
    buffer_load_dwordx4 v[172:175], v3, s[28:31], s52 offen sc1
    s_add_u32 s64, s64, 4096
    s_cmp_ge_u32 s64, s66
    s_cselect_b32 s64, s65, s64
    s_add_u32 m0, s49, 131072
    s_nop 0
    buffer_load_dwordx4 v4, s[40:43], s68 offen lds
    buffer_load_dwordx4 v5, s[40:43], s68 offen offset:1024 lds
    s_add_u32 s68, s68, 65536
    s_cmp_ge_u32 s68, s61
    s_cselect_b32 s68, s51, s68
    ds_read_b64_tr_b16 v[216:217], v249 offset:16384
    ds_read_b64_tr_b16 v[218:219], v249 offset:17408
    ds_read_b64_tr_b16 v[220:221], v249 offset:16640
    ds_read_b64_tr_b16 v[222:223], v249 offset:17664
    s_waitcnt vmcnt(24)
    s_waitcnt lgkmcnt(4)
    v_mfma_f32_32x32x16_bf16 v[16:31], v[208:211], v[176:179], v[16:31]
    v_mfma_f32_32x32x16_bf16 v[48:63], v[208:211], v[180:183], v[48:63]
    v_mfma_f32_32x32x16_bf16 v[32:47], v[212:215], v[176:179], v[32:47]
    v_mfma_f32_32x32x16_bf16 v[64:79], v[212:215], v[180:183], v[64:79]
    s_min_u32 s52, s64, 87040
    s_add_u32 s52, s52, s50
    buffer_load_dwordx4 v[176:179], v2, s[28:31], s52 offen sc1
    buffer_load_dwordx4 v[180:183], v3, s[28:31], s52 offen sc1
    s_add_u32 s64, s64, 4096
    s_cmp_ge_u32 s64, s66
    s_cselect_b32 s64, s65, s64
    s_add_u32 m0, s49, 139264
    s_nop 0
    buffer_load_dwordx4 v4, s[40:43], s68 offen lds
    buffer_load_dwordx4 v5, s[40:43], s68 offen offset:1024 lds
    s_add_u32 s68, s68, 65536
    s_cmp_ge_u32 s68, s61
    s_cselect_b32 s68, s51, s68
    ds_read_b64_tr_b16 v[208:209], v249 offset:24576
    ds_read_b64_tr_b16 v[210:211], v249 offset:25600
    ds_read_b64_tr_b16 v[212:213], v249 offset:24832
    ds_read_b64_tr_b16 v[214:215], v249 offset:25856
    s_waitcnt vmcnt(26)
    s_waitcnt lgkmcnt(4)
    v_mfma_f32_32x32x16_bf16 v[16:31], v[216:219], v[184:187], v[16:31]
    v_mfma_f32_32x32x16_bf16 v[48:63], v[216:219], v[188:191], v[48:63]
    v_mfma_f32_32x32x16_bf16 v[32:47], v[220:223], v[184:187], v[32:47]
    v_mfma_f32_32x32x16_bf16 v[64:79], v[220:223], v[188:191], v[64:79]
    s_min_u32 s52, s64, 87040
    s_add_u32 s52, s52, s50
    buffer_load_dwordx4 v[184:187], v2, s[28:31], s52 offen sc1
    buffer_load_dwordx4 v[188:191], v3, s[28:31], s52 offen sc1
    s_add_u32 s64, s64, 4096
    s_cmp_ge_u32 s64, s66
    s_cselect_b32 s64, s65, s64
    s_add_u32 m0, s49, 147456
    s_nop 0
    buffer_load_dwordx4 v4, s[40:43], s68 offen lds
    buffer_load_dwordx4 v5, s[40:43], s68 offen offset:1024 lds
    s_add_u32 s68, s68, 65536
    s_cmp_ge_u32 s68, s61
    s_cselect_b32 s68, s51, s68
    ds_read_b64_tr_b16 v[216:217], v6 offset:40960
    ds_read_b64_tr_b16 v[218:219], v6 offset:41984
    ds_read_b64_tr_b16 v[220:221], v6 offset:41216
    ds_read_b64_tr_b16 v[222:223], v6 offset:42240
    s_waitcnt vmcnt(28)
    s_waitcnt lgkmcnt(4)
    v_mfma_f32_32x32x16_bf16 v[16:31], v[208:211], v[192:195], v[16:31]
    v_mfma_f32_32x32x16_bf16 v[48:63], v[208:211], v[196:199], v[48:63]
    v_mfma_f32_32x32x16_bf16 v[32:47], v[212:215], v[192:195], v[32:47]
    v_mfma_f32_32x32x16_bf16 v[64:79], v[212:215], v[196:199], v[64:79]
    s_add_u32 m0, s49, 155648
    s_nop 0
    buffer_load_dwordx4 v4, s[40:43], s68 offen lds
    buffer_load_dwordx4 v5, s[40:43], s68 offen offset:1024 lds
    s_add_u32 s68, s68, 65536
    s_cmp_ge_u32 s68, s61
    s_cselect_b32 s68, s51, s68
    ds_read_b64_tr_b16 v[208:209], v6 offset:49152
    ds_read_b64_tr_b16 v[210:211], v6 offset:50176
    ds_read_b64_tr_b16 v[212:213], v6 offset:49408
    ds_read_b64_tr_b16 v[214:215], v6 offset:50432
    s_waitcnt vmcnt(28)
    s_waitcnt lgkmcnt(4)
    v_mfma_f32_32x32x16_bf16 v[16:31], v[216:219], v[200:203], v[16:31]
    v_mfma_f32_32x32x16_bf16 v[48:63], v[216:219], v[204:207], v[48:63]
    v_mfma_f32_32x32x16_bf16 v[32:47], v[220:223], v[200:203], v[32:47]
    v_mfma_f32_32x32x16_bf16 v[64:79], v[220:223], v[204:207], v[64:79]
    ds_read_b64_tr_b16 v[216:217], v6 offset:57344
    ds_read_b64_tr_b16 v[218:219], v6 offset:58368
    ds_read_b64_tr_b16 v[220:221], v6 offset:57600
    ds_read_b64_tr_b16 v[222:223], v6 offset:58624
    s_waitcnt vmcnt(24)
    s_waitcnt lgkmcnt(4)
    v_mfma_f32_32x32x16_bf16 v[16:31], v[208:211], v[144:147], v[16:31]
    v_mfma_f32_32x32x16_bf16 v[48:63], v[208:211], v[148:151], v[48:63]
    v_mfma_f32_32x32x16_bf16 v[32:47], v[212:215], v[144:147], v[32:47]
    v_mfma_f32_32x32x16_bf16 v[64:79], v[212:215], v[148:151], v[64:79]
    ds_read_b64_tr_b16 v[208:209], v248 offset:0
    ds_read_b64_tr_b16 v[210:211], v248 offset:1024
    ds_read_b64_tr_b16 v[212:213], v248 offset:256
    ds_read_b64_tr_b16 v[214:215], v248 offset:1280
    s_waitcnt vmcnt(20)
    s_waitcnt lgkmcnt(4)
    v_mfma_f32_32x32x16_bf16 v[16:31], v[216:219], v[152:155], v[16:31]
    v_mfma_f32_32x32x16_bf16 v[48:63], v[216:219], v[156:159], v[48:63]
    v_mfma_f32_32x32x16_bf16 v[32:47], v[220:223], v[152:155], v[32:47]
    v_mfma_f32_32x32x16_bf16 v[64:79], v[220:223], v[156:159], v[64:79]
    ds_read_b64_tr_b16 v[216:217], v248 offset:8192
    ds_read_b64_tr_b16 v[218:219], v248 offset:9216
    ds_read_b64_tr_b16 v[220:221], v248 offset:8448
    ds_read_b64_tr_b16 v[222:223], v248 offset:9472
    s_waitcnt vmcnt(16)
    s_waitcnt lgkmcnt(4)
    v_mfma_f32_32x32x16_bf16 v[16:31], v[208:211], v[160:163], v[16:31]
    v_mfma_f32_32x32x16_bf16 v[48:63], v[208:211], v[164:167], v[48:63]
    v_mfma_f32_32x32x16_bf16 v[32:47], v[212:215], v[160:163], v[32:47]
    v_mfma_f32_32x32x16_bf16 v[64:79], v[212:215], v[164:167], v[64:79]
    ds_read_b64_tr_b16 v[208:209], v248 offset:16384
    ds_read_b64_tr_b16 v[210:211], v248 offset:17408
    ds_read_b64_tr_b16 v[212:213], v248 offset:16640
    ds_read_b64_tr_b16 v[214:215], v248 offset:17664
    s_waitcnt vmcnt(12)
    s_waitcnt lgkmcnt(4)
    v_mfma_f32_32x32x16_bf16 v[16:31], v[216:219], v[168:171], v[16:31]
    v_mfma_f32_32x32x16_bf16 v[48:63], v[216:219], v[172:175], v[48:63]
    v_mfma_f32_32x32x16_bf16 v[32:47], v[220:223], v[168:171], v[32:47]
    v_mfma_f32_32x32x16_bf16 v[64:79], v[220:223], v[172:175], v[64:79]
    s_waitcnt vmcnt(42)
    ds_read_b64_tr_b16 v[216:217], v248 offset:24576
    ds_read_b64_tr_b16 v[218:219], v248 offset:25600
    ds_read_b64_tr_b16 v[220:221], v248 offset:24832
    ds_read_b64_tr_b16 v[222:223], v248 offset:25856
    s_waitcnt vmcnt(8)
    s_waitcnt lgkmcnt(4)
    v_mfma_f32_32x32x16_bf16 v[16:31], v[208:211], v[176:179], v[16:31]
    v_mfma_f32_32x32x16_bf16 v[48:63], v[208:211], v[180:183], v[48:63]
    v_mfma_f32_32x32x16_bf16 v[32:47], v[212:215], v[176:179], v[32:47]
    v_mfma_f32_32x32x16_bf16 v[64:79], v[212:215], v[180:183], v[64:79]
    s_mov_b64 exec, 0xff
    buffer_load_dwordx2 v[12:13], v10, s[28:31], s55 offen sc1
    s_mov_b64 exec, -1
    s_waitcnt vmcnt(27)
    ds_read_b64_tr_b16 v[208:209], v248 offset:32768
    ds_read_b64_tr_b16 v[210:211], v248 offset:33792
    ds_read_b64_tr_b16 v[212:213], v248 offset:33024
    ds_read_b64_tr_b16 v[214:215], v248 offset:34048
    s_waitcnt vmcnt(5)
    s_waitcnt lgkmcnt(4)
    v_mfma_f32_32x32x16_bf16 v[16:31], v[216:219], v[184:187], v[16:31]
    v_mfma_f32_32x32x16_bf16 v[48:63], v[216:219], v[188:191], v[48:63]
    v_mfma_f32_32x32x16_bf16 v[32:47], v[220:223], v[184:187], v[32:47]
    v_mfma_f32_32x32x16_bf16 v[64:79], v[220:223], v[188:191], v[64:79]
    s_waitcnt vmcnt(0)
    s_mov_b64 exec, 0xff
    v_cmp_ne_u64 vcc, v[12:13], v[252:253]
    s_mov_b64 exec, -1
    s_cbranch_vccz L_FOK
    s_mov_b32 s96, 0
    s_mov_b32 exec_lo, 0xff
    s_mov_b32 exec_hi, 0
L_PO:
    buffer_load_dwordx2 v[12:13], v10, s[28:31], s55 offen sc1
    s_add_u32 s96, s96, 1
    s_waitcnt vmcnt(0)
    v_cmp_ne_u64 vcc, v[12:13], v[252:253]
    s_cmp_ge_u32 s96, 200000
    s_cbranch_scc1 L_PO_X
    s_cbranch_vccz L_PO_X
    s_sleep 1
    s_branch L_PO
L_PO_X:
    s_mov_b64 exec, -1
L_FOK:
    s_add_u32 s52, s69, 88064
    s_add_u32 s52, s52, s50
    buffer_load_dwordx4 v[192:195], v2, s[28:31], s52 offen sc1
    buffer_load_dwordx4 v[196:199], v3, s[28:31], s52 offen sc1
    s_add_u32 s69, s69, 4096
    s_cmp_ge_u32 s69, s70
    s_cselect_b32 s69, s65, s69
    s_add_u32 s52, s69, 88064
    s_add_u32 s52, s52, s50
    buffer_load_dwordx4 v[200:203], v2, s[28:31], s52 offen sc1
    buffer_load_dwordx4 v[204:207], v3, s[28:31], s52 offen sc1
    s_add_u32 s69, s69, 4096
    s_cmp_ge_u32 s69, s70
    s_cselect_b32 s69, s65, s69
    s_add_u32 s52, s69, 88064
    s_add_u32 s52, s52, s50
    buffer_load_dwordx4 v[144:147], v2, s[28:31], s52 offen sc1
    buffer_load_dwordx4 v[148:151], v3, s[28:31], s52 offen sc1
    s_add_u32 s69, s69, 4096
    s_cmp_ge_u32 s69, s70
    s_cselect_b32 s69, s65, s69
    s_add_u32 s52, s69, 88064
    s_add_u32 s52, s52, s50
    buffer_load_dwordx4 v[152:155], v2, s[28:31], s52 offen sc1
    buffer_load_dwordx4 v[156:159], v3, s[28:31], s52 offen sc1
    s_add_u32 s69, s69, 4096
    s_cmp_ge_u32 s69, s70
    s_cselect_b32 s69, s65, s69
    s_add_u32 s52, s69, 88064
    s_add_u32 s52, s52, s50
    buffer_load_dwordx4 v[160:163], v2, s[28:31], s52 offen sc1
    buffer_load_dwordx4 v[164:167], v3, s[28:31], s52 offen sc1
    s_add_u32 s69, s69, 4096
    s_cmp_ge_u32 s69, s70
    s_cselect_b32 s69, s65, s69
    s_add_u32 s52, s69, 88064
    s_add_u32 s52, s52, s50
    buffer_load_dwordx4 v[168:171], v2, s[28:31], s52 offen sc1
    buffer_load_dwordx4 v[172:175], v3, s[28:31], s52 offen sc1
    s_add_u32 s69, s69, 4096
    s_cmp_ge_u32 s69, s70
    s_cselect_b32 s69, s65, s69
    s_add_u32 s52, s69, 88064
    s_add_u32 s52, s52, s50
    buffer_load_dwordx4 v[176:179], v2, s[28:31], s52 offen sc1
    buffer_load_dwordx4 v[180:183], v3, s[28:31], s52 offen sc1
    s_add_u32 s69, s69, 4096
    s_cmp_ge_u32 s69, s70
    s_cselect_b32 s69, s65, s69
    s_add_u32 s52, s69, 88064
    s_add_u32 s52, s52, s50
    buffer_load_dwordx4 v[184:187], v2, s[28:31], s52 offen sc1
    buffer_load_dwordx4 v[188:191], v3, s[28:31], s52 offen sc1
    s_add_u32 s69, s69, 4096
    s_cmp_ge_u32 s69, s70
    s_cselect_b32 s69, s65, s69
    v_add_f32 v246, 1.0, v246
    v_add_f32 v247, 1.0, v247
    v_rcp_f32 v246, v246
    v_rcp_f32 v247, v247
    s_nop 4
    v_mul_f32 v16, v16, v14
    v_mul_f32 v17, v17, v14
    v_mul_f32 v18, v18, v14
    v_mul_f32 v19, v19, v14
    v_mul_f32 v20, v20, v14
    v_mul_f32 v21, v21, v14
    v_mul_f32 v22, v22, v14
    v_mul_f32 v23, v23, v14
    v_mul_f32 v24, v24, v14
    v_mul_f32 v25, v25, v14
    v_mul_f32 v26, v26, v14
    v_mul_f32 v27, v27, v14
    v_mul_f32 v28, v28, v14
    v_mul_f32 v29, v29, v14
    v_mul_f32 v30, v30, v14
    v_mul_f32 v31, v31, v14
    v_mul_f32 v48, v48, v15
    v_mul_f32 v49, v49, v15
    v_mul_f32 v50, v50, v15
    v_mul_f32 v51, v51, v15
    v_mul_f32 v52, v52, v15
    v_mul_f32 v53, v53, v15
    v_mul_f32 v54, v54, v15
    v_mul_f32 v55, v55, v15
    v_mul_f32 v56, v56, v15
    v_mul_f32 v57, v57, v15
    v_mul_f32 v58, v58, v15
    v_mul_f32 v59, v59, v15
    v_mul_f32 v60, v60, v15
    v_mul_f32 v61, v61, v15
    v_mul_f32 v62, v62, v15
    v_mul_f32 v63, v63, v15
    v_mul_f32 v32, v32, v14
    v_mul_f32 v33, v33, v14
    v_mul_f32 v34, v34, v14
    v_mul_f32 v35, v35, v14
    v_mul_f32 v36, v36, v14
    v_mul_f32 v37, v37, v14
    v_mul_f32 v38, v38, v14
    v_mul_f32 v39, v39, v14
    v_mul_f32 v40, v40, v14
    v_mul_f32 v41, v41, v14
    v_mul_f32 v42, v42, v14
    v_mul_f32 v43, v43, v14
    v_mul_f32 v44, v44, v14
    v_mul_f32 v45, v45, v14
    v_mul_f32 v46, v46, v14
    v_mul_f32 v47, v47, v14
    v_mul_f32 v64, v64, v15
    v_mul_f32 v65, v65, v15
    v_mul_f32 v66, v66, v15
    v_mul_f32 v67, v67, v15
    v_mul_f32 v68, v68, v15
    v_mul_f32 v69, v69, v15
    v_mul_f32 v70, v70, v15
    v_mul_f32 v71, v71, v15
    v_mul_f32 v72, v72, v15
    v_mul_f32 v73, v73, v15
    v_mul_f32 v74, v74, v15
    v_mul_f32 v75, v75, v15
    v_mul_f32 v76, v76, v15
    v_mul_f32 v77, v77, v15
    v_mul_f32 v78, v78, v15
    v_mul_f32 v79, v79, v15
    ds_read_b64_tr_b16 v[216:217], v248 offset:40960
    ds_read_b64_tr_b16 v[218:219], v248 offset:41984
    ds_read_b64_tr_b16 v[220:221], v248 offset:41216
    ds_read_b64_tr_b16 v[222:223], v248 offset:42240
    s_waitcnt vmcnt(14)
    s_waitcnt lgkmcnt(4)
    v_mfma_f32_32x32x16_bf16 v[16:31], v[208:211], v[192:195], v[16:31]
    v_mfma_f32_32x32x16_bf16 v[48:63], v[208:211], v[196:199], v[48:63]
    v_mfma_f32_32x32x16_bf16 v[32:47], v[212:215], v[192:195], v[32:47]
    v_mfma_f32_32x32x16_bf16 v[64:79], v[212:215], v[196:199], v[64:79]
    ds_read_b64_tr_b16 v[208:209], v248 offset:49152
    ds_read_b64_tr_b16 v[210:211], v248 offset:50176
    ds_read_b64_tr_b16 v[212:213], v248 offset:49408
    ds_read_b64_tr_b16 v[214:215], v248 offset:50432
    s_waitcnt vmcnt(12)
    s_waitcnt lgkmcnt(4)
    v_mfma_f32_32x32x16_bf16 v[16:31], v[216:219], v[200:203], v[16:31]
    v_mfma_f32_32x32x16_bf16 v[48:63], v[216:219], v[204:207], v[48:63]
    v_mfma_f32_32x32x16_bf16 v[32:47], v[220:223], v[200:203], v[32:47]
    v_mfma_f32_32x32x16_bf16 v[64:79], v[220:223], v[204:207], v[64:79]
    ds_read_b64_tr_b16 v[216:217], v248 offset:57344
    ds_read_b64_tr_b16 v[218:219], v248 offset:58368
    ds_read_b64_tr_b16 v[220:221], v248 offset:57600
    ds_read_b64_tr_b16 v[222:223], v248 offset:58624
    s_waitcnt vmcnt(10)
    s_waitcnt lgkmcnt(4)
    v_mfma_f32_32x32x16_bf16 v[16:31], v[208:211], v[144:147], v[16:31]
    v_mfma_f32_32x32x16_bf16 v[48:63], v[208:211], v[148:151], v[48:63]
    v_mfma_f32_32x32x16_bf16 v[32:47], v[212:215], v[144:147], v[32:47]
    v_mfma_f32_32x32x16_bf16 v[64:79], v[212:215], v[148:151], v[64:79]
    ds_read_b64_tr_b16 v[208:209], v249 offset:0
    ds_read_b64_tr_b16 v[210:211], v249 offset:1024
    ds_read_b64_tr_b16 v[212:213], v249 offset:256
    ds_read_b64_tr_b16 v[214:215], v249 offset:1280
    s_waitcnt vmcnt(8)
    s_waitcnt lgkmcnt(4)
    v_mfma_f32_32x32x16_bf16 v[16:31], v[216:219], v[152:155], v[16:31]
    v_mfma_f32_32x32x16_bf16 v[48:63], v[216:219], v[156:159], v[48:63]
    v_mfma_f32_32x32x16_bf16 v[32:47], v[220:223], v[152:155], v[32:47]
    v_mfma_f32_32x32x16_bf16 v[64:79], v[220:223], v[156:159], v[64:79]
    ds_read_b64_tr_b16 v[216:217], v249 offset:8192
    ds_read_b64_tr_b16 v[218:219], v249 offset:9216
    ds_read_b64_tr_b16 v[220:221], v249 offset:8448
    ds_read_b64_tr_b16 v[222:223], v249 offset:9472
    s_waitcnt vmcnt(6)
    s_waitcnt lgkmcnt(4)
    v_mfma_f32_32x32x16_bf16 v[16:31], v[208:211], v[160:163], v[16:31]
    v_mfma_f32_32x32x16_bf16 v[48:63], v[208:211], v[164:167], v[48:63]
    v_mfma_f32_32x32x16_bf16 v[32:47], v[212:215], v[160:163], v[32:47]
    v_mfma_f32_32x32x16_bf16 v[64:79], v[212:215], v[164:167], v[64:79]
    ds_read_b64_tr_b16 v[208:209], v249 offset:16384
    ds_read_b64_tr_b16 v[210:211], v249 offset:17408
    ds_read_b64_tr_b16 v[212:213], v249 offset:16640
    ds_read_b64_tr_b16 v[214:215], v249 offset:17664
    s_waitcnt vmcnt(4)
    s_waitcnt lgkmcnt(4)
    v_mfma_f32_32x32x16_bf16 v[16:31], v[216:219], v[168:171], v[16:31]
    v_mfma_f32_32x32x16_bf16 v[48:63], v[216:219], v[172:175], v[48:63]
    v_mfma_f32_32x32x16_bf16 v[32:47], v[220:223], v[168:171], v[32:47]
    v_mfma_f32_32x32x16_bf16 v[64:79], v[220:223], v[172:175], v[64:79]
    ds_read_b64_tr_b16 v[216:217], v249 offset:24576
    ds_read_b64_tr_b16 v[218:219], v249 offset:25600
    ds_read_b64_tr_b16 v[220:221], v249 offset:24832
    ds_read_b64_tr_b16 v[222:223], v249 offset:25856
    s_waitcnt vmcnt(2)
    s_waitcnt lgkmcnt(4)
    v_mfma_f32_32x32x16_bf16 v[16:31], v[208:211], v[176:179], v[16:31]
    v_mfma_f32_32x32x16_bf16 v[48:63], v[208:211], v[180:183], v[48:63]
    v_mfma_f32_32x32x16_bf16 v[32:47], v[212:215], v[176:179], v[32:47]
    v_mfma_f32_32x32x16_bf16 v[64:79], v[212:215], v[180:183], v[64:79]
    s_waitcnt vmcnt(0)
    s_waitcnt lgkmcnt(0)
    v_mfma_f32_32x32x16_bf16 v[16:31], v[216:219], v[184:187], v[16:31]
    v_mfma_f32_32x32x16_bf16 v[48:63], v[216:219], v[188:191], v[48:63]
    v_mfma_f32_32x32x16_bf16 v[32:47], v[220:223], v[184:187], v[32:47]
    v_mfma_f32_32x32x16_bf16 v[64:79], v[220:223], v[188:191], v[64:79]
L_OJOIN:
    s_nop 8
    ds_write_b128 v241, v[16:19] offset:0
    ds_write_b128 v242, v[20:23] offset:0
    ds_write_b128 v243, v[24:27] offset:0
    ds_write_b128 v244, v[28:31] offset:0
    ds_write_b128 v241, v[48:51] offset:32768
    ds_write_b128 v242, v[52:55] offset:32768
    ds_write_b128 v243, v[56:59] offset:32768
    ds_write_b128 v244, v[60:63] offset:32768
    ds_write_b128 v241, v[32:35] offset:128
    ds_write_b128 v242, v[36:39] offset:128
    ds_write_b128 v243, v[40:43] offset:128
    ds_write_b128 v244, v[44:47] offset:128
    ds_write_b128 v241, v[64:67] offset:32896
    ds_write_b128 v242, v[68:71] offset:32896
    ds_write_b128 v243, v[72:75] offset:32896
    ds_write_b128 v244, v[76:79] offset:32896
    s_waitcnt lgkmcnt(0)
    s_barrier
    ds_read_b128 v[80:83], v245 offset:0
    ds_read_b128 v[84:87], v240 offset:0
    ds_read_b128 v[88:91], v245 offset:2048
    ds_read_b128 v[92:95], v240 offset:2048
    ds_read_b128 v[96:99], v245 offset:4096
    ds_read_b128 v[100:103], v240 offset:4096
    ds_read_b128 v[104:107], v245 offset:6144
    ds_read_b128 v[108:111], v240 offset:6144
    ds_read_b128 v[112:115], v245 offset:8192
    ds_read_b128 v[116:119], v240 offset:8192
    ds_read_b128 v[120:123], v245 offset:10240
    ds_read_b128 v[124:127], v240 offset:10240
    ds_read_b128 v[128:131], v245 offset:12288
    ds_read_b128 v[132:135], v240 offset:12288
    ds_read_b128 v[136:139], v245 offset:14336
    ds_read_b128 v[140:143], v240 offset:14336
    s_waitcnt lgkmcnt(8)
    v_pk_add_f32 v[80:81], v[80:81], v[88:89]
    v_pk_add_f32 v[96:97], v[96:97], v[104:105]
    v_pk_add_f32 v[82:83], v[82:83], v[90:91]
    v_pk_add_f32 v[98:99], v[98:99], v[106:107]
    v_pk_add_f32 v[84:85], v[84:85], v[92:93]
    v_pk_add_f32 v[100:101], v[100:101], v[108:109]
    v_pk_add_f32 v[86:87], v[86:87], v[94:95]
    v_pk_add_f32 v[102:103], v[102:103], v[110:111]
    v_pk_add_f32 v[80:81], v[80:81], v[96:97]
    v_pk_add_f32 v[82:83], v[82:83], v[98:99]
    v_pk_add_f32 v[84:85], v[84:85], v[100:101]
    v_pk_add_f32 v[86:87], v[86:87], v[102:103]
    v_mul_f32 v80, v80, v246
    v_mul_f32 v81, v81, v246
    v_mul_f32 v82, v82, v246
    v_mul_f32 v83, v83, v246
    v_mul_f32 v84, v84, v246
    v_mul_f32 v85, v85, v246
    v_mul_f32 v86, v86, v246
    v_mul_f32 v87, v87, v246
    v_cvt_pk_bf16_f32 v88, v80, v81
    v_cvt_pk_bf16_f32 v89, v82, v83
    v_cvt_pk_bf16_f32 v90, v84, v85
    v_cvt_pk_bf16_f32 v91, v86, v87
    buffer_store_dwordx4 v[88:91], v11, s[44:47], s56 offen sc1
    s_waitcnt lgkmcnt(0)
    v_pk_add_f32 v[112:113], v[112:113], v[120:121]
    v_pk_add_f32 v[128:129], v[128:129], v[136:137]
    v_pk_add_f32 v[114:115], v[114:115], v[122:123]
    v_pk_add_f32 v[130:131], v[130:131], v[138:139]
    v_pk_add_f32 v[116:117], v[116:117], v[124:125]
    v_pk_add_f32 v[132:133], v[132:133], v[140:141]
    v_pk_add_f32 v[118:119], v[118:119], v[126:127]
    v_pk_add_f32 v[134:135], v[134:135], v[142:143]
    v_pk_add_f32 v[112:113], v[112:113], v[128:129]
    v_pk_add_f32 v[114:115], v[114:115], v[130:131]
    v_pk_add_f32 v[116:117], v[116:117], v[132:133]
    v_pk_add_f32 v[118:119], v[118:119], v[134:135]
    v_mul_f32 v112, v112, v247
    v_mul_f32 v113, v113, v247
    v_mul_f32 v114, v114, v247
    v_mul_f32 v115, v115, v247
    v_mul_f32 v116, v116, v247
    v_mul_f32 v117, v117, v247
    v_mul_f32 v118, v118, v247
    v_mul_f32 v119, v119, v247
    v_cvt_pk_bf16_f32 v120, v112, v113
    v_cvt_pk_bf16_f32 v121, v114, v115
    v_cvt_pk_bf16_f32 v122, v116, v117
    v_cvt_pk_bf16_f32 v123, v118, v119
    buffer_store_dwordx4 v[120:123], v11, s[44:47], s57 offen sc1
L_END:
    s_endpgm
L_CODE_END:
L_FB0:
    v_mov_b32 v4, 0xf149f2ca
    v_mfma_f32_32x32x16_bf16 v[176:191], v[48:51], v[136:139], 0
    v_mfma_f32_32x32x16_bf16 v[192:207], v[16:19], v[136:139], 0
    v_mfma_f32_32x32x16_bf16 v[144:159], v[20:23], v[136:139], 0
    s_nop 15
    s_cmp_ge_i32 0, s38
    s_cbranch_scc1 L_FBV_40
    v_mov_b32 v192, 0xff800000
    v_mov_b32 v193, 0xff800000
    v_mov_b32 v194, 0xff800000
    v_mov_b32 v195, 0xff800000
    v_mov_b32 v196, 0xff800000
    v_mov_b32 v197, 0xff800000
    v_mov_b32 v198, 0xff800000
    v_mov_b32 v199, 0xff800000
    v_mov_b32 v200, 0xff800000
    v_mov_b32 v201, 0xff800000
    v_mov_b32 v202, 0xff800000
    v_mov_b32 v203, 0xff800000
    v_mov_b32 v204, 0xff800000
    v_mov_b32 v205, 0xff800000
    v_mov_b32 v206, 0xff800000
    v_mov_b32 v207, 0xff800000
L_FBV_40:
    v_cndmask_b32 v176, v192, v176, s[64:65]
    v_cndmask_b32 v177, v193, v177, s[66:67]
    v_cndmask_b32 v178, v194, v178, s[68:69]
    v_cndmask_b32 v179, v195, v179, s[70:71]
    v_cndmask_b32 v180, v196, v180, s[72:73]
    v_cndmask_b32 v181, v197, v181, s[74:75]
    v_cndmask_b32 v182, v198, v182, s[76:77]
    v_cndmask_b32 v183, v199, v183, s[78:79]
    v_cndmask_b32 v184, v200, v184, s[80:81]
    v_cndmask_b32 v185, v201, v185, s[82:83]
    v_cndmask_b32 v186, v202, v186, s[84:85]
    v_cndmask_b32 v187, v203, v187, s[86:87]
    v_cndmask_b32 v188, v204, v188, s[88:89]
    v_cndmask_b32 v189, v205, v189, s[90:91]
    v_cndmask_b32 v190, v206, v190, s[92:93]
    v_cndmask_b32 v191, v207, v191, s[94:95]
    v_mov_b32 v4, 0xff800000
    v_max3_f32 v4, v4, v176, v177
    v_max3_f32 v4, v4, v178, v179
    v_max3_f32 v4, v4, v180, v181
    v_max3_f32 v4, v4, v182, v183
    v_max3_f32 v4, v4, v184, v185
    v_max3_f32 v4, v4, v186, v187
    v_max3_f32 v4, v4, v188, v189
    v_max3_f32 v4, v4, v190, v191
    v_mfma_f32_32x32x16_bf16 v[160:175], v[24:27], v[136:139], 0
    s_cmp_lt_i32 1, s38
    s_cbranch_scc1 L_F1_41
    v_max3_f32 v4, v4, v144, v145
    v_max3_f32 v4, v4, v146, v147
    v_max3_f32 v4, v4, v148, v149
    v_max3_f32 v4, v4, v150, v151
    v_max3_f32 v4, v4, v152, v153
    v_max3_f32 v4, v4, v154, v155
    v_max3_f32 v4, v4, v156, v157
    v_max3_f32 v4, v4, v158, v159
L_F1_41:
    s_nop 9
    v_mfma_f32_32x32x16_bf16 v[144:159], v[28:31], v[136:139], 0
    s_cmp_lt_i32 2, s38
    s_cbranch_scc1 L_F1_42
    v_max3_f32 v4, v4, v160, v161
    v_max3_f32 v4, v4, v162, v163
    v_max3_f32 v4, v4, v164, v165
    v_max3_f32 v4, v4, v166, v167
    v_max3_f32 v4, v4, v168, v169
    v_max3_f32 v4, v4, v170, v171
    v_max3_f32 v4, v4, v172, v173
    v_max3_f32 v4, v4, v174, v175
L_F1_42:
    s_nop 9
    v_mfma_f32_32x32x16_bf16 v[160:175], v[32:35], v[136:139], 0
    s_cmp_lt_i32 3, s38
    s_cbranch_scc1 L_F1_43
    v_max3_f32 v4, v4, v144, v145
    v_max3_f32 v4, v4, v146, v147
    v_max3_f32 v4, v4, v148, v149
    v_max3_f32 v4, v4, v150, v151
    v_max3_f32 v4, v4, v152, v153
    v_max3_f32 v4, v4, v154, v155
    v_max3_f32 v4, v4, v156, v157
    v_max3_f32 v4, v4, v158, v159
L_F1_43:
    s_nop 9
    v_mfma_f32_32x32x16_bf16 v[144:159], v[36:39], v[136:139], 0
    s_cmp_lt_i32 4, s38
    s_cbranch_scc1 L_F1_44
    v_max3_f32 v4, v4, v160, v161
    v_max3_f32 v4, v4, v162, v163
    v_max3_f32 v4, v4, v164, v165
    v_max3_f32 v4, v4, v166, v167
    v_max3_f32 v4, v4, v168, v169
    v_max3_f32 v4, v4, v170, v171
    v_max3_f32 v4, v4, v172, v173
    v_max3_f32 v4, v4, v174, v175
L_F1_44:
    s_nop 9
    v_mfma_f32_32x32x16_bf16 v[160:175], v[40:43], v[136:139], 0
    s_cmp_lt_i32 5, s38
    s_cbranch_scc1 L_F1_45
    v_max3_f32 v4, v4, v144, v145
    v_max3_f32 v4, v4, v146, v147
    v_max3_f32 v4, v4, v148, v149
    v_max3_f32 v4, v4, v150, v151
    v_max3_f32 v4, v4, v152, v153
    v_max3_f32 v4, v4, v154, v155
    v_max3_f32 v4, v4, v156, v157
    v_max3_f32 v4, v4, v158, v159
L_F1_45:
    s_nop 9
    v_mfma_f32_32x32x16_bf16 v[144:159], v[44:47], v[136:139], 0
    s_cmp_lt_i32 6, s38
    s_cbranch_scc1 L_F1_46
    v_max3_f32 v4, v4, v160, v161
    v_max3_f32 v4, v4, v162, v163
    v_max3_f32 v4, v4, v164, v165
    v_max3_f32 v4, v4, v166, v167
    v_max3_f32 v4, v4, v168, v169
    v_max3_f32 v4, v4, v170, v171
    v_max3_f32 v4, v4, v172, v173
    v_max3_f32 v4, v4, v174, v175
L_F1_46:
    s_nop 9
    s_cmp_lt_i32 7, s38
    s_cbranch_scc1 L_F1_47
    v_max3_f32 v4, v4, v144, v145
    v_max3_f32 v4, v4, v146, v147
    v_max3_f32 v4, v4, v148, v149
    v_max3_f32 v4, v4, v150, v151
    v_max3_f32 v4, v4, v152, v153
    v_max3_f32 v4, v4, v154, v155
    v_max3_f32 v4, v4, v156, v157
    v_max3_f32 v4, v4, v158, v159
L_F1_47:
    s_nop 9
    v_mov_b32 v5, v4
    s_nop 1
    v_permlane32_swap_b32 v4, v5
    s_nop 1
    v_max_f32 v4, v4, v5
    v_sub_f32 v4, 0, v4
    v_mov_b32 v192, v4
    v_mov_b32 v193, v4
    v_mov_b32 v194, v4
    v_mov_b32 v195, v4
    v_mov_b32 v196, v4
    v_mov_b32 v197, v4
    v_mov_b32 v198, v4
    v_mov_b32 v199, v4
    v_mov_b32 v200, v4
    v_mov_b32 v201, v4
    v_mov_b32 v202, v4
    v_mov_b32 v203, v4
    v_mov_b32 v204, v4
    v_mov_b32 v205, v4
    v_mov_b32 v206, v4
    v_mov_b32 v207, v4
    v_mov_b32 v208, 0
    v_mov_b32 v209, 0
    v_mov_b32 v210, 0
    v_mov_b32 v211, 0
    v_mov_b32 v212, 0
    v_mov_b32 v213, 0
    v_mov_b32 v214, 0
    v_mov_b32 v215, 0
    v_mov_b32 v216, 0
    v_mov_b32 v217, 0
    v_mov_b32 v218, 0
    v_mov_b32 v219, 0
    v_mov_b32 v220, 0
    v_mov_b32 v221, 0
    v_mov_b32 v222, 0
    v_mov_b32 v223, 0
    v_mfma_f32_32x32x16_bf16 v[144:159], v[20:23], v[136:139], v[192:207]
    v_add_f32 v176, v176, v4
    v_add_f32 v177, v177, v4
    v_add_f32 v178, v178, v4
    v_add_f32 v179, v179, v4
    v_add_f32 v180, v180, v4
    v_add_f32 v181, v181, v4
    v_add_f32 v182, v182, v4
    v_add_f32 v183, v183, v4
    v_add_f32 v184, v184, v4
    v_add_f32 v185, v185, v4
    v_add_f32 v186, v186, v4
    v_add_f32 v187, v187, v4
    v_add_f32 v188, v188, v4
    v_add_f32 v189, v189, v4
    v_add_f32 v190, v190, v4
    v_add_f32 v191, v191, v4
    v_exp_f32 v176, v176
    v_exp_f32 v177, v177
    v_exp_f32 v178, v178
    v_exp_f32 v179, v179
    v_exp_f32 v180, v180
    v_exp_f32 v181, v181
    v_exp_f32 v182, v182
    v_exp_f32 v183, v183
    v_exp_f32 v184, v184
    v_exp_f32 v185, v185
    v_exp_f32 v186, v186
    v_exp_f32 v187, v187
    v_exp_f32 v188, v188
    v_exp_f32 v189, v189
    v_exp_f32 v190, v190
    v_exp_f32 v191, v191
    s_nop 0
    v_cvt_pk_bf16_f32 v232, v176, v177
    v_cvt_pk_bf16_f32 v233, v178, v179
    v_cvt_pk_bf16_f32 v234, v180, v181
    v_cvt_pk_bf16_f32 v235, v182, v183
    v_cvt_pk_bf16_f32 v236, v184, v185
    v_cvt_pk_bf16_f32 v237, v186, v187
    v_cvt_pk_bf16_f32 v238, v188, v189
    v_cvt_pk_bf16_f32 v239, v190, v191
    v_and_b32 v224, v232, v240
    v_and_b32 v225, v233, v241
    v_and_b32 v226, v234, v242
    v_and_b32 v227, v235, v243
    v_and_b32 v228, v236, v244
    v_and_b32 v229, v237, v245
    v_and_b32 v230, v238, v246
    v_and_b32 v231, v239, v247
    v_xor_b32 v232, v232, v224
    v_xor_b32 v233, v233, v225
    v_xor_b32 v234, v234, v226
    v_xor_b32 v235, v235, v227
    v_xor_b32 v236, v236, v228
    v_xor_b32 v237, v237, v229
    v_xor_b32 v238, v238, v230
    v_xor_b32 v239, v239, v231
    s_nop 1
    v_mfma_f32_32x32x16_bf16 v[208:223], v[120:123], v[224:227], v[208:223]
    v_mfma_f32_32x32x16_bf16 v[208:223], v[124:127], v[228:231], v[208:223]
    s_cmp_lt_i32 0, s38
    s_cbranch_scc1 L_FBW_48
    v_mfma_f32_32x32x16_bf16 v[208:223], v[56:59], v[232:235], v[208:223]
    v_mfma_f32_32x32x16_bf16 v[208:223], v[60:63], v[236:239], v[208:223]
L_FBW_48:
    v_mfma_f32_32x32x16_bf16 v[160:175], v[24:27], v[136:139], v[192:207]
    s_cmp_lt_i32 1, s38
    s_cbranch_scc1 L_F2_49
    v_exp_f32 v144, v144
    v_exp_f32 v145, v145
    v_exp_f32 v146, v146
    v_exp_f32 v147, v147
    v_exp_f32 v148, v148
    v_exp_f32 v149, v149
    v_exp_f32 v150, v150
    v_exp_f32 v151, v151
    v_exp_f32 v152, v152
    v_exp_f32 v153, v153
    v_exp_f32 v154, v154
    v_exp_f32 v155, v155
    v_exp_f32 v156, v156
    v_exp_f32 v157, v157
    v_exp_f32 v158, v158
    v_exp_f32 v159, v159
    s_nop 0
    v_cvt_pk_bf16_f32 v224, v144, v145
    v_cvt_pk_bf16_f32 v225, v146, v147
    v_cvt_pk_bf16_f32 v226, v148, v149
    v_cvt_pk_bf16_f32 v227, v150, v151
    v_cvt_pk_bf16_f32 v228, v152, v153
    v_cvt_pk_bf16_f32 v229, v154, v155
    v_cvt_pk_bf16_f32 v230, v156, v157
    v_cvt_pk_bf16_f32 v231, v158, v159
    s_nop 1
    v_mfma_f32_32x32x16_bf16 v[208:223], v[64:67], v[224:227], v[208:223]
    v_mfma_f32_32x32x16_bf16 v[208:223], v[68:71], v[228:231], v[208:223]
L_F2_49:
    s_nop 9
    v_mfma_f32_32x32x16_bf16 v[144:159], v[28:31], v[136:139], v[192:207]
    s_cmp_lt_i32 2, s38
    s_cbranch_scc1 L_F2_50
    v_exp_f32 v160, v160
    v_exp_f32 v161, v161
    v_exp_f32 v162, v162
    v_exp_f32 v163, v163
    v_exp_f32 v164, v164
    v_exp_f32 v165, v165
    v_exp_f32 v166, v166
    v_exp_f32 v167, v167
    v_exp_f32 v168, v168
    v_exp_f32 v169, v169
    v_exp_f32 v170, v170
    v_exp_f32 v171, v171
    v_exp_f32 v172, v172
    v_exp_f32 v173, v173
    v_exp_f32 v174, v174
    v_exp_f32 v175, v175
    s_nop 0
    v_cvt_pk_bf16_f32 v232, v160, v161
    v_cvt_pk_bf16_f32 v233, v162, v163
    v_cvt_pk_bf16_f32 v234, v164, v165
    v_cvt_pk_bf16_f32 v235, v166, v167
    v_cvt_pk_bf16_f32 v236, v168, v169
    v_cvt_pk_bf16_f32 v237, v170, v171
    v_cvt_pk_bf16_f32 v238, v172, v173
    v_cvt_pk_bf16_f32 v239, v174, v175
    s_nop 1
    v_mfma_f32_32x32x16_bf16 v[208:223], v[72:75], v[232:235], v[208:223]
    v_mfma_f32_32x32x16_bf16 v[208:223], v[76:79], v[236:239], v[208:223]
L_F2_50:
    s_nop 9
    v_mfma_f32_32x32x16_bf16 v[160:175], v[32:35], v[136:139], v[192:207]
    s_cmp_lt_i32 3, s38
    s_cbranch_scc1 L_F2_51
    v_exp_f32 v144, v144
    v_exp_f32 v145, v145
    v_exp_f32 v146, v146
    v_exp_f32 v147, v147
    v_exp_f32 v148, v148
    v_exp_f32 v149, v149
    v_exp_f32 v150, v150
    v_exp_f32 v151, v151
    v_exp_f32 v152, v152
    v_exp_f32 v153, v153
    v_exp_f32 v154, v154
    v_exp_f32 v155, v155
    v_exp_f32 v156, v156
    v_exp_f32 v157, v157
    v_exp_f32 v158, v158
    v_exp_f32 v159, v159
    s_nop 0
    v_cvt_pk_bf16_f32 v224, v144, v145
    v_cvt_pk_bf16_f32 v225, v146, v147
    v_cvt_pk_bf16_f32 v226, v148, v149
    v_cvt_pk_bf16_f32 v227, v150, v151
    v_cvt_pk_bf16_f32 v228, v152, v153
    v_cvt_pk_bf16_f32 v229, v154, v155
    v_cvt_pk_bf16_f32 v230, v156, v157
    v_cvt_pk_bf16_f32 v231, v158, v159
    s_nop 1
    v_mfma_f32_32x32x16_bf16 v[208:223], v[80:83], v[224:227], v[208:223]
    v_mfma_f32_32x32x16_bf16 v[208:223], v[84:87], v[228:231], v[208:223]
L_F2_51:
    s_nop 9
    v_mfma_f32_32x32x16_bf16 v[144:159], v[36:39], v[136:139], v[192:207]
    s_cmp_lt_i32 4, s38
    s_cbranch_scc1 L_F2_52
    v_exp_f32 v160, v160
    v_exp_f32 v161, v161
    v_exp_f32 v162, v162
    v_exp_f32 v163, v163
    v_exp_f32 v164, v164
    v_exp_f32 v165, v165
    v_exp_f32 v166, v166
    v_exp_f32 v167, v167
    v_exp_f32 v168, v168
    v_exp_f32 v169, v169
    v_exp_f32 v170, v170
    v_exp_f32 v171, v171
    v_exp_f32 v172, v172
    v_exp_f32 v173, v173
    v_exp_f32 v174, v174
    v_exp_f32 v175, v175
    s_nop 0
    v_cvt_pk_bf16_f32 v232, v160, v161
    v_cvt_pk_bf16_f32 v233, v162, v163
    v_cvt_pk_bf16_f32 v234, v164, v165
    v_cvt_pk_bf16_f32 v235, v166, v167
    v_cvt_pk_bf16_f32 v236, v168, v169
    v_cvt_pk_bf16_f32 v237, v170, v171
    v_cvt_pk_bf16_f32 v238, v172, v173
    v_cvt_pk_bf16_f32 v239, v174, v175
    s_nop 1
    v_mfma_f32_32x32x16_bf16 v[208:223], v[88:91], v[232:235], v[208:223]
    v_mfma_f32_32x32x16_bf16 v[208:223], v[92:95], v[236:239], v[208:223]
L_F2_52:
    s_nop 9
    v_mfma_f32_32x32x16_bf16 v[160:175], v[40:43], v[136:139], v[192:207]
    s_cmp_lt_i32 5, s38
    s_cbranch_scc1 L_F2_53
    v_exp_f32 v144, v144
    v_exp_f32 v145, v145
    v_exp_f32 v146, v146
    v_exp_f32 v147, v147
    v_exp_f32 v148, v148
    v_exp_f32 v149, v149
    v_exp_f32 v150, v150
    v_exp_f32 v151, v151
    v_exp_f32 v152, v152
    v_exp_f32 v153, v153
    v_exp_f32 v154, v154
    v_exp_f32 v155, v155
    v_exp_f32 v156, v156
    v_exp_f32 v157, v157
    v_exp_f32 v158, v158
    v_exp_f32 v159, v159
    s_nop 0
    v_cvt_pk_bf16_f32 v224, v144, v145
    v_cvt_pk_bf16_f32 v225, v146, v147
    v_cvt_pk_bf16_f32 v226, v148, v149
    v_cvt_pk_bf16_f32 v227, v150, v151
    v_cvt_pk_bf16_f32 v228, v152, v153
    v_cvt_pk_bf16_f32 v229, v154, v155
    v_cvt_pk_bf16_f32 v230, v156, v157
    v_cvt_pk_bf16_f32 v231, v158, v159
    s_nop 1
    v_mfma_f32_32x32x16_bf16 v[208:223], v[96:99], v[224:227], v[208:223]
    v_mfma_f32_32x32x16_bf16 v[208:223], v[100:103], v[228:231], v[208:223]
L_F2_53:
    s_nop 9
    v_mfma_f32_32x32x16_bf16 v[144:159], v[44:47], v[136:139], v[192:207]
    s_cmp_lt_i32 6, s38
    s_cbranch_scc1 L_F2_54
    v_exp_f32 v160, v160
    v_exp_f32 v161, v161
    v_exp_f32 v162, v162
    v_exp_f32 v163, v163
    v_exp_f32 v164, v164
    v_exp_f32 v165, v165
    v_exp_f32 v166, v166
    v_exp_f32 v167, v167
    v_exp_f32 v168, v168
    v_exp_f32 v169, v169
    v_exp_f32 v170, v170
    v_exp_f32 v171, v171
    v_exp_f32 v172, v172
    v_exp_f32 v173, v173
    v_exp_f32 v174, v174
    v_exp_f32 v175, v175
    s_nop 0
    v_cvt_pk_bf16_f32 v232, v160, v161
    v_cvt_pk_bf16_f32 v233, v162, v163
    v_cvt_pk_bf16_f32 v234, v164, v165
    v_cvt_pk_bf16_f32 v235, v166, v167
    v_cvt_pk_bf16_f32 v236, v168, v169
    v_cvt_pk_bf16_f32 v237, v170, v171
    v_cvt_pk_bf16_f32 v238, v172, v173
    v_cvt_pk_bf16_f32 v239, v174, v175
    s_nop 1
    v_mfma_f32_32x32x16_bf16 v[208:223], v[104:107], v[232:235], v[208:223]
    v_mfma_f32_32x32x16_bf16 v[208:223], v[108:111], v[236:239], v[208:223]
L_F2_54:
    s_nop 9
    s_cmp_lt_i32 7, s38
    s_cbranch_scc1 L_F2_55
    v_exp_f32 v144, v144
    v_exp_f32 v145, v145
    v_exp_f32 v146, v146
    v_exp_f32 v147, v147
    v_exp_f32 v148, v148
    v_exp_f32 v149, v149
    v_exp_f32 v150, v150
    v_exp_f32 v151, v151
    v_exp_f32 v152, v152
    v_exp_f32 v153, v153
    v_exp_f32 v154, v154
    v_exp_f32 v155, v155
    v_exp_f32 v156, v156
    v_exp_f32 v157, v157
    v_exp_f32 v158, v158
    v_exp_f32 v159, v159
    s_nop 0
    v_cvt_pk_bf16_f32 v224, v144, v145
    v_cvt_pk_bf16_f32 v225, v146, v147
    v_cvt_pk_bf16_f32 v226, v148, v149
    v_cvt_pk_bf16_f32 v227, v150, v151
    v_cvt_pk_bf16_f32 v228, v152, v153
    v_cvt_pk_bf16_f32 v229, v154, v155
    v_cvt_pk_bf16_f32 v230, v156, v157
    v_cvt_pk_bf16_f32 v231, v158, v159
    s_nop 1
    v_mfma_f32_32x32x16_bf16 v[208:223], v[112:115], v[224:227], v[208:223]
    v_mfma_f32_32x32x16_bf16 v[208:223], v[116:119], v[228:231], v[208:223]
L_F2_55:
    s_nop 9
    s_nop 7
    v_rcp_f32 v5, v216
    s_add_u32 s62, s37, 0
    s_mul_i32 s62, s62, 118
    v_mul_f32 v208, v208, v5
    v_mul_f32 v209, v209, v5
    v_mul_f32 v210, v210, v5
    v_mul_f32 v211, v211, v5
    v_mul_f32 v212, v212, v5
    v_mul_f32 v213, v213, v5
    v_mul_f32 v214, v214, v5
    v_mul_f32 v215, v215, v5
    s_add_u32 s62, s62, s36
    s_lshl_b32 s62, s62, 10
    s_add_u32 s62, s62, 6379520
    v_cvt_pk_bf16_f32 v12, v208, v209
    v_cvt_pk_bf16_f32 v13, v210, v211
    v_cvt_pk_bf16_f32 v14, v212, v213
    v_cvt_pk_bf16_f32 v15, v214, v215
    buffer_store_dwordx4 v[12:15], v2, s[28:31], s62 offen sc1
    s_nop 1
    s_branch L_ATT_MID
L_FB1:
    v_mov_b32 v4, 0xf149f2ca
    v_mfma_f32_32x32x16_bf16 v[176:191], v[52:55], v[140:143], 0
    v_mfma_f32_32x32x16_bf16 v[192:207], v[20:23], v[140:143], 0
    v_mfma_f32_32x32x16_bf16 v[144:159], v[24:27], v[140:143], 0
    s_nop 15
    s_cmp_ge_i32 1, s38
    s_cbranch_scc1 L_FBV_56
    v_mov_b32 v192, 0xff800000
    v_mov_b32 v193, 0xff800000
    v_mov_b32 v194, 0xff800000
    v_mov_b32 v195, 0xff800000
    v_mov_b32 v196, 0xff800000
    v_mov_b32 v197, 0xff800000
    v_mov_b32 v198, 0xff800000
    v_mov_b32 v199, 0xff800000
    v_mov_b32 v200, 0xff800000
    v_mov_b32 v201, 0xff800000
    v_mov_b32 v202, 0xff800000
    v_mov_b32 v203, 0xff800000
    v_mov_b32 v204, 0xff800000
    v_mov_b32 v205, 0xff800000
    v_mov_b32 v206, 0xff800000
    v_mov_b32 v207, 0xff800000
L_FBV_56:
    v_cndmask_b32 v176, v192, v176, s[64:65]
    v_cndmask_b32 v177, v193, v177, s[66:67]
    v_cndmask_b32 v178, v194, v178, s[68:69]
    v_cndmask_b32 v179, v195, v179, s[70:71]
    v_cndmask_b32 v180, v196, v180, s[72:73]
    v_cndmask_b32 v181, v197, v181, s[74:75]
    v_cndmask_b32 v182, v198, v182, s[76:77]
    v_cndmask_b32 v183, v199, v183, s[78:79]
    v_cndmask_b32 v184, v200, v184, s[80:81]
    v_cndmask_b32 v185, v201, v185, s[82:83]
    v_cndmask_b32 v186, v202, v186, s[84:85]
    v_cndmask_b32 v187, v203, v187, s[86:87]
    v_cndmask_b32 v188, v204, v188, s[88:89]
    v_cndmask_b32 v189, v205, v189, s[90:91]
    v_cndmask_b32 v190, v206, v190, s[92:93]
    v_cndmask_b32 v191, v207, v191, s[94:95]
    v_mov_b32 v4, 0xff800000
    v_max3_f32 v4, v4, v176, v177
    v_max3_f32 v4, v4, v178, v179
    v_max3_f32 v4, v4, v180, v181
    v_max3_f32 v4, v4, v182, v183
    v_max3_f32 v4, v4, v184, v185
    v_max3_f32 v4, v4, v186, v187
    v_max3_f32 v4, v4, v188, v189
    v_max3_f32 v4, v4, v190, v191
    v_mfma_f32_32x32x16_bf16 v[160:175], v[28:31], v[140:143], 0
    s_cmp_lt_i32 2, s38
    s_cbranch_scc1 L_F1_57
    v_max3_f32 v4, v4, v144, v145
    v_max3_f32 v4, v4, v146, v147
    v_max3_f32 v4, v4, v148, v149
    v_max3_f32 v4, v4, v150, v151
    v_max3_f32 v4, v4, v152, v153
    v_max3_f32 v4, v4, v154, v155
    v_max3_f32 v4, v4, v156, v157
    v_max3_f32 v4, v4, v158, v159
L_F1_57:
    s_nop 9
    v_mfma_f32_32x32x16_bf16 v[144:159], v[32:35], v[140:143], 0
    s_cmp_lt_i32 3, s38
    s_cbranch_scc1 L_F1_58
    v_max3_f32 v4, v4, v160, v161
    v_max3_f32 v4, v4, v162, v163
    v_max3_f32 v4, v4, v164, v165
    v_max3_f32 v4, v4, v166, v167
    v_max3_f32 v4, v4, v168, v169
    v_max3_f32 v4, v4, v170, v171
    v_max3_f32 v4, v4, v172, v173
    v_max3_f32 v4, v4, v174, v175
L_F1_58:
    s_nop 9
    v_mfma_f32_32x32x16_bf16 v[160:175], v[36:39], v[140:143], 0
    s_cmp_lt_i32 4, s38
    s_cbranch_scc1 L_F1_59
    v_max3_f32 v4, v4, v144, v145
    v_max3_f32 v4, v4, v146, v147
    v_max3_f32 v4, v4, v148, v149
    v_max3_f32 v4, v4, v150, v151
    v_max3_f32 v4, v4, v152, v153
    v_max3_f32 v4, v4, v154, v155
    v_max3_f32 v4, v4, v156, v157
    v_max3_f32 v4, v4, v158, v159
L_F1_59:
    s_nop 9
    v_mfma_f32_32x32x16_bf16 v[144:159], v[40:43], v[140:143], 0
    s_cmp_lt_i32 5, s38
    s_cbranch_scc1 L_F1_60
    v_max3_f32 v4, v4, v160, v161
    v_max3_f32 v4, v4, v162, v163
    v_max3_f32 v4, v4, v164, v165
    v_max3_f32 v4, v4, v166, v167
    v_max3_f32 v4, v4, v168, v169
    v_max3_f32 v4, v4, v170, v171
    v_max3_f32 v4, v4, v172, v173
    v_max3_f32 v4, v4, v174, v175
L_F1_60:
    s_nop 9
    v_mfma_f32_32x32x16_bf16 v[160:175], v[44:47], v[140:143], 0
    s_cmp_lt_i32 6, s38
    s_cbranch_scc1 L_F1_61
    v_max3_f32 v4, v4, v144, v145
    v_max3_f32 v4, v4, v146, v147
    v_max3_f32 v4, v4, v148, v149
    v_max3_f32 v4, v4, v150, v151
    v_max3_f32 v4, v4, v152, v153
    v_max3_f32 v4, v4, v154, v155
    v_max3_f32 v4, v4, v156, v157
    v_max3_f32 v4, v4, v158, v159
L_F1_61:
    s_nop 9
    v_mfma_f32_32x32x16_bf16 v[144:159], v[48:51], v[140:143], 0
    s_cmp_lt_i32 7, s38
    s_cbranch_scc1 L_F1_62
    v_max3_f32 v4, v4, v160, v161
    v_max3_f32 v4, v4, v162, v163
    v_max3_f32 v4, v4, v164, v165
    v_max3_f32 v4, v4, v166, v167
    v_max3_f32 v4, v4, v168, v169
    v_max3_f32 v4, v4, v170, v171
    v_max3_f32 v4, v4, v172, v173
    v_max3_f32 v4, v4, v174, v175
L_F1_62:
    s_nop 9
    s_cmp_lt_i32 8, s38
    s_cbranch_scc1 L_F1_63
    v_max3_f32 v4, v4, v144, v145
    v_max3_f32 v4, v4, v146, v147
    v_max3_f32 v4, v4, v148, v149
    v_max3_f32 v4, v4, v150, v151
    v_max3_f32 v4, v4, v152, v153
    v_max3_f32 v4, v4, v154, v155
    v_max3_f32 v4, v4, v156, v157
    v_max3_f32 v4, v4, v158, v159
L_F1_63:
    s_nop 9
    v_mov_b32 v5, v4
    s_nop 1
    v_permlane32_swap_b32 v4, v5
    s_nop 1
    v_max_f32 v4, v4, v5
    v_sub_f32 v4, 0, v4
    v_mov_b32 v192, v4
    v_mov_b32 v193, v4
    v_mov_b32 v194, v4
    v_mov_b32 v195, v4
    v_mov_b32 v196, v4
    v_mov_b32 v197, v4
    v_mov_b32 v198, v4
    v_mov_b32 v199, v4
    v_mov_b32 v200, v4
    v_mov_b32 v201, v4
    v_mov_b32 v202, v4
    v_mov_b32 v203, v4
    v_mov_b32 v204, v4
    v_mov_b32 v205, v4
    v_mov_b32 v206, v4
    v_mov_b32 v207, v4
    v_mov_b32 v208, 0
    v_mov_b32 v209, 0
    v_mov_b32 v210, 0
    v_mov_b32 v211, 0
    v_mov_b32 v212, 0
    v_mov_b32 v213, 0
    v_mov_b32 v214, 0
    v_mov_b32 v215, 0
    v_mov_b32 v216, 0
    v_mov_b32 v217, 0
    v_mov_b32 v218, 0
    v_mov_b32 v219, 0
    v_mov_b32 v220, 0
    v_mov_b32 v221, 0
    v_mov_b32 v222, 0
    v_mov_b32 v223, 0
    v_mfma_f32_32x32x16_bf16 v[144:159], v[24:27], v[140:143], v[192:207]
    v_add_f32 v176, v176, v4
    v_add_f32 v177, v177, v4
    v_add_f32 v178, v178, v4
    v_add_f32 v179, v179, v4
    v_add_f32 v180, v180, v4
    v_add_f32 v181, v181, v4
    v_add_f32 v182, v182, v4
    v_add_f32 v183, v183, v4
    v_add_f32 v184, v184, v4
    v_add_f32 v185, v185, v4
    v_add_f32 v186, v186, v4
    v_add_f32 v187, v187, v4
    v_add_f32 v188, v188, v4
    v_add_f32 v189, v189, v4
    v_add_f32 v190, v190, v4
    v_add_f32 v191, v191, v4
    v_exp_f32 v176, v176
    v_exp_f32 v177, v177
    v_exp_f32 v178, v178
    v_exp_f32 v179, v179
    v_exp_f32 v180, v180
    v_exp_f32 v181, v181
    v_exp_f32 v182, v182
    v_exp_f32 v183, v183
    v_exp_f32 v184, v184
    v_exp_f32 v185, v185
    v_exp_f32 v186, v186
    v_exp_f32 v187, v187
    v_exp_f32 v188, v188
    v_exp_f32 v189, v189
    v_exp_f32 v190, v190
    v_exp_f32 v191, v191
    s_nop 0
    v_cvt_pk_bf16_f32 v232, v176, v177
    v_cvt_pk_bf16_f32 v233, v178, v179
    v_cvt_pk_bf16_f32 v234, v180, v181
    v_cvt_pk_bf16_f32 v235, v182, v183
    v_cvt_pk_bf16_f32 v236, v184, v185
    v_cvt_pk_bf16_f32 v237, v186, v187
    v_cvt_pk_bf16_f32 v238, v188, v189
    v_cvt_pk_bf16_f32 v239, v190, v191
    v_and_b32 v224, v232, v240
    v_and_b32 v225, v233, v241
    v_and_b32 v226, v234, v242
    v_and_b32 v227, v235, v243
    v_and_b32 v228, v236, v244
    v_and_b32 v229, v237, v245
    v_and_b32 v230, v238, v246
    v_and_b32 v231, v239, v247
    v_xor_b32 v232, v232, v224
    v_xor_b32 v233, v233, v225
    v_xor_b32 v234, v234, v226
    v_xor_b32 v235, v235, v227
    v_xor_b32 v236, v236, v228
    v_xor_b32 v237, v237, v229
    v_xor_b32 v238, v238, v230
    v_xor_b32 v239, v239, v231
    s_nop 1
    v_mfma_f32_32x32x16_bf16 v[208:223], v[128:131], v[224:227], v[208:223]
    v_mfma_f32_32x32x16_bf16 v[208:223], v[132:135], v[228:231], v[208:223]
    s_cmp_lt_i32 1, s38
    s_cbranch_scc1 L_FBW_64
    v_mfma_f32_32x32x16_bf16 v[208:223], v[64:67], v[232:235], v[208:223]
    v_mfma_f32_32x32x16_bf16 v[208:223], v[68:71], v[236:239], v[208:223]
L_FBW_64:
    v_mfma_f32_32x32x16_bf16 v[160:175], v[28:31], v[140:143], v[192:207]
    s_cmp_lt_i32 2, s38
    s_cbranch_scc1 L_F2_65
    v_exp_f32 v144, v144
    v_exp_f32 v145, v145
    v_exp_f32 v146, v146
    v_exp_f32 v147, v147
    v_exp_f32 v148, v148
    v_exp_f32 v149, v149
    v_exp_f32 v150, v150
    v_exp_f32 v151, v151
    v_exp_f32 v152, v152
    v_exp_f32 v153, v153
    v_exp_f32 v154, v154
    v_exp_f32 v155, v155
    v_exp_f32 v156, v156
    v_exp_f32 v157, v157
    v_exp_f32 v158, v158
    v_exp_f32 v159, v159
    s_nop 0
    v_cvt_pk_bf16_f32 v224, v144, v145
    v_cvt_pk_bf16_f32 v225, v146, v147
    v_cvt_pk_bf16_f32 v226, v148, v149
    v_cvt_pk_bf16_f32 v227, v150, v151
    v_cvt_pk_bf16_f32 v228, v152, v153
    v_cvt_pk_bf16_f32 v229, v154, v155
    v_cvt_pk_bf16_f32 v230, v156, v157
    v_cvt_pk_bf16_f32 v231, v158, v159
    s_nop 1
    v_mfma_f32_32x32x16_bf16 v[208:223], v[72:75], v[224:227], v[208:223]
    v_mfma_f32_32x32x16_bf16 v[208:223], v[76:79], v[228:231], v[208:223]
L_F2_65:
    s_nop 9
    v_mfma_f32_32x32x16_bf16 v[144:159], v[32:35], v[140:143], v[192:207]
    s_cmp_lt_i32 3, s38
    s_cbranch_scc1 L_F2_66
    v_exp_f32 v160, v160
    v_exp_f32 v161, v161
    v_exp_f32 v162, v162
    v_exp_f32 v163, v163
    v_exp_f32 v164, v164
    v_exp_f32 v165, v165
    v_exp_f32 v166, v166
    v_exp_f32 v167, v167
    v_exp_f32 v168, v168
    v_exp_f32 v169, v169
    v_exp_f32 v170, v170
    v_exp_f32 v171, v171
    v_exp_f32 v172, v172
    v_exp_f32 v173, v173
    v_exp_f32 v174, v174
    v_exp_f32 v175, v175
    s_nop 0
    v_cvt_pk_bf16_f32 v232, v160, v161
    v_cvt_pk_bf16_f32 v233, v162, v163
    v_cvt_pk_bf16_f32 v234, v164, v165
    v_cvt_pk_bf16_f32 v235, v166, v167
    v_cvt_pk_bf16_f32 v236, v168, v169
    v_cvt_pk_bf16_f32 v237, v170, v171
    v_cvt_pk_bf16_f32 v238, v172, v173
    v_cvt_pk_bf16_f32 v239, v174, v175
    s_nop 1
    v_mfma_f32_32x32x16_bf16 v[208:223], v[80:83], v[232:235], v[208:223]
    v_mfma_f32_32x32x16_bf16 v[208:223], v[84:87], v[236:239], v[208:223]
L_F2_66:
    s_nop 9
    v_mfma_f32_32x32x16_bf16 v[160:175], v[36:39], v[140:143], v[192:207]
    s_cmp_lt_i32 4, s38
    s_cbranch_scc1 L_F2_67
    v_exp_f32 v144, v144
    v_exp_f32 v145, v145
    v_exp_f32 v146, v146
    v_exp_f32 v147, v147
    v_exp_f32 v148, v148
    v_exp_f32 v149, v149
    v_exp_f32 v150, v150
    v_exp_f32 v151, v151
    v_exp_f32 v152, v152
    v_exp_f32 v153, v153
    v_exp_f32 v154, v154
    v_exp_f32 v155, v155
    v_exp_f32 v156, v156
    v_exp_f32 v157, v157
    v_exp_f32 v158, v158
    v_exp_f32 v159, v159
    s_nop 0
    v_cvt_pk_bf16_f32 v224, v144, v145
    v_cvt_pk_bf16_f32 v225, v146, v147
    v_cvt_pk_bf16_f32 v226, v148, v149
    v_cvt_pk_bf16_f32 v227, v150, v151
    v_cvt_pk_bf16_f32 v228, v152, v153
    v_cvt_pk_bf16_f32 v229, v154, v155
    v_cvt_pk_bf16_f32 v230, v156, v157
    v_cvt_pk_bf16_f32 v231, v158, v159
    s_nop 1
    v_mfma_f32_32x32x16_bf16 v[208:223], v[88:91], v[224:227], v[208:223]
    v_mfma_f32_32x32x16_bf16 v[208:223], v[92:95], v[228:231], v[208:223]
L_F2_67:
    s_nop 9
    v_mfma_f32_32x32x16_bf16 v[144:159], v[40:43], v[140:143], v[192:207]
    s_cmp_lt_i32 5, s38
    s_cbranch_scc1 L_F2_68
    v_exp_f32 v160, v160
    v_exp_f32 v161, v161
    v_exp_f32 v162, v162
    v_exp_f32 v163, v163
    v_exp_f32 v164, v164
    v_exp_f32 v165, v165
    v_exp_f32 v166, v166
    v_exp_f32 v167, v167
    v_exp_f32 v168, v168
    v_exp_f32 v169, v169
    v_exp_f32 v170, v170
    v_exp_f32 v171, v171
    v_exp_f32 v172, v172
    v_exp_f32 v173, v173
    v_exp_f32 v174, v174
    v_exp_f32 v175, v175
    s_nop 0
    v_cvt_pk_bf16_f32 v232, v160, v161
    v_cvt_pk_bf16_f32 v233, v162, v163
    v_cvt_pk_bf16_f32 v234, v164, v165
    v_cvt_pk_bf16_f32 v235, v166, v167
    v_cvt_pk_bf16_f32 v236, v168, v169
    v_cvt_pk_bf16_f32 v237, v170, v171
    v_cvt_pk_bf16_f32 v238, v172, v173
    v_cvt_pk_bf16_f32 v239, v174, v175
    s_nop 1
    v_mfma_f32_32x32x16_bf16 v[208:223], v[96:99], v[232:235], v[208:223]
    v_mfma_f32_32x32x16_bf16 v[208:223], v[100:103], v[236:239], v[208:223]
L_F2_68:
    s_nop 9
    v_mfma_f32_32x32x16_bf16 v[160:175], v[44:47], v[140:143], v[192:207]
    s_cmp_lt_i32 6, s38
    s_cbranch_scc1 L_F2_69
    v_exp_f32 v144, v144
    v_exp_f32 v145, v145
    v_exp_f32 v146, v146
    v_exp_f32 v147, v147
    v_exp_f32 v148, v148
    v_exp_f32 v149, v149
    v_exp_f32 v150, v150
    v_exp_f32 v151, v151
    v_exp_f32 v152, v152
    v_exp_f32 v153, v153
    v_exp_f32 v154, v154
    v_exp_f32 v155, v155
    v_exp_f32 v156, v156
    v_exp_f32 v157, v157
    v_exp_f32 v158, v158
    v_exp_f32 v159, v159
    s_nop 0
    v_cvt_pk_bf16_f32 v224, v144, v145
    v_cvt_pk_bf16_f32 v225, v146, v147
    v_cvt_pk_bf16_f32 v226, v148, v149
    v_cvt_pk_bf16_f32 v227, v150, v151
    v_cvt_pk_bf16_f32 v228, v152, v153
    v_cvt_pk_bf16_f32 v229, v154, v155
    v_cvt_pk_bf16_f32 v230, v156, v157
    v_cvt_pk_bf16_f32 v231, v158, v159
    s_nop 1
    v_mfma_f32_32x32x16_bf16 v[208:223], v[104:107], v[224:227], v[208:223]
    v_mfma_f32_32x32x16_bf16 v[208:223], v[108:111], v[228:231], v[208:223]
L_F2_69:
    s_nop 9
    v_mfma_f32_32x32x16_bf16 v[144:159], v[48:51], v[140:143], v[192:207]
    s_cmp_lt_i32 7, s38
    s_cbranch_scc1 L_F2_70
    v_exp_f32 v160, v160
    v_exp_f32 v161, v161
    v_exp_f32 v162, v162
    v_exp_f32 v163, v163
    v_exp_f32 v164, v164
    v_exp_f32 v165, v165
    v_exp_f32 v166, v166
    v_exp_f32 v167, v167
    v_exp_f32 v168, v168
    v_exp_f32 v169, v169
    v_exp_f32 v170, v170
    v_exp_f32 v171, v171
    v_exp_f32 v172, v172
    v_exp_f32 v173, v173
    v_exp_f32 v174, v174
    v_exp_f32 v175, v175
    s_nop 0
    v_cvt_pk_bf16_f32 v232, v160, v161
    v_cvt_pk_bf16_f32 v233, v162, v163
    v_cvt_pk_bf16_f32 v234, v164, v165
    v_cvt_pk_bf16_f32 v235, v166, v167
    v_cvt_pk_bf16_f32 v236, v168, v169
    v_cvt_pk_bf16_f32 v237, v170, v171
    v_cvt_pk_bf16_f32 v238, v172, v173
    v_cvt_pk_bf16_f32 v239, v174, v175
    s_nop 1
    v_mfma_f32_32x32x16_bf16 v[208:223], v[112:115], v[232:235], v[208:223]
    v_mfma_f32_32x32x16_bf16 v[208:223], v[116:119], v[236:239], v[208:223]
L_F2_70:
    s_nop 9
    s_cmp_lt_i32 8, s38
    s_cbranch_scc1 L_F2_71
    v_exp_f32 v144, v144
    v_exp_f32 v145, v145
    v_exp_f32 v146, v146
    v_exp_f32 v147, v147
    v_exp_f32 v148, v148
    v_exp_f32 v149, v149
    v_exp_f32 v150, v150
    v_exp_f32 v151, v151
    v_exp_f32 v152, v152
    v_exp_f32 v153, v153
    v_exp_f32 v154, v154
    v_exp_f32 v155, v155
    v_exp_f32 v156, v156
    v_exp_f32 v157, v157
    v_exp_f32 v158, v158
    v_exp_f32 v159, v159
    s_nop 0
    v_cvt_pk_bf16_f32 v224, v144, v145
    v_cvt_pk_bf16_f32 v225, v146, v147
    v_cvt_pk_bf16_f32 v226, v148, v149
    v_cvt_pk_bf16_f32 v227, v150, v151
    v_cvt_pk_bf16_f32 v228, v152, v153
    v_cvt_pk_bf16_f32 v229, v154, v155
    v_cvt_pk_bf16_f32 v230, v156, v157
    v_cvt_pk_bf16_f32 v231, v158, v159
    s_nop 1
    v_mfma_f32_32x32x16_bf16 v[208:223], v[120:123], v[224:227], v[208:223]
    v_mfma_f32_32x32x16_bf16 v[208:223], v[124:127], v[228:231], v[208:223]
L_F2_71:
    s_nop 9
    s_nop 7
    v_rcp_f32 v5, v216
    s_add_u32 s62, s37, 1
    s_mul_i32 s62, s62, 118
    v_mul_f32 v208, v208, v5
    v_mul_f32 v209, v209, v5
    v_mul_f32 v210, v210, v5
    v_mul_f32 v211, v211, v5
    v_mul_f32 v212, v212, v5
    v_mul_f32 v213, v213, v5
    v_mul_f32 v214, v214, v5
    v_mul_f32 v215, v215, v5
    s_add_u32 s62, s62, s36
    s_lshl_b32 s62, s62, 10
    s_add_u32 s62, s62, 6379520
    v_cvt_pk_bf16_f32 v12, v208, v209
    v_cvt_pk_bf16_f32 v13, v210, v211
    v_cvt_pk_bf16_f32 v14, v212, v213
    v_cvt_pk_bf16_f32 v15, v214, v215
    buffer_store_dwordx4 v[12:15], v2, s[28:31], s62 offen sc1
    s_nop 1
    s_branch L_ATT_DONE
.section .rodata,"a"
.p2align 6
.amdhsa_kernel gated_mix__sliding_block__dense_activation_mish__prompt_kernel
  .amdhsa_next_free_vgpr 256
  .amdhsa_next_free_sgpr 102
  .amdhsa_accum_offset 256
  .amdhsa_group_segment_fixed_size 0
  .amdhsa_kernarg_size 88
  .amdhsa_user_sgpr_count 2
  .amdhsa_user_sgpr_kernarg_segment_ptr 1
  .amdhsa_system_sgpr_workgroup_id_x 1
.end_amdhsa_kernel
```
